```python
import torch

def _softmax(x, axis=-1):
    return torch.softmax(x, dim=axis)
def _gelu(x):
    return torch.nn.functional.gelu(x, approximate="tanh")
def _silu(x):
    return torch.nn.functional.silu(x)
def _sigmoid(x):
    return torch.sigmoid(x)
def _layernorm(x, axis=-1, eps=1e-5):
    m = x.mean(dim=axis, keepdim=True)
    v = x.var(dim=axis, keepdim=True, unbiased=False)
    return (x - m) / torch.sqrt(v + eps)
def _scatter_add(tgt, idx, src, axis=0):
    return tgt.clone().index_add_(axis, idx, src)
def _segment_sum(src, seg, n):
    out = torch.zeros((n,) + src.shape[1:], dtype=src.dtype)
    return out.index_add_(0, seg, src)
def _pad(x, pw):
    flat = tuple(v for pair in reversed(pw) for v in pair)
    return torch.nn.functional.pad(x, flat)

kernel_name = 'interleave_layers__linear_kernel_hedgehog__geglu_ffn__prompt'

def setup_inputs():

    _w = (lambda a: (lambda t: t.to(torch.bfloat16) if t.is_floating_point() else t)(torch.as_tensor(a)))
    def _A_setup():
        B, S, D, H = 1, 2048, 512, 32
        Dh = D // H
        return {
            "x": _w((lambda *s: torch.randn(*s, dtype=torch.bfloat16) * 0.05)(B, S, D)),
            "wqkv": _w((lambda *s: torch.randn(*s, dtype=torch.bfloat16) * 0.2)(D, 3 * D)),
            "w_phi": _w((lambda *s: torch.randn(*s, dtype=torch.bfloat16) * 0.2)(H, Dh, Dh) * (Dh ** -0.5)),
            "wo": _w((lambda *s: torch.randn(*s, dtype=torch.bfloat16) * 0.05)(D, D)),
        }
    _A_in = _A_setup()

    def _B_setup():
        B, S, D, F = 1, 2048, 512, 1792
        return {
            "x": _w((lambda *s: torch.randn(*s, dtype=torch.bfloat16) * 0.05)(B, S, D)),
            "w_gate": _w((lambda *s: torch.randn(*s, dtype=torch.bfloat16) * 0.05)(D, F)),
            "w_up": _w((lambda *s: torch.randn(*s, dtype=torch.bfloat16) * 0.05)(D, F)),
            "w_down": _w((lambda *s: torch.randn(*s, dtype=torch.bfloat16) * 0.05)(F, D)),
        }
    _B_in = _B_setup()

    return {
        "A_x": _A_in["x"],
        "A_wqkv": _A_in["wqkv"],
        "A_w_phi": _A_in["w_phi"],
        "A_wo": _A_in["wo"],
        "B_x": _B_in["x"],
        "B_w_gate": _B_in["w_gate"],
        "B_w_up": _B_in["w_up"],
        "B_w_down": _B_in["w_down"],
    }

def reference(A_x, A_wqkv, A_w_phi, A_wo, B_x, B_w_gate, B_w_up, B_w_down):
    def _A_ref(x, wqkv, w_phi, wo):
        B, S, D = x.shape
        H = 32; Dh = D // H
        qkv = (lambda x, *d: x.permute(*d))((x @ wqkv).reshape(B, S, 3, H, Dh), 2, 0, 3, 1, 4)
        q, k, v = qkv[0], qkv[1], qkv[2]
        pq = torch.einsum("bhsd,hdf->bhsf", q, w_phi)
        pk = torch.einsum("bhsd,hdf->bhsf", k, w_phi)
        phi_q = torch.concatenate([_softmax(pq, axis=-1), _softmax(-pq, axis=-1)], axis=-1)
        phi_k = torch.concatenate([_softmax(pk, axis=-1), _softmax(-pk, axis=-1)], axis=-1)
        kv = torch.einsum("bhsf,bhsd->bhfd", phi_k, v)
        z  = torch.einsum("bhsf->bhf", phi_k)
        num = torch.einsum("bhqf,bhfd->bhqd", phi_q, kv)
        den = torch.einsum("bhqf,bhf->bhq", phi_q, z)[..., None] + 1e-6
        o = num / den
        return (lambda x, *d: x.permute(*d))(o, 0, 2, 1, 3).reshape(B, S, D) @ wo

    def _B_ref(x, w_gate, w_up, w_down):
        return (_gelu(x @ w_gate) * (x @ w_up)) @ w_down

    x = A_x
    x = x + _A_ref(_layernorm(x, axis=-1), A_wqkv, A_w_phi, A_wo)
    x = x + _B_ref(_layernorm(x, axis=-1), B_w_gate, B_w_up, B_w_down)
    x = x + _A_ref(_layernorm(x, axis=-1), A_wqkv, A_w_phi, A_wo)
    x = x + _B_ref(_layernorm(x, axis=-1), B_w_gate, B_w_up, B_w_down)
    return x
```

```asm
; @launch grid=(256,1,1) block=(256,1,1) lds=163840
.amdgcn_target "amdgcn-amd-amdhsa--gfx950"
.text
.globl interleave_layers__linear_kernel_hedgehog__geglu_ffn__prompt_kernel
.p2align 8
.type interleave_layers__linear_kernel_hedgehog__geglu_ffn__prompt_kernel,@function
interleave_layers__linear_kernel_hedgehog__geglu_ffn__prompt_kernel:
    s_cmp_ge_u32 s2, 256
    s_cbranch_scc1 L_end
    s_load_dwordx16 s[80:95], s[0:1], 0
    s_load_dwordx4 s[96:99], s[0:1], 64
    s_load_dwordx2 s[100:101], s[0:1], 80
    v_lshrrev_b32 v100, 6, v0
    v_and_b32 v9, 63, v0
    v_readfirstlane_b32 s48, v100
    s_and_b32 s49, s2, 7
    s_lshr_b32 s50, s2, 3
    s_getpc_b64 s[44:45]
L_pc:
    s_sub_u32 s44, s44, L_pc-interleave_layers__linear_kernel_hedgehog__geglu_ffn__prompt_kernel
    s_subb_u32 s45, s45, 0
    s_cmp_lg_u32 s48, 3
    s_cbranch_scc1 L_nopf
    s_and_b32 s46, s50, 7
    s_lshl_b32 s46, s46, 13
    v_lshl_add_u32 v101, v9, 7, s46
    v_min_u32 v101, L_last-interleave_layers__linear_kernel_hedgehog__geglu_ffn__prompt_kernel, v101
    global_load_dword v127, v101, s[44:45]
L_nopf:
    s_and_b32 s52, s50, 1
    s_lshr_b32 s51, s50, 1
    s_and_b32 s54, s50, 3
    s_lshr_b32 s53, s50, 2
    s_xor_b32 s53, s53, 4
    s_lshl_b32 s69, s48, 11
    s_lshl_b32 s70, s48, 13
    v_lshlrev_b32 v1, 4, v9
    v_and_b32 v104, 3, v9
    v_lshrrev_b32 v106, 3, v9
    v_and_b32 v107, 7, v9
    v_lshrrev_b32 v108, 4, v9
    v_lshrrev_b32 v110, 2, v9
    v_mul_u32_u24 v110, 3072, v110
    v_lshl_add_u32 v5, v104, 4, v110
    v_xor_b32 v110, v107, v108
    v_lshlrev_b32 v110, 4, v110
    v_lshl_add_u32 v112, v106, 10, v110
    v_xor_b32 v113, 64, v112
    v_add_u32 v113, 7168, v113
    v_add_u32 v114, 14336, v112
    v_add_u32 v115, 14336, v113
    s_lshl_b32 s57, s51, 6
    s_mul_i32 s58, s48, 49152
    s_add_u32 s65, s57, s58
    s_add_u32 s65, s65, 1024
    s_add_u32 s71, s53, s49
    s_and_b32 s71, s71, 7
    s_lshl_b32 s71, s71, 12
    s_lshl_b32 s60, s49, 3
    s_lshl_b32 s57, s52, 2
    s_add_u32 s60, s60, s57
    s_add_u32 s60, s60, s48
    s_waitcnt lgkmcnt(0)
    s_mov_b64 s[4:5], s[80:81]
    s_mov_b32 s6, 2097152
    s_mov_b32 s7, 0x20000
    s_mov_b64 s[8:9], s[82:83]
    s_mov_b32 s10, 1572864
    s_mov_b32 s11, 0x20000
    s_mov_b64 s[32:33], s[100:101]
    s_mov_b32 s34, 29360128
    s_mov_b32 s35, 0x20000
    s_mov_b64 s[40:41], s[98:99]
    s_mov_b32 s42, 256
    s_mov_b32 s43, 0x20000
    s_lshl_b32 s3, s60, 15
    s_add_u32 s57, s71, 0
    s_and_b32 s57, s57, 0x7000
    s_lshr_b32 s0, s57, 5
    s_add_u32 m0, s70, 32768
    s_add_u32 s0, s0, s3
    buffer_load_dwordx4 v112, s[4:7], s0 offen offset:0 lds
    buffer_load_dwordx4 v113, s[4:7], s0 offen offset:1024 lds
    buffer_load_dwordx4 v114, s[4:7], s0 offen offset:2048 lds
    buffer_load_dwordx4 v115, s[4:7], s0 offen offset:3072 lds
    s_mul_i32 s0, s57, 48
    s_add_u32 m0, s69, 65536
    s_add_u32 s0, s0, s65
    buffer_load_dwordx4 v5, s[8:11], s0 offen lds
    buffer_load_dwordx4 v5, s[8:11], s0 offen offset:1024 lds
    v_min_u32 v110, 11, v9
    v_lshlrev_b32 v110, 10, v110
    s_lshl2_add_u32 s0, s50, s48
    s_mul_i32 s0, s0, 12288
    buffer_load_dword v126, v110, s[8:11], s0 offen offset:384
    s_mov_b64 s[44:45], s[84:85]
    s_mov_b32 s46, 16384
    s_mov_b32 s47, 0x20000
    s_mov_b64 s[12:13], s[86:87]
    s_mov_b32 s14, 524288
    s_mov_b32 s15, 0x20000
    s_mov_b64 s[16:17], s[90:91]
    s_mov_b32 s18, 1835008
    s_mov_b32 s19, 0x20000
    s_sub_u32 s20, s92, 1024
    s_subb_u32 s21, s93, 0
    s_mov_b32 s22, 1836032
    s_mov_b32 s23, 0x20000
    s_mov_b64 s[24:25], s[94:95]
    s_mov_b32 s26, 1835008
    s_mov_b32 s27, 0x20000
    s_mov_b64 s[36:37], s[100:101]
    s_mov_b32 s38, 29360128
    s_mov_b32 s39, 0x20000
    s_mov_b64 s[28:29], s[96:97]
    s_mov_b32 s30, 2097152
    s_mov_b32 s31, 0x20000
    s_mov_b32 s56, 200000
    s_mov_b32 s55, 1
    s_mul_i32 s62, s49, 8192
    s_add_u32 s62, s62, 196608
    s_mul_i32 s63, s51, 12288
    s_and_b32 s57, s48, 1
    s_lshl_b32 s61, s54, 1
    s_add_u32 s61, s61, s57
    s_lshr_b32 s58, s48, 1
    s_lshl_b32 s72, s53, 1
    s_add_u32 s72, s72, s58
    s_lshl_b32 s68, s58, 2
    s_add_u32 s68, s68, s57
    s_lshl_b32 s68, s68, 16
    s_lshl_b32 s76, s53, 7
    s_add_u32 s68, s68, s76
    s_mul_i32 s95, s48, 1280
    s_add_u32 s95, s95, s63
    s_lshl_b32 s77, s49, 3
    s_add_u32 s77, s77, s61
    s_mul_i32 s81, s77, 114688
    s_lshl_b32 s57, s58, 14
    s_add_u32 s81, s81, s57
    s_add_u32 s81, s81, 11534336
    s_lshl_b32 s80, s61, 6
    s_lshl_b32 s57, s58, 5
    s_add_u32 s80, s80, s57
    s_add_u32 s80, s80, s62
    s_mul_i32 s58, s48, 458752
    s_add_u32 s67, s76, s58
    s_lshl2_add_u32 s57, s49, s54
    s_cmp_ge_u32 s50, 28
    s_cselect_b32 s53, s57, s50
    s_lshl_b32 s57, s53, 7
    s_mul_i32 s58, s48, 28672
    s_add_u32 s66, s57, s58
    s_mul_i32 s74, s51, 98304
    s_add_u32 s74, s74, s69
    s_add_u32 s74, s74, 27262976
    s_mul_i32 s78, s60, 114688
    s_lshl_b32 s57, s51, 11
    s_add_u32 s78, s78, s57
    s_add_u32 s78, s78, 11534336
    s_and_b32 s57, s60, 7
    s_lshl_b32 s57, s57, 6
    s_add_u32 s57, s57, s62
    s_add_u32 s86, s57, 1024
    s_lshl_b32 s58, s51, 2
    s_add_u32 s79, s57, s58
    s_lshl_b32 s57, s77, 15
    s_lshl_b32 s58, s72, 6
    s_add_u32 s75, s57, s58
    s_lshl_b32 s58, s72, 11
    s_add_u32 s82, s57, s58
    s_add_u32 s82, s82, 5242880
    s_lshl_b32 s83, s77, 12
    s_bfe_u32 s58, s72, 0x20001
    s_lshl_b32 s58, s58, 10
    s_add_u32 s83, s83, s58
    s_lshr_b32 s58, s72, 3
    s_lshl_b32 s58, s58, 9
    s_add_u32 s83, s83, s58
    s_and_b32 s58, s72, 1
    s_lshl_b32 s58, s58, 3
    s_add_u32 s83, s83, s58
    s_add_u32 s83, s83, 262144
    s_lshl_b32 s84, s61, 6
    s_lshl_b32 s58, s72, 2
    s_add_u32 s84, s84, s58
    s_add_u32 s84, s84, s62
    s_add_u32 s84, s84, 1024
    s_lshl_b32 s88, s60, 15
    s_add_u32 s88, s88, 5242880
    s_lshl_b32 s90, s60, 12
    s_add_u32 s90, s90, 262144
    s_lshl_b32 s57, s48, 7
    s_add_u32 s85, s57, s62
    s_add_u32 s85, s85, 1024
    s_lshl_b32 s57, s48, 8
    s_lshl_b32 s58, s50, 2
    s_add_u32 s92, s57, s58
    s_add_u32 s92, s92, s62
    s_add_u32 s92, s92, 4096
    s_lshl_b32 s57, s49, 2
    s_add_u32 s57, s57, s48
    s_lshl_b32 s87, s57, 16
    s_add_u32 s87, s87, 5242880
    s_lshl_b32 s89, s57, 13
    s_add_u32 s89, s89, 262144
    s_mul_i32 s91, s57, 229376
    s_lshl_b32 s58, s50, 12
    s_add_u32 s91, s91, s58
    s_add_u32 s91, s91, 11534336
    s_lshl_b32 s57, s54, 8
    s_mul_i32 s58, s48, 28
    s_add_u32 s93, s57, s58
    s_add_u32 s93, s93, s62
    s_add_u32 s93, s93, 4096
    s_lshl_b32 s57, s49, 2
    s_add_u32 s57, s57, s54
    s_mul_i32 s94, s57, 229376
    s_lshl_b32 s58, s58, 10
    s_add_u32 s94, s94, s58
    s_add_u32 s94, s94, 11534336
    s_cmp_eq_u32 s48, 0
    s_cselect_b32 s98, s63, 117440512
    s_add_u32 s98, s98, 10240
    s_getreg_b32 s57, hwreg(HW_REG_XCC_ID)
    s_and_b32 s57, s57, 15
    s_mul_i32 s58, s57, s57
    s_lshl_b32 s58, s58, 15
    s_lshl_b32 s57, s57, 6
    s_add_u32 s64, s57, s58
    s_add_u32 s64, s64, 1
    v_lshrrev_b32 v100, 5, v9
    v_and_b32 v101, 31, v9
    v_bfe_u32 v102, v9, 4, 1
    v_bfe_u32 v103, v9, 2, 2
    v_lshrrev_b32 v105, 1, v104
    v_and_b32 v110, 1, v104
    v_lshl_add_u32 v105, v110, 1, v105
    v_lshl_add_u32 v110, v100, 3, v103
    v_lshl_add_u32 v111, v102, 2, v105
    v_lshlrev_b32 v111, 3, v111
    v_lshl_add_u32 v2, v110, 6, v111
    v_lshrrev_b32 v109, 1, v103
    v_lshl_add_u32 v111, v109, 6, v111
    v_lshl_add_u32 v3, v110, 7, v111
    s_lshr_b32 s57, s48, 1
    s_lshl_b32 s57, s57, 6
    v_xor_b32 v3, s57, v3
    v_lshlrev_b32_e64 v110, 11, v100
    v_lshl_add_u32 v110, v102, 10, v110
    v_lshl_add_u32 v110, v103, 7, v110
    v_lshl_add_u32 v111, v102, 1, v109
    v_lshl_add_u32 v110, v111, 5, v110
    v_lshl_add_u32 v4, v105, 3, v110
    v_lshlrev_b32 v110, 2, v102
    v_xor_b32 v110, v107, v110
    v_lshlrev_b32 v110, 4, v110
    v_lshl_add_u32 v6, v106, 10, v110
    v_add_u32 v10, 7168, v6
    v_lshlrev_b32 v110, 1, v102
    v_xor_b32 v110, v107, v110
    v_lshlrev_b32 v110, 4, v110
    v_mul_u32_u24 v111, 3584, v106
    v_add_u32 v7, v110, v111
    v_xor_b32 v11, 64, v7
    v_lshlrev_b32 v110, 4, v100
    v_lshl_add_u32 v8, v101, 10, v110
    v_min_u32 v110, 1, v9
    v_lshlrev_b32 v28, 30, v110
    v_add_u32 v12, 65536, v2
    v_add_u32 v20, 32768, v2
    v_lshrrev_b32 v29, 5, v9
    v_and_b32 v30, 31, v9
    v_lshlrev_b32 v13, 4, v30
    v_add_u32 v13, 161792, v13
    s_lshl_b32 s57, s48, 5
    v_add_u32 v30, s57, v30
    v_mul_u32_u24 v30, 208, v30
    v_add_u32 v30, 131072, v30
    v_lshl_add_u32 v15, v29, 5, v30
    v_lshl_add_u32 v14, v29, 4, v30
    v_bfe_u32 v30, v9, 2, 2
    v_lshl_add_u32 v30, v29, 4, v30
    v_mul_u32_u24 v27, 40, v30
    v_and_b32 v30, 0x38, v2
    v_min_u32 v30, 32, v30
    v_add_u32 v27, v27, v30
    v_add_u32 v27, 158720, v27
    v_bfe_u32 v30, v9, 2, 2
    v_lshrrev_b32 v29, 4, v9
    v_lshl_add_u32 v25, v30, 2, v29
    v_lshl_add_u32 v26, v29, 2, v30
    v_mul_u32_u24 v25, 40, v25
    v_mul_u32_u24 v26, 40, v26
    v_and_b32 v30, 3, v9
    v_lshl_add_u32 v25, v30, 3, v25
    v_lshl_add_u32 v26, v30, 1, v26
    s_mul_i32 s58, s48, 640
    s_add_u32 s58, s58, 158720
    v_add_u32 v25, s58, v25
    v_add_u32 v26, s58, v26
    v_lshrrev_b32 v29, 4, v9
    v_bfe_u32 v30, v9, 2, 2
    v_lshl_add_u32 v30, v29, 3, v30
    v_mul_u32_u24 v30, 208, v30
    v_and_b32 v16, 3, v9
    v_lshl_add_u32 v30, v16, 3, v30
    s_lshr_b32 s58, s48, 1
    s_lshl_b32 s59, s58, 5
    s_add_u32 s59, s59, 131072
    v_add_u32 v16, s59, v30
    s_add_u32 s57, s57, 131136
    v_add_u32 v17, s57, v30
    v_lshlrev_b32 v18, 2, v9
    s_lshl_b32 s58, s58, 14
    v_add_u32 v21, s58, v3
    v_xor_b32 v22, 64, v21
    v_add_u32 v23, 98304, v21
    v_add_u32 v24, 98304, v22
    v_bfe_u32 v116, v101, 1, 3
    v_xor_b32 v116, v100, v116
    v_lshlrev_b32 v116, 4, v116
    v_lshl_add_u32 v116, v101, 7, v116
    v_add_u32 v116, s70, v116
    v_xor_b32 v117, 32, v116
    v_xor_b32 v118, 64, v116
    v_xor_b32 v119, 96, v116
    v_lshl_add_u32 v110, v100, 3, v103
    v_lshrrev_b32 v120, 1, v104
    v_lshl_add_u32 v120, v102, 1, v120
    v_lshlrev_b32 v120, 3, v120
    v_lshl_add_u32 v120, v110, 5, v120
    s_lshl_b32 s58, s48, 10
    s_add_u32 s76, s58, 131072
    v_add_u32 v120, s76, v120
    v_bfe_u32 v121, v9, 2, 1
    v_mul_u32_u24 v121, 0x8000, v121
    v_lshl_add_u32 v121, v121, 16, v121
    v_mov_b32 v92, 0
    v_mov_b32 v93, 0
    v_mov_b32 v94, 0
    v_mov_b32 v95, 0
    v_mov_b32 v100, 0
    v_mov_b32 v101, 0
    v_mov_b32 v102, 0
    v_mov_b32 v103, 0
    s_and_b32 s57, s48, 1
    s_lshl_b32 s57, s57, 10
    s_lshr_b32 s58, s48, 1
    s_lshl_b32 s58, s58, 12
    s_add_u32 s57, s57, s58
    v_add_u32 v109, s57, v12
    v_lshlrev_b32 v110, 7, v9
    v_min_u32 v124, 768, v110
    v_min_u32 v125, 384, v110
    s_lshl2_add_u32 s59, s50, s48
    s_lshl_b32 s57, s49, 7
    s_add_u32 s57, s57, s59
    s_mul_i32 s77, s57, 896
    v_add_u32 v0, s78, v110
    s_sub_u32 s58, s82, 2048
    v_add_u32 v111, s58, v110
    v_cmp_lt_u32 vcc, 15, v9
    s_and_b32 s59, s83, 0xfffffe00
    s_sub_u32 s58, s59, 4096
    v_cndmask_b32 v0, v0, v111, vcc
    v_min_u32 v111, 4480, v110
    v_add_u32 v111, s58, v111
    v_cmp_lt_u32 vcc, 31, v9
    v_lshrrev_b32 v110, 5, v9
    v_lshl_add_u32 v19, v110, 28, v1
    v_cndmask_b32 v0, v0, v111, vcc
    v_mov_b32 v88, 0x3f803f80
    v_mov_b32 v89, 0x3f803f80
    v_mov_b32 v90, 0x3f803f80
    v_mov_b32 v91, 0x3f803f80
    s_mov_b32 m0, s76
    s_lshl_b32 s0, s51, 10
    buffer_load_dwordx4 v1, s[44:47], s0 offen lds
    s_mov_b32 s45, s59
    s_mul_i32 s57, s48, 3072
    s_add_u32 s46, s63, s57
    s_mov_b32 s47, 0
    s_lshl_b32 s57, s48, 11
    s_add_u32 s57, s62, s57
    s_mov_b32 s58, 0
    s_cmp_lt_u32 s51, 8
    s_cselect_b32 s57, s57, 117440512
    s_cselect_b32 s58, s58, 117440512
    s_cmp_eq_u32 s52, 0
    s_cselect_b32 s46, s46, s57
    s_cselect_b32 s47, s47, s58
    s_cselect_b32 s59, 0, 4
    s_and_b32 s57, s51, 7
    s_cmp_eq_u32 s57, s49
    s_cselect_b32 s46, s46, 117440512
    s_cselect_b32 s47, s47, 117440512
    s_cmp_eq_u32 s48, 0
    s_cselect_b32 s47, s47, 117440512
    s_add_u32 s47, s47, 0
    v_add_u32 v105, s47, v28
    v_add_u32 v106, s59, v108
    v_lshrrev_b32 v106, 2, v106
    v_lshl_add_u32 v106, v106, 28, v1
    v_mov_b32 v104, 1
    v_mov_b32 v96, 0
    v_mov_b32 v97, 0
    v_mov_b32 v98, 0
    v_mov_b32 v99, 0
    s_add_u32 s57, s71, 4096
    s_and_b32 s57, s57, 0x7000
    s_lshr_b32 s0, s57, 5
    s_add_u32 m0, s70, 36864
    s_add_u32 s0, s0, s3
    buffer_load_dwordx4 v112, s[4:7], s0 offen offset:0 lds
    buffer_load_dwordx4 v113, s[4:7], s0 offen offset:1024 lds
    buffer_load_dwordx4 v114, s[4:7], s0 offen offset:2048 lds
    buffer_load_dwordx4 v115, s[4:7], s0 offen offset:3072 lds
    s_mul_i32 s0, s57, 48
    s_add_u32 m0, s69, 73728
    s_add_u32 s0, s0, s65
    buffer_load_dwordx4 v5, s[8:11], s0 offen lds
    buffer_load_dwordx4 v5, s[8:11], s0 offen offset:1024 lds
    s_add_u32 s57, s71, 8192
    s_and_b32 s57, s57, 0x7000
    s_lshr_b32 s0, s57, 5
    s_add_u32 m0, s70, 0
    s_add_u32 s0, s0, s3
    buffer_load_dwordx4 v112, s[4:7], s0 offen offset:0 lds
    buffer_load_dwordx4 v113, s[4:7], s0 offen offset:1024 lds
    buffer_load_dwordx4 v114, s[4:7], s0 offen offset:2048 lds
    buffer_load_dwordx4 v115, s[4:7], s0 offen offset:3072 lds
    s_mul_i32 s0, s57, 48
    s_add_u32 m0, s69, 81920
    s_add_u32 s0, s0, s65
    buffer_load_dwordx4 v5, s[8:11], s0 offen lds
    buffer_load_dwordx4 v5, s[8:11], s0 offen offset:1024 lds
    s_waitcnt vmcnt(16)
    ds_read_b128 v[128:131], v116 offset:32768
    ds_read_b128 v[132:135], v117 offset:32768
    ds_read_b128 v[136:139], v118 offset:32768
    ds_read_b128 v[140:143], v119 offset:32768
    s_waitcnt vmcnt(14)
    s_barrier
    ds_read_b64_tr_b16 a[224:225], v12 offset:0
    ds_read_b64_tr_b16 a[226:227], v12 offset:256
    ds_read_b64_tr_b16 a[228:229], v12 offset:1024
    ds_read_b64_tr_b16 a[230:231], v12 offset:1280
    ds_read_b64_tr_b16 a[232:233], v12 offset:2048
    ds_read_b64_tr_b16 a[234:235], v12 offset:2304
    ds_read_b64_tr_b16 a[236:237], v12 offset:3072
    ds_read_b64_tr_b16 a[238:239], v12 offset:3328
    ds_read_b64_tr_b16 a[0:1], v109 offset:0
    ds_read_b64_tr_b16 a[2:3], v109 offset:256
    ds_read_b64_tr_b16 a[4:5], v109 offset:2048
    ds_read_b64_tr_b16 a[6:7], v109 offset:2304
    s_waitcnt lgkmcnt(14)
    v_dot2c_f32_bf16 v92, v128, v88
    v_dot2c_f32_bf16 v93, v128, v128
    v_dot2c_f32_bf16 v94, v129, v88
    v_dot2c_f32_bf16 v95, v129, v129
    v_dot2c_f32_bf16 v100, v130, v88
    v_dot2c_f32_bf16 v101, v130, v130
    v_dot2c_f32_bf16 v102, v131, v88
    v_dot2c_f32_bf16 v103, v131, v131
    v_dot2c_f32_bf16 v92, v132, v88
    v_dot2c_f32_bf16 v93, v132, v132
    v_dot2c_f32_bf16 v94, v133, v88
    v_dot2c_f32_bf16 v95, v133, v133
    v_dot2c_f32_bf16 v100, v134, v88
    v_dot2c_f32_bf16 v101, v134, v134
    v_dot2c_f32_bf16 v102, v135, v88
    v_dot2c_f32_bf16 v103, v135, v135
    s_waitcnt lgkmcnt(13)
    v_dot2c_f32_bf16 v92, v136, v88
    v_dot2c_f32_bf16 v93, v136, v136
    v_dot2c_f32_bf16 v94, v137, v88
    v_dot2c_f32_bf16 v95, v137, v137
    v_dot2c_f32_bf16 v100, v138, v88
    v_dot2c_f32_bf16 v101, v138, v138
    v_dot2c_f32_bf16 v102, v139, v88
    v_dot2c_f32_bf16 v103, v139, v139
    s_waitcnt lgkmcnt(12)
    v_dot2c_f32_bf16 v92, v140, v88
    v_dot2c_f32_bf16 v93, v140, v140
    v_dot2c_f32_bf16 v94, v141, v88
    v_dot2c_f32_bf16 v95, v141, v141
    v_dot2c_f32_bf16 v100, v142, v88
    v_dot2c_f32_bf16 v101, v142, v142
    v_dot2c_f32_bf16 v102, v143, v88
    v_dot2c_f32_bf16 v103, v143, v143
    s_add_u32 s57, s71, 12288
    s_and_b32 s57, s57, 0x7000
    s_lshr_b32 s0, s57, 5
    s_add_u32 m0, s70, 4096
    s_add_u32 s0, s0, s3
    buffer_load_dwordx4 v112, s[4:7], s0 offen offset:0 lds
    s_waitcnt lgkmcnt(10)
    v_mfma_f32_32x32x16_bf16 v[48:63], a[224:227], v[128:131], 0
    s_waitcnt vmcnt(9)
    ds_read_b128 v[144:147], v116 offset:36864
    ds_read_b128 v[148:151], v117 offset:36864
    ds_read_b128 v[152:155], v118 offset:36864
    ds_read_b128 v[156:159], v119 offset:36864
    buffer_load_dwordx4 v113, s[4:7], s0 offen offset:1024 lds
    s_waitcnt lgkmcnt(12)
    v_mfma_f32_32x32x16_bf16 v[64:79], a[228:231], v[128:131], 0
    ds_read_b64_tr_b16 a[240:241], v12 offset:4096
    ds_read_b64_tr_b16 a[242:243], v12 offset:4352
    ds_read_b64_tr_b16 a[244:245], v12 offset:5120
    ds_read_b64_tr_b16 a[246:247], v12 offset:5376
    buffer_load_dwordx4 v114, s[4:7], s0 offen offset:2048 lds
    s_waitcnt lgkmcnt(10)
    v_mfma_f32_32x32x16_bf16 a[16:31], v[88:91], a[0:3], 0
    v_mfma_f32_32x32x16_bf16 v[48:63], a[232:235], v[132:135], v[48:63]
    buffer_load_dwordx4 v115, s[4:7], s0 offen offset:3072 lds
    v_mfma_f32_32x32x16_bf16 v[64:79], a[236:239], v[132:135], v[64:79]
    s_mul_i32 s0, s57, 48
    s_add_u32 m0, s69, 90112
    s_add_u32 s0, s0, s65
    buffer_load_dwordx4 v5, s[8:11], s0 offen lds
    ds_read_b64_tr_b16 a[224:225], v12 offset:6144
    ds_read_b64_tr_b16 a[226:227], v12 offset:6400
    ds_read_b64_tr_b16 a[228:229], v12 offset:7168
    ds_read_b64_tr_b16 a[230:231], v12 offset:7424
    s_waitcnt lgkmcnt(12)
    v_mfma_f32_32x32x16_bf16 a[16:31], v[88:91], a[4:7], a[16:31]
    buffer_load_dwordx4 v5, s[8:11], s0 offen offset:1024 lds
    s_waitcnt lgkmcnt(6)
    v_mfma_f32_32x32x16_bf16 v[48:63], a[240:243], v[136:139], v[48:63]
    s_waitcnt lgkmcnt(4)
    v_mfma_f32_32x32x16_bf16 v[64:79], a[244:247], v[136:139], v[64:79]
    buffer_store_dwordx4 v[96:99], v1, s[32:35], s46 offen sc1
    s_waitcnt vmcnt(13)
    s_barrier
    ds_read_b64_tr_b16 a[232:233], v12 offset:8192
    ds_read_b64_tr_b16 a[234:235], v12 offset:8448
    ds_read_b64_tr_b16 a[236:237], v12 offset:9216
    ds_read_b64_tr_b16 a[238:239], v12 offset:9472
    s_waitcnt lgkmcnt(6)
    v_mfma_f32_32x32x16_bf16 v[48:63], a[224:227], v[140:143], v[48:63]
    buffer_store_dwordx4 v[96:99], v1, s[32:35], s46 offen offset:1024 sc1
    s_waitcnt lgkmcnt(4)
    v_mfma_f32_32x32x16_bf16 v[64:79], a[228:231], v[140:143], v[64:79]
    buffer_store_dwordx4 v[96:99], v106, s[32:35], s46 offen offset:2048 sc1
    ds_read_b64_tr_b16 a[240:241], v12 offset:10240
    ds_read_b64_tr_b16 a[242:243], v12 offset:10496
    ds_read_b64_tr_b16 a[244:245], v12 offset:11264
    ds_read_b64_tr_b16 a[246:247], v12 offset:11520
    ds_read_b64_tr_b16 a[8:9], v109 offset:8192
    ds_read_b64_tr_b16 a[10:11], v109 offset:8448
    ds_read_b64_tr_b16 a[12:13], v109 offset:10240
    ds_read_b64_tr_b16 a[14:15], v109 offset:10496
    v_dot2c_f32_bf16 v92, v144, v88
    v_dot2c_f32_bf16 v93, v144, v144
    v_dot2c_f32_bf16 v94, v145, v88
    v_dot2c_f32_bf16 v95, v145, v145
    v_dot2c_f32_bf16 v100, v146, v88
    v_dot2c_f32_bf16 v101, v146, v146
    v_dot2c_f32_bf16 v102, v147, v88
    v_dot2c_f32_bf16 v103, v147, v147
    v_dot2c_f32_bf16 v92, v148, v88
    v_dot2c_f32_bf16 v93, v148, v148
    v_dot2c_f32_bf16 v94, v149, v88
    v_dot2c_f32_bf16 v95, v149, v149
    v_dot2c_f32_bf16 v100, v150, v88
    v_dot2c_f32_bf16 v101, v150, v150
    v_dot2c_f32_bf16 v102, v151, v88
    v_dot2c_f32_bf16 v103, v151, v151
    v_dot2c_f32_bf16 v92, v152, v88
    v_dot2c_f32_bf16 v93, v152, v152
    v_dot2c_f32_bf16 v94, v153, v88
    v_dot2c_f32_bf16 v95, v153, v153
    v_dot2c_f32_bf16 v100, v154, v88
    v_dot2c_f32_bf16 v101, v154, v154
    v_dot2c_f32_bf16 v102, v155, v88
    v_dot2c_f32_bf16 v103, v155, v155
    v_dot2c_f32_bf16 v92, v156, v88
    v_dot2c_f32_bf16 v93, v156, v156
    v_dot2c_f32_bf16 v94, v157, v88
    v_dot2c_f32_bf16 v95, v157, v157
    v_dot2c_f32_bf16 v100, v158, v88
    v_dot2c_f32_bf16 v101, v158, v158
    v_dot2c_f32_bf16 v102, v159, v88
    v_dot2c_f32_bf16 v103, v159, v159
    s_add_u32 s57, s71, 16384
    s_and_b32 s57, s57, 0x7000
    s_lshr_b32 s0, s57, 5
    s_add_u32 m0, s70, 32768
    s_add_u32 s0, s0, s3
    buffer_load_dwordx4 v112, s[4:7], s0 offen offset:0 lds
    s_waitcnt lgkmcnt(10)
    v_mfma_f32_32x32x16_bf16 v[48:63], a[232:235], v[144:147], v[48:63]
    s_waitcnt vmcnt(12)
    ds_read_b128 v[160:163], v116 offset:0
    ds_read_b128 v[164:167], v117 offset:0
    ds_read_b128 v[168:171], v118 offset:0
    ds_read_b128 v[172:175], v119 offset:0
    s_waitcnt lgkmcnt(12)
    v_mfma_f32_32x32x16_bf16 v[64:79], a[236:239], v[144:147], v[64:79]
    buffer_load_dwordx4 v113, s[4:7], s0 offen offset:1024 lds
    ds_read_b64_tr_b16 a[224:225], v12 offset:12288
    ds_read_b64_tr_b16 a[226:227], v12 offset:12544
    ds_read_b64_tr_b16 a[228:229], v12 offset:13312
    ds_read_b64_tr_b16 a[230:231], v12 offset:13568
    s_waitcnt lgkmcnt(10)
    v_mfma_f32_32x32x16_bf16 a[16:31], v[88:91], a[8:11], a[16:31]
    buffer_load_dwordx4 v114, s[4:7], s0 offen offset:2048 lds
    v_mfma_f32_32x32x16_bf16 v[48:63], a[240:243], v[148:151], v[48:63]
    buffer_load_dwordx4 v115, s[4:7], s0 offen offset:3072 lds
    v_mfma_f32_32x32x16_bf16 v[64:79], a[244:247], v[148:151], v[64:79]
    ds_read_b64_tr_b16 a[232:233], v12 offset:14336
    ds_read_b64_tr_b16 a[234:235], v12 offset:14592
    ds_read_b64_tr_b16 a[236:237], v12 offset:15360
    ds_read_b64_tr_b16 a[238:239], v12 offset:15616
    s_waitcnt lgkmcnt(12)
    v_mfma_f32_32x32x16_bf16 a[16:31], v[88:91], a[12:15], a[16:31]
    s_mul_i32 s0, s57, 48
    s_add_u32 m0, s69, 98304
    s_add_u32 s0, s0, s65
    buffer_load_dwordx4 v5, s[8:11], s0 offen lds
    s_waitcnt lgkmcnt(6)
    v_mfma_f32_32x32x16_bf16 v[48:63], a[224:227], v[152:155], v[48:63]
    buffer_load_dwordx4 v5, s[8:11], s0 offen offset:1024 lds
    s_waitcnt lgkmcnt(4)
    v_mfma_f32_32x32x16_bf16 v[64:79], a[228:231], v[152:155], v[64:79]
    s_waitcnt vmcnt(15)
    s_barrier
    ds_read_b64_tr_b16 a[240:241], v12 offset:16384
    ds_read_b64_tr_b16 a[242:243], v12 offset:16640
    buffer_load_dwordx4 v[80:83], v8, s[4:7], s75 offen
    ds_read_b64_tr_b16 a[244:245], v12 offset:17408
    ds_read_b64_tr_b16 a[246:247], v12 offset:17664
    s_waitcnt lgkmcnt(6)
    v_mfma_f32_32x32x16_bf16 v[48:63], a[232:235], v[156:159], v[48:63]
    s_waitcnt lgkmcnt(4)
    v_mfma_f32_32x32x16_bf16 v[64:79], a[236:239], v[156:159], v[64:79]
    buffer_load_dwordx4 v[84:87], v8, s[4:7], s75 offen offset:32
    s_nop 0
    ds_read_b64_tr_b16 a[224:225], v12 offset:18432
    ds_read_b64_tr_b16 a[226:227], v12 offset:18688
    ds_read_b64_tr_b16 a[228:229], v12 offset:19456
    ds_read_b64_tr_b16 a[230:231], v12 offset:19712
    ds_read_b64_tr_b16 a[0:1], v109 offset:16384
    ds_read_b64_tr_b16 a[2:3], v109 offset:16640
    ds_read_b64_tr_b16 a[4:5], v109 offset:18432
    ds_read_b64_tr_b16 a[6:7], v109 offset:18688
    v_dot2c_f32_bf16 v92, v160, v88
    v_dot2c_f32_bf16 v93, v160, v160
    v_dot2c_f32_bf16 v94, v161, v88
    v_dot2c_f32_bf16 v95, v161, v161
    v_dot2c_f32_bf16 v100, v162, v88
    v_dot2c_f32_bf16 v101, v162, v162
    v_dot2c_f32_bf16 v102, v163, v88
    v_dot2c_f32_bf16 v103, v163, v163
    v_dot2c_f32_bf16 v92, v164, v88
    v_dot2c_f32_bf16 v93, v164, v164
    v_dot2c_f32_bf16 v94, v165, v88
    v_dot2c_f32_bf16 v95, v165, v165
    v_dot2c_f32_bf16 v100, v166, v88
    v_dot2c_f32_bf16 v101, v166, v166
    v_dot2c_f32_bf16 v102, v167, v88
    v_dot2c_f32_bf16 v103, v167, v167
    v_dot2c_f32_bf16 v92, v168, v88
    v_dot2c_f32_bf16 v93, v168, v168
    v_dot2c_f32_bf16 v94, v169, v88
    v_dot2c_f32_bf16 v95, v169, v169
    v_dot2c_f32_bf16 v100, v170, v88
    v_dot2c_f32_bf16 v101, v170, v170
    v_dot2c_f32_bf16 v102, v171, v88
    v_dot2c_f32_bf16 v103, v171, v171
    v_dot2c_f32_bf16 v92, v172, v88
    v_dot2c_f32_bf16 v93, v172, v172
    v_dot2c_f32_bf16 v94, v173, v88
    v_dot2c_f32_bf16 v95, v173, v173
    v_dot2c_f32_bf16 v100, v174, v88
    v_dot2c_f32_bf16 v101, v174, v174
    v_dot2c_f32_bf16 v102, v175, v88
    v_dot2c_f32_bf16 v103, v175, v175
    s_add_u32 s57, s71, 20480
    s_and_b32 s57, s57, 0x7000
    s_lshr_b32 s0, s57, 5
    s_add_u32 m0, s70, 36864
    s_add_u32 s0, s0, s3
    buffer_load_dwordx4 v112, s[4:7], s0 offen offset:0 lds
    s_waitcnt lgkmcnt(10)
    v_mfma_f32_32x32x16_bf16 v[48:63], a[240:243], v[160:163], v[48:63]
    s_waitcnt vmcnt(14)
    ds_read_b128 v[176:179], v116 offset:4096
    ds_read_b128 v[180:183], v117 offset:4096
    ds_read_b128 v[184:187], v118 offset:4096
    ds_read_b128 v[188:191], v119 offset:4096
    s_waitcnt lgkmcnt(12)
    v_mfma_f32_32x32x16_bf16 v[64:79], a[244:247], v[160:163], v[64:79]
    buffer_load_dwordx4 v113, s[4:7], s0 offen offset:1024 lds
    ds_read_b64_tr_b16 a[232:233], v12 offset:20480
    ds_read_b64_tr_b16 a[234:235], v12 offset:20736
    ds_read_b64_tr_b16 a[236:237], v12 offset:21504
    ds_read_b64_tr_b16 a[238:239], v12 offset:21760
    s_waitcnt lgkmcnt(10)
    v_mfma_f32_32x32x16_bf16 a[16:31], v[88:91], a[0:3], a[16:31]
    v_mfma_f32_32x32x16_bf16 v[48:63], a[224:227], v[164:167], v[48:63]
    buffer_load_dwordx4 v114, s[4:7], s0 offen offset:2048 lds
    v_mfma_f32_32x32x16_bf16 v[64:79], a[228:231], v[164:167], v[64:79]
    ds_read_b64_tr_b16 a[240:241], v12 offset:22528
    ds_read_b64_tr_b16 a[242:243], v12 offset:22784
    ds_read_b64_tr_b16 a[244:245], v12 offset:23552
    ds_read_b64_tr_b16 a[246:247], v12 offset:23808
    s_waitcnt lgkmcnt(12)
    v_mfma_f32_32x32x16_bf16 a[16:31], v[88:91], a[4:7], a[16:31]
    buffer_load_dwordx4 v115, s[4:7], s0 offen offset:3072 lds
    s_waitcnt lgkmcnt(6)
    v_mfma_f32_32x32x16_bf16 v[48:63], a[232:235], v[168:171], v[48:63]
    s_waitcnt lgkmcnt(4)
    v_mfma_f32_32x32x16_bf16 v[64:79], a[236:239], v[168:171], v[64:79]
    s_mul_i32 s0, s57, 48
    s_add_u32 m0, s69, 106496
    s_add_u32 s0, s0, s65
    buffer_load_dwordx4 v5, s[8:11], s0 offen lds
    s_waitcnt vmcnt(16)
    s_barrier
    ds_read_b64_tr_b16 a[224:225], v12 offset:24576
    ds_read_b64_tr_b16 a[226:227], v12 offset:24832
    ds_read_b64_tr_b16 a[228:229], v12 offset:25600
    ds_read_b64_tr_b16 a[230:231], v12 offset:25856
    s_waitcnt lgkmcnt(6)
    v_mfma_f32_32x32x16_bf16 v[48:63], a[240:243], v[172:175], v[48:63]
    buffer_load_dwordx4 v5, s[8:11], s0 offen offset:1024 lds
    s_waitcnt lgkmcnt(4)
    v_mfma_f32_32x32x16_bf16 v[64:79], a[244:247], v[172:175], v[64:79]
    s_nop 0
    ds_read_b64_tr_b16 a[232:233], v12 offset:26624
    ds_read_b64_tr_b16 a[234:235], v12 offset:26880
    ds_read_b64_tr_b16 a[236:237], v12 offset:27648
    ds_read_b64_tr_b16 a[238:239], v12 offset:27904
    ds_read_b64_tr_b16 a[8:9], v109 offset:24576
    ds_read_b64_tr_b16 a[10:11], v109 offset:24832
    ds_read_b64_tr_b16 a[12:13], v109 offset:26624
    ds_read_b64_tr_b16 a[14:15], v109 offset:26880
    v_dot2c_f32_bf16 v92, v176, v88
    v_dot2c_f32_bf16 v93, v176, v176
    v_dot2c_f32_bf16 v94, v177, v88
    v_dot2c_f32_bf16 v95, v177, v177
    v_dot2c_f32_bf16 v100, v178, v88
    v_dot2c_f32_bf16 v101, v178, v178
    v_dot2c_f32_bf16 v102, v179, v88
    v_dot2c_f32_bf16 v103, v179, v179
    v_dot2c_f32_bf16 v92, v180, v88
    v_dot2c_f32_bf16 v93, v180, v180
    v_dot2c_f32_bf16 v94, v181, v88
    v_dot2c_f32_bf16 v95, v181, v181
    v_dot2c_f32_bf16 v100, v182, v88
    v_dot2c_f32_bf16 v101, v182, v182
    v_dot2c_f32_bf16 v102, v183, v88
    v_dot2c_f32_bf16 v103, v183, v183
    v_dot2c_f32_bf16 v92, v184, v88
    v_dot2c_f32_bf16 v93, v184, v184
    v_dot2c_f32_bf16 v94, v185, v88
    v_dot2c_f32_bf16 v95, v185, v185
    v_dot2c_f32_bf16 v100, v186, v88
    v_dot2c_f32_bf16 v101, v186, v186
    v_dot2c_f32_bf16 v102, v187, v88
    v_dot2c_f32_bf16 v103, v187, v187
    v_dot2c_f32_bf16 v92, v188, v88
    v_dot2c_f32_bf16 v93, v188, v188
    v_dot2c_f32_bf16 v94, v189, v88
    v_dot2c_f32_bf16 v95, v189, v189
    v_dot2c_f32_bf16 v100, v190, v88
    v_dot2c_f32_bf16 v101, v190, v190
    v_dot2c_f32_bf16 v102, v191, v88
    v_dot2c_f32_bf16 v103, v191, v191
    s_add_u32 s57, s71, 24576
    s_and_b32 s57, s57, 0x7000
    s_lshr_b32 s0, s57, 5
    s_add_u32 m0, s70, 0
    s_add_u32 s0, s0, s3
    buffer_load_dwordx4 v112, s[4:7], s0 offen offset:0 lds
    s_waitcnt lgkmcnt(10)
    v_mfma_f32_32x32x16_bf16 v[48:63], a[224:227], v[176:179], v[48:63]
    s_waitcnt vmcnt(11)
    ds_read_b128 v[192:195], v116 offset:32768
    ds_read_b128 v[196:199], v117 offset:32768
    ds_read_b128 v[200:203], v118 offset:32768
    ds_read_b128 v[204:207], v119 offset:32768
    s_waitcnt lgkmcnt(12)
    v_mfma_f32_32x32x16_bf16 v[64:79], a[228:231], v[176:179], v[64:79]
    buffer_load_dwordx4 v113, s[4:7], s0 offen offset:1024 lds
    ds_read_b64_tr_b16 a[240:241], v12 offset:28672
    ds_read_b64_tr_b16 a[242:243], v12 offset:28928
    ds_read_b64_tr_b16 a[244:245], v12 offset:29696
    ds_read_b64_tr_b16 a[246:247], v12 offset:29952
    s_waitcnt lgkmcnt(10)
    v_mfma_f32_32x32x16_bf16 a[16:31], v[88:91], a[8:11], a[16:31]
    v_mfma_f32_32x32x16_bf16 v[48:63], a[232:235], v[180:183], v[48:63]
    buffer_load_dwordx4 v114, s[4:7], s0 offen offset:2048 lds
    v_mfma_f32_32x32x16_bf16 v[64:79], a[236:239], v[180:183], v[64:79]
    ds_read_b64_tr_b16 a[224:225], v12 offset:30720
    ds_read_b64_tr_b16 a[226:227], v12 offset:30976
    ds_read_b64_tr_b16 a[228:229], v12 offset:31744
    ds_read_b64_tr_b16 a[230:231], v12 offset:32000
    s_waitcnt lgkmcnt(12)
    v_mfma_f32_32x32x16_bf16 a[16:31], v[88:91], a[12:15], a[16:31]
    buffer_load_dwordx4 v115, s[4:7], s0 offen offset:3072 lds
    s_waitcnt lgkmcnt(6)
    v_mfma_f32_32x32x16_bf16 v[48:63], a[240:243], v[184:187], v[48:63]
    s_waitcnt lgkmcnt(4)
    v_mfma_f32_32x32x16_bf16 v[64:79], a[244:247], v[184:187], v[64:79]
    s_mul_i32 s0, s57, 48
    s_add_u32 m0, s69, 114688
    s_add_u32 s0, s0, s65
    buffer_load_dwordx4 v5, s[8:11], s0 offen lds
    s_waitcnt vmcnt(13)
    s_barrier
    buffer_atomic_add v104, v105, s[40:43], 0 offen
    ds_read_b64_tr_b16 a[232:233], v12 offset:32768
    ds_read_b64_tr_b16 a[234:235], v12 offset:33024
    ds_read_b64_tr_b16 a[236:237], v12 offset:33792
    ds_read_b64_tr_b16 a[238:239], v12 offset:34048
    s_waitcnt lgkmcnt(6)
    v_mfma_f32_32x32x16_bf16 v[48:63], a[224:227], v[188:191], v[48:63]
    buffer_load_dwordx4 v5, s[8:11], s0 offen offset:1024 lds
    s_waitcnt lgkmcnt(4)
    v_mfma_f32_32x32x16_bf16 v[64:79], a[228:231], v[188:191], v[64:79]
    ds_read_b64_tr_b16 a[240:241], v12 offset:34816
    ds_read_b64_tr_b16 a[242:243], v12 offset:35072
    ds_read_b64_tr_b16 a[244:245], v12 offset:35840
    ds_read_b64_tr_b16 a[246:247], v12 offset:36096
    ds_read_b64_tr_b16 a[0:1], v109 offset:32768
    ds_read_b64_tr_b16 a[2:3], v109 offset:33024
    ds_read_b64_tr_b16 a[4:5], v109 offset:34816
    ds_read_b64_tr_b16 a[6:7], v109 offset:35072
    v_dot2c_f32_bf16 v92, v192, v88
    v_dot2c_f32_bf16 v93, v192, v192
    v_dot2c_f32_bf16 v94, v193, v88
    v_dot2c_f32_bf16 v95, v193, v193
    v_dot2c_f32_bf16 v100, v194, v88
    v_dot2c_f32_bf16 v101, v194, v194
    v_dot2c_f32_bf16 v102, v195, v88
    v_dot2c_f32_bf16 v103, v195, v195
    v_dot2c_f32_bf16 v92, v196, v88
    v_dot2c_f32_bf16 v93, v196, v196
    v_dot2c_f32_bf16 v94, v197, v88
    v_dot2c_f32_bf16 v95, v197, v197
    v_dot2c_f32_bf16 v100, v198, v88
    v_dot2c_f32_bf16 v101, v198, v198
    v_dot2c_f32_bf16 v102, v199, v88
    v_dot2c_f32_bf16 v103, v199, v199
    v_dot2c_f32_bf16 v92, v200, v88
    v_dot2c_f32_bf16 v93, v200, v200
    v_dot2c_f32_bf16 v94, v201, v88
    v_dot2c_f32_bf16 v95, v201, v201
    v_dot2c_f32_bf16 v100, v202, v88
    v_dot2c_f32_bf16 v101, v202, v202
    v_dot2c_f32_bf16 v102, v203, v88
    v_dot2c_f32_bf16 v103, v203, v203
    v_dot2c_f32_bf16 v92, v204, v88
    v_dot2c_f32_bf16 v93, v204, v204
    v_dot2c_f32_bf16 v94, v205, v88
    v_dot2c_f32_bf16 v95, v205, v205
    v_dot2c_f32_bf16 v100, v206, v88
    v_dot2c_f32_bf16 v101, v206, v206
    v_dot2c_f32_bf16 v102, v207, v88
    v_dot2c_f32_bf16 v103, v207, v207
    s_add_u32 s57, s71, 28672
    s_and_b32 s57, s57, 0x7000
    s_lshr_b32 s0, s57, 5
    s_add_u32 m0, s70, 4096
    s_add_u32 s0, s0, s3
    buffer_load_dwordx4 v112, s[4:7], s0 offen offset:0 lds
    s_waitcnt lgkmcnt(10)
    v_mfma_f32_32x32x16_bf16 v[48:63], a[232:235], v[192:195], v[48:63]
    s_waitcnt vmcnt(10)
    ds_read_b128 v[208:211], v116 offset:36864
    ds_read_b128 v[212:215], v117 offset:36864
    ds_read_b128 v[216:219], v118 offset:36864
    buffer_load_dwordx4 v113, s[4:7], s0 offen offset:1024 lds
    ds_read_b128 v[220:223], v119 offset:36864
    s_waitcnt lgkmcnt(12)
    v_mfma_f32_32x32x16_bf16 v[64:79], a[236:239], v[192:195], v[64:79]
    ds_read_b64_tr_b16 a[224:225], v12 offset:36864
    buffer_load_dwordx4 v114, s[4:7], s0 offen offset:2048 lds
    ds_read_b64_tr_b16 a[226:227], v12 offset:37120
    ds_read_b64_tr_b16 a[228:229], v12 offset:37888
    ds_read_b64_tr_b16 a[230:231], v12 offset:38144
    s_waitcnt lgkmcnt(10)
    v_mfma_f32_32x32x16_bf16 a[16:31], v[88:91], a[0:3], a[16:31]
    buffer_load_dwordx4 v115, s[4:7], s0 offen offset:3072 lds
    v_mfma_f32_32x32x16_bf16 v[48:63], a[240:243], v[196:199], v[48:63]
    v_mfma_f32_32x32x16_bf16 v[64:79], a[244:247], v[196:199], v[64:79]
    s_mul_i32 s0, s57, 48
    s_add_u32 m0, s69, 122880
    s_add_u32 s0, s0, s65
    buffer_load_dwordx4 v5, s[8:11], s0 offen lds
    ds_read_b64_tr_b16 a[232:233], v12 offset:38912
    ds_read_b64_tr_b16 a[234:235], v12 offset:39168
    ds_read_b64_tr_b16 a[236:237], v12 offset:39936
    ds_read_b64_tr_b16 a[238:239], v12 offset:40192
    s_waitcnt lgkmcnt(12)
    v_mfma_f32_32x32x16_bf16 a[16:31], v[88:91], a[4:7], a[16:31]
    buffer_load_dwordx4 v5, s[8:11], s0 offen offset:1024 lds
    s_waitcnt lgkmcnt(6)
    v_mfma_f32_32x32x16_bf16 v[48:63], a[224:227], v[200:203], v[48:63]
    s_lshl_b32 s73, s48, 13
    s_add_u32 s73, s73, s71
    s_add_u32 s73, s73, 0
    s_and_b32 s73, s73, 0x7000
    s_mul_i32 s73, s73, 48
    s_lshl_b32 s0, s51, 6
    s_add_u32 s73, s73, s0
    s_add_u32 m0, s70, 32768
    s_add_u32 s0, s73, 0
    buffer_load_dwordx4 v5, s[8:11], s0 offen lds
    s_waitcnt lgkmcnt(4)
    v_mfma_f32_32x32x16_bf16 v[64:79], a[228:231], v[200:203], v[64:79]
    s_add_u32 m0, s70, 33792
    s_add_u32 s0, s73, 49152
    buffer_load_dwordx4 v5, s[8:11], s0 offen lds
    s_waitcnt vmcnt(15)
    s_barrier
    ds_read_b64_tr_b16 a[240:241], v12 offset:40960
    ds_read_b64_tr_b16 a[242:243], v12 offset:41216
    ds_read_b64_tr_b16 a[244:245], v12 offset:41984
    ds_read_b64_tr_b16 a[246:247], v12 offset:42240
    s_waitcnt lgkmcnt(6)
    v_mfma_f32_32x32x16_bf16 v[48:63], a[232:235], v[204:207], v[48:63]
    s_add_u32 m0, s70, 34816
    s_add_u32 s0, s73, 98304
    buffer_load_dwordx4 v5, s[8:11], s0 offen lds
    s_waitcnt lgkmcnt(4)
    v_mfma_f32_32x32x16_bf16 v[64:79], a[236:239], v[204:207], v[64:79]
    s_add_u32 m0, s70, 35840
    s_add_u32 s0, s73, 147456
    buffer_load_dwordx4 v5, s[8:11], s0 offen lds
    ds_read_b64_tr_b16 a[224:225], v12 offset:43008
    ds_read_b64_tr_b16 a[226:227], v12 offset:43264
    ds_read_b64_tr_b16 a[228:229], v12 offset:44032
    ds_read_b64_tr_b16 a[230:231], v12 offset:44288
    ds_read_b64_tr_b16 a[8:9], v109 offset:40960
    ds_read_b64_tr_b16 a[10:11], v109 offset:41216
    ds_read_b64_tr_b16 a[12:13], v109 offset:43008
    ds_read_b64_tr_b16 a[14:15], v109 offset:43264
    v_lshlrev_b32 v32, 16, v80
    v_and_b32 v33, 0xffff0000, v80
    v_lshlrev_b32 v34, 16, v81
    v_and_b32 v35, 0xffff0000, v81
    v_lshlrev_b32 v36, 16, v82
    v_and_b32 v37, 0xffff0000, v82
    v_lshlrev_b32 v38, 16, v83
    v_and_b32 v39, 0xffff0000, v83
    v_lshlrev_b32 v40, 16, v84
    v_and_b32 v41, 0xffff0000, v84
    v_lshlrev_b32 v42, 16, v85
    v_and_b32 v43, 0xffff0000, v85
    v_lshlrev_b32 v44, 16, v86
    v_and_b32 v45, 0xffff0000, v86
    v_lshlrev_b32 v46, 16, v87
    v_and_b32 v47, 0xffff0000, v87
    ds_read_b64_tr_b16 v[80:81], v120 offset:0
    ds_read_b64_tr_b16 v[82:83], v120 offset:128
    ds_read_b64_tr_b16 v[84:85], v120 offset:512
    ds_read_b64_tr_b16 v[86:87], v120 offset:640
    v_dot2c_f32_bf16 v92, v208, v88
    v_dot2c_f32_bf16 v93, v208, v208
    v_dot2c_f32_bf16 v94, v209, v88
    v_dot2c_f32_bf16 v95, v209, v209
    v_dot2c_f32_bf16 v100, v210, v88
    v_dot2c_f32_bf16 v101, v210, v210
    v_dot2c_f32_bf16 v102, v211, v88
    v_dot2c_f32_bf16 v103, v211, v211
    v_dot2c_f32_bf16 v92, v212, v88
    v_dot2c_f32_bf16 v93, v212, v212
    v_dot2c_f32_bf16 v94, v213, v88
    v_dot2c_f32_bf16 v95, v213, v213
    v_dot2c_f32_bf16 v100, v214, v88
    v_dot2c_f32_bf16 v101, v214, v214
    v_dot2c_f32_bf16 v102, v215, v88
    v_dot2c_f32_bf16 v103, v215, v215
    v_dot2c_f32_bf16 v92, v216, v88
    v_dot2c_f32_bf16 v93, v216, v216
    v_dot2c_f32_bf16 v94, v217, v88
    v_dot2c_f32_bf16 v95, v217, v217
    v_dot2c_f32_bf16 v100, v218, v88
    v_dot2c_f32_bf16 v101, v218, v218
    v_dot2c_f32_bf16 v102, v219, v88
    v_dot2c_f32_bf16 v103, v219, v219
    v_dot2c_f32_bf16 v92, v220, v88
    v_dot2c_f32_bf16 v93, v220, v220
    v_dot2c_f32_bf16 v94, v221, v88
    v_dot2c_f32_bf16 v95, v221, v221
    v_dot2c_f32_bf16 v100, v222, v88
    v_dot2c_f32_bf16 v101, v222, v222
    v_dot2c_f32_bf16 v102, v223, v88
    v_dot2c_f32_bf16 v103, v223, v223
    s_lshl_b32 s73, s48, 13
    s_add_u32 s73, s73, s71
    s_add_u32 s73, s73, 4096
    s_and_b32 s73, s73, 0x7000
    s_mul_i32 s73, s73, 48
    s_lshl_b32 s0, s51, 6
    s_add_u32 s73, s73, s0
    s_add_u32 m0, s70, 36864
    s_add_u32 s0, s73, 0
    buffer_load_dwordx4 v5, s[8:11], s0 offen lds
    s_waitcnt lgkmcnt(14)
    v_mfma_f32_32x32x16_bf16 v[48:63], a[240:243], v[208:211], v[48:63]
    s_waitcnt vmcnt(14)
    ds_read_b128 v[224:227], v116 offset:0
    ds_read_b128 v[228:231], v117 offset:0
    ds_read_b128 v[232:235], v118 offset:0
    ds_read_b128 v[236:239], v119 offset:0
    s_waitcnt lgkmcnt(14)
    v_mfma_f32_32x32x16_bf16 v[64:79], a[244:247], v[208:211], v[64:79]
    s_add_u32 m0, s70, 37888
    s_add_u32 s0, s73, 49152
    buffer_load_dwordx4 v5, s[8:11], s0 offen lds
    ds_read_b64_tr_b16 a[232:233], v12 offset:45056
    ds_read_b64_tr_b16 a[234:235], v12 offset:45312
    ds_read_b64_tr_b16 a[236:237], v12 offset:46080
    ds_read_b64_tr_b16 a[238:239], v12 offset:46336
    s_waitcnt lgkmcnt(14)
    v_mfma_f32_32x32x16_bf16 a[16:31], v[88:91], a[8:11], a[16:31]
    s_add_u32 m0, s70, 38912
    s_add_u32 s0, s73, 98304
    buffer_load_dwordx4 v5, s[8:11], s0 offen lds
    v_mfma_f32_32x32x16_bf16 v[48:63], a[224:227], v[212:215], v[48:63]
    v_mfma_f32_32x32x16_bf16 v[64:79], a[228:231], v[212:215], v[64:79]
    s_add_u32 m0, s70, 39936
    s_add_u32 s0, s73, 147456
    buffer_load_dwordx4 v5, s[8:11], s0 offen lds
    ds_read_b64_tr_b16 a[240:241], v12 offset:47104
    ds_read_b64_tr_b16 a[242:243], v12 offset:47360
    ds_read_b64_tr_b16 a[244:245], v12 offset:48128
    ds_read_b64_tr_b16 a[246:247], v12 offset:48384
    s_waitcnt lgkmcnt(14)
    v_mfma_f32_32x32x16_bf16 a[16:31], v[88:91], a[12:15], a[16:31]
    s_lshl2_add_u32 s0, s50, s48
    s_lshl3_add_u32 s0, s0, s49
    s_lshl_b32 s0, s0, 9
    buffer_load_dword a40, v125, s[12:15], s0 offen
    s_add_u32 s44, s77, 917504
    s_waitcnt lgkmcnt(6)
    v_mfma_f32_32x32x16_bf16 v[48:63], a[232:235], v[216:219], v[48:63]
    s_waitcnt lgkmcnt(4)
    v_mfma_f32_32x32x16_bf16 v[64:79], a[236:239], v[216:219], v[64:79]
    buffer_load_dword a41, v124, s[16:19], s77 offen
    s_waitcnt vmcnt(16)
    s_barrier
    ds_read_b64_tr_b16 a[224:225], v12 offset:49152
    ds_read_b64_tr_b16 a[226:227], v12 offset:49408
    ds_read_b64_tr_b16 a[228:229], v12 offset:50176
    ds_read_b64_tr_b16 a[230:231], v12 offset:50432
    s_waitcnt lgkmcnt(6)
    v_mfma_f32_32x32x16_bf16 v[48:63], a[240:243], v[220:223], v[48:63]
    s_waitcnt lgkmcnt(4)
    v_mfma_f32_32x32x16_bf16 v[64:79], a[244:247], v[220:223], v[64:79]
    buffer_load_dword a42, v124, s[20:23], s77 offen offset:1024
    ds_read_b64_tr_b16 a[232:233], v12 offset:51200
    ds_read_b64_tr_b16 a[234:235], v12 offset:51456
    ds_read_b64_tr_b16 a[236:237], v12 offset:52224
    ds_read_b64_tr_b16 a[238:239], v12 offset:52480
    ds_read_b64_tr_b16 a[0:1], v109 offset:49152
    ds_read_b64_tr_b16 a[2:3], v109 offset:49408
    ds_read_b64_tr_b16 a[4:5], v109 offset:51200
    ds_read_b64_tr_b16 a[6:7], v109 offset:51456
    v_xor_b32 v80, v121, v80
    v_accvgpr_write_b32 a248, v80
    v_xor_b32 v81, v121, v81
    v_accvgpr_write_b32 a249, v81
    v_xor_b32 v82, v121, v82
    v_accvgpr_write_b32 a250, v82
    v_xor_b32 v83, v121, v83
    v_accvgpr_write_b32 a251, v83
    v_xor_b32 v84, v121, v84
    v_accvgpr_write_b32 a252, v84
    v_xor_b32 v85, v121, v85
    v_accvgpr_write_b32 a253, v85
    v_xor_b32 v86, v121, v86
    v_accvgpr_write_b32 a254, v86
    v_xor_b32 v87, v121, v87
    v_accvgpr_write_b32 a255, v87
    v_dot2c_f32_bf16 v92, v224, v88
    v_dot2c_f32_bf16 v93, v224, v224
    v_dot2c_f32_bf16 v94, v225, v88
    v_dot2c_f32_bf16 v95, v225, v225
    v_dot2c_f32_bf16 v100, v226, v88
    v_dot2c_f32_bf16 v101, v226, v226
    v_dot2c_f32_bf16 v102, v227, v88
    v_dot2c_f32_bf16 v103, v227, v227
    v_dot2c_f32_bf16 v92, v228, v88
    v_dot2c_f32_bf16 v93, v228, v228
    v_dot2c_f32_bf16 v94, v229, v88
    v_dot2c_f32_bf16 v95, v229, v229
    v_dot2c_f32_bf16 v100, v230, v88
    v_dot2c_f32_bf16 v101, v230, v230
    v_dot2c_f32_bf16 v102, v231, v88
    v_dot2c_f32_bf16 v103, v231, v231
    v_dot2c_f32_bf16 v92, v232, v88
    v_dot2c_f32_bf16 v93, v232, v232
    v_dot2c_f32_bf16 v94, v233, v88
    v_dot2c_f32_bf16 v95, v233, v233
    v_dot2c_f32_bf16 v100, v234, v88
    v_dot2c_f32_bf16 v101, v234, v234
    v_dot2c_f32_bf16 v102, v235, v88
    v_dot2c_f32_bf16 v103, v235, v235
    v_dot2c_f32_bf16 v92, v236, v88
    v_dot2c_f32_bf16 v93, v236, v236
    v_dot2c_f32_bf16 v94, v237, v88
    v_dot2c_f32_bf16 v95, v237, v237
    v_dot2c_f32_bf16 v100, v238, v88
    v_dot2c_f32_bf16 v101, v238, v238
    v_dot2c_f32_bf16 v102, v239, v88
    v_dot2c_f32_bf16 v103, v239, v239
    s_waitcnt lgkmcnt(10)
    v_mfma_f32_32x32x16_bf16 v[48:63], a[224:227], v[224:227], v[48:63]
    s_waitcnt vmcnt(13)
    ds_read_b128 v[240:243], v116 offset:4096
    ds_read_b128 v[244:247], v117 offset:4096
    ds_read_b128 v[248:251], v118 offset:4096
    ds_read_b128 v[252:255], v119 offset:4096
    s_waitcnt lgkmcnt(12)
    v_mfma_f32_32x32x16_bf16 v[64:79], a[228:231], v[224:227], v[64:79]
    ds_read_b64_tr_b16 a[240:241], v12 offset:53248
    ds_read_b64_tr_b16 a[242:243], v12 offset:53504
    ds_read_b64_tr_b16 a[244:245], v12 offset:54272
    ds_read_b64_tr_b16 a[246:247], v12 offset:54528
    s_waitcnt lgkmcnt(10)
    v_mfma_f32_32x32x16_bf16 a[16:31], v[88:91], a[0:3], a[16:31]
    v_mfma_f32_32x32x16_bf16 v[48:63], a[232:235], v[228:231], v[48:63]
    v_mfma_f32_32x32x16_bf16 v[64:79], a[236:239], v[228:231], v[64:79]
    ds_read_b64_tr_b16 a[224:225], v12 offset:55296
    ds_read_b64_tr_b16 a[226:227], v12 offset:55552
    ds_read_b64_tr_b16 a[228:229], v12 offset:56320
    ds_read_b64_tr_b16 a[230:231], v12 offset:56576
    s_waitcnt lgkmcnt(12)
    v_mfma_f32_32x32x16_bf16 a[16:31], v[88:91], a[4:7], a[16:31]
    s_waitcnt lgkmcnt(6)
    v_mfma_f32_32x32x16_bf16 v[48:63], a[240:243], v[232:235], v[48:63]
    s_waitcnt lgkmcnt(4)
    v_mfma_f32_32x32x16_bf16 v[64:79], a[244:247], v[232:235], v[64:79]
    s_waitcnt vmcnt(11)
    s_barrier
    ds_read_b64_tr_b16 a[232:233], v12 offset:57344
    ds_read_b64_tr_b16 a[234:235], v12 offset:57600
    ds_read_b64_tr_b16 a[236:237], v12 offset:58368
    ds_read_b64_tr_b16 a[238:239], v12 offset:58624
    s_waitcnt lgkmcnt(6)
    v_mfma_f32_32x32x16_bf16 v[48:63], a[224:227], v[236:239], v[48:63]
    s_waitcnt lgkmcnt(4)
    v_mfma_f32_32x32x16_bf16 v[64:79], a[228:231], v[236:239], v[64:79]
    s_nop 0
    ds_read_b64_tr_b16 a[240:241], v12 offset:59392
    ds_read_b64_tr_b16 a[242:243], v12 offset:59648
    ds_read_b64_tr_b16 a[244:245], v12 offset:60416
    ds_read_b64_tr_b16 a[246:247], v12 offset:60672
    ds_read_b64_tr_b16 a[8:9], v109 offset:57344
    ds_read_b64_tr_b16 a[10:11], v109 offset:57600
    ds_read_b64_tr_b16 a[12:13], v109 offset:59392
    ds_read_b64_tr_b16 a[14:15], v109 offset:59648
    v_dot2c_f32_bf16 v92, v240, v88
    v_dot2c_f32_bf16 v93, v240, v240
    v_dot2c_f32_bf16 v94, v241, v88
    v_dot2c_f32_bf16 v95, v241, v241
    v_dot2c_f32_bf16 v100, v242, v88
    v_dot2c_f32_bf16 v101, v242, v242
    v_dot2c_f32_bf16 v102, v243, v88
    v_dot2c_f32_bf16 v103, v243, v243
    v_dot2c_f32_bf16 v92, v244, v88
    v_dot2c_f32_bf16 v93, v244, v244
    v_dot2c_f32_bf16 v94, v245, v88
    v_dot2c_f32_bf16 v95, v245, v245
    v_dot2c_f32_bf16 v100, v246, v88
    v_dot2c_f32_bf16 v101, v246, v246
    v_dot2c_f32_bf16 v102, v247, v88
    v_dot2c_f32_bf16 v103, v247, v247
    v_dot2c_f32_bf16 v92, v248, v88
    v_dot2c_f32_bf16 v93, v248, v248
    v_dot2c_f32_bf16 v94, v249, v88
    v_dot2c_f32_bf16 v95, v249, v249
    v_dot2c_f32_bf16 v100, v250, v88
    v_dot2c_f32_bf16 v101, v250, v250
    v_dot2c_f32_bf16 v102, v251, v88
    v_dot2c_f32_bf16 v103, v251, v251
    v_dot2c_f32_bf16 v92, v252, v88
    v_dot2c_f32_bf16 v93, v252, v252
    v_dot2c_f32_bf16 v94, v253, v88
    v_dot2c_f32_bf16 v95, v253, v253
    v_dot2c_f32_bf16 v100, v254, v88
    v_dot2c_f32_bf16 v101, v254, v254
    v_dot2c_f32_bf16 v102, v255, v88
    v_dot2c_f32_bf16 v103, v255, v255
    buffer_store_dwordx4 v[88:91], v1, s[32:35], s78 offen sc1
    s_waitcnt lgkmcnt(10)
    v_mfma_f32_32x32x16_bf16 v[48:63], a[232:235], v[240:243], v[48:63]
    s_waitcnt lgkmcnt(8)
    v_mfma_f32_32x32x16_bf16 v[64:79], a[236:239], v[240:243], v[64:79]
    ds_read_b64_tr_b16 a[224:225], v12 offset:61440
    ds_read_b64_tr_b16 a[226:227], v12 offset:61696
    buffer_store_dwordx4 v[88:91], v1, s[32:35], s78 offen offset:1024 sc1
    ds_read_b64_tr_b16 a[228:229], v12 offset:62464
    ds_read_b64_tr_b16 a[230:231], v12 offset:62720
    s_waitcnt lgkmcnt(6)
    v_mfma_f32_32x32x16_bf16 a[16:31], v[88:91], a[8:11], a[16:31]
    v_mfma_f32_32x32x16_bf16 v[48:63], a[240:243], v[244:247], v[48:63]
    buffer_store_dwordx4 v[88:91], v1, s[32:35], s82 offen sc1
    v_mfma_f32_32x32x16_bf16 v[64:79], a[244:247], v[244:247], v[64:79]
    ds_read_b64_tr_b16 a[232:233], v12 offset:63488
    ds_read_b64_tr_b16 a[234:235], v12 offset:63744
    ds_read_b64_tr_b16 a[236:237], v12 offset:64512
    ds_read_b64_tr_b16 a[238:239], v12 offset:64768
    s_waitcnt lgkmcnt(8)
    v_mfma_f32_32x32x16_bf16 a[16:31], v[88:91], a[12:15], a[16:31]
    buffer_store_dwordx4 v[88:91], v1, s[32:35], s82 offen offset:1024 sc1
    s_waitcnt lgkmcnt(6)
    v_mfma_f32_32x32x16_bf16 v[48:63], a[224:227], v[248:251], v[48:63]
    s_waitcnt lgkmcnt(4)
    v_mfma_f32_32x32x16_bf16 v[64:79], a[228:231], v[248:251], v[64:79]
    buffer_store_dwordx4 v[88:91], v19, s[32:35], s45 offen sc1
    s_waitcnt lgkmcnt(2)
    v_mfma_f32_32x32x16_bf16 v[48:63], a[232:235], v[252:255], v[48:63]
    s_waitcnt lgkmcnt(0)
    v_mfma_f32_32x32x16_bf16 v[64:79], a[236:239], v[252:255], v[64:79]
    s_lshl1_add_u32 s57, s49, s52
    s_lshl2_add_u32 s57, s57, s48
    s_lshl_b32 s3, s57, 9
    s_sub_u32 s58, s3, s71
    s_and_b32 s58, s58, 0x7fff
    s_lshl1_add_u32 s58, s58, 65536
    v_add_u32 v114, s58, v1
    ds_read_b128 v[80:83], v114
    v_accvgpr_read_b32 v112, a16
    s_and_b32 s57, s48, 1
    s_lshl_b32 s57, s57, 9
    s_lshr_b32 s58, s48, 1
    s_lshl3_add_u32 s57, s58, s57
    v_add_u32 v113, s57, v13
    v_cvt_pk_bf16_f32 v84, v112, v112
    v_and_b32 v85, 0xffff0000, v84
    v_sub_f32 v85, v112, v85
    v_cvt_pk_bf16_f32 v85, v85, v85
    ds_write_b64 v113, v[84:85]
    s_sub_u32 s58, s74, s69
    s_lshl1_add_u32 s57, s3, s58
    s_waitcnt lgkmcnt(1)
    buffer_store_dwordx4 v[80:83], v1, s[32:35], s57 offen sc1
    v_pk_add_f32 v[92:93], v[92:93], v[94:95]
    v_pk_add_f32 v[100:101], v[100:101], v[102:103]
    v_pk_add_f32 v[92:93], v[92:93], v[100:101]
    v_mov_b32 v94, v92
    v_mov_b32 v95, v93
    s_nop 0
    v_permlane32_swap_b32 v92, v94
    v_permlane32_swap_b32 v93, v95
    v_add_f32 v92, v92, v94
    v_add_f32_e64 v93, v93, v95
    v_mul_f32 v95, 0x3b000000, v92
    v_mul_f32 v93, 0x3b000000, v93
    v_mul_f32 v92, 0xba800000, v92
    v_fma_f32 v94, -v95, v95, v93
    v_cvt_pk_bf16_f32 v95, v92, v92
    v_max_f32 v94, 0, v94
    v_and_b32 v95, 0xffff0000, v95
    v_add_f32 v94, 0x3727c5ac, v94
    v_sub_f32 v95, v92, v95
    v_rsq_f32 v93, v94
    v_cvt_pk_bf16_f32 v120, v92, v95
    v_mov_b32 v121, v120
    v_mov_b32 v122, v120
    v_mov_b32 v123, v120
    v_mul_f32 v94, 0x3fb8aa3b, v93
    s_waitcnt lgkmcnt(0)
    s_barrier
    ds_read_b128 v[112:115], v13
    ds_read_b128 v[116:119], v13 offset:512
    s_waitcnt lgkmcnt(1)
    v_mfma_f32_32x32x16_bf16 v[48:63], v[112:115], v[120:123], v[48:63]
    s_waitcnt lgkmcnt(0)
    v_mfma_f32_32x32x16_bf16 v[64:79], v[116:119], v[120:123], v[64:79]
    s_nop 3
    s_nop 0
    v_cvt_pk_bf16_f32 v80, v48, v49
    v_cvt_pk_bf16_f32 v81, v50, v51
    v_cvt_pk_bf16_f32 v82, v52, v53
    v_cvt_pk_bf16_f32 v83, v54, v55
    v_cvt_pk_bf16_f32 v84, v56, v57
    v_cvt_pk_bf16_f32 v85, v58, v59
    v_cvt_pk_bf16_f32 v86, v60, v61
    v_cvt_pk_bf16_f32 v87, v62, v63
    v_mfma_f32_32x32x16_bf16 v[48:63], a[248:251], v[80:83], 0
    v_mul_f32 v64, v64, v93
    v_mul_f32 v65, v65, v93
    v_mul_f32 v66, v66, v93
    v_mul_f32 v67, v67, v93
    v_mul_f32 v68, v68, v93
    v_mul_f32 v69, v69, v93
    v_mfma_f32_32x32x16_bf16 v[96:111], a[252:255], v[84:87], 0
    v_mul_f32 v70, v70, v93
    v_mul_f32 v71, v71, v93
    v_mul_f32 v72, v72, v93
    v_mul_f32 v73, v73, v93
    v_mul_f32 v74, v74, v93
    v_mul_f32 v75, v75, v93
    v_mul_f32 v76, v76, v93
    v_mul_f32 v77, v77, v93
    v_mul_f32 v78, v78, v93
    v_mul_f32 v79, v79, v93
    v_cvt_pk_bf16_f32 v112, v64, v65
    v_cvt_pk_bf16_f32 v113, v66, v67
    v_cvt_pk_bf16_f32 v114, v68, v69
    v_cvt_pk_bf16_f32 v115, v70, v71
    v_cvt_pk_bf16_f32 v116, v72, v73
    v_cvt_pk_bf16_f32 v117, v74, v75
    v_cvt_pk_bf16_f32 v118, v76, v77
    v_cvt_pk_bf16_f32 v119, v78, v79
    ds_write_b128 v14, v[112:115]
    ds_write_b128 v14, v[116:119] offset:32
    v_max3_f32 v80, v48, v49, v50
    v_max3_f32 v81, v51, v52, v53
    v_max3_f32 v80, v80, v54, v55
    v_max3_f32 v81, v81, v56, v57
    v_max3_f32 v80, v80, v58, v59
    v_max3_f32 v81, v81, v60, v61
    v_max3_f32 v80, v80, v62, v63
    v_max_f32 v80, v80, v81
    v_mul_f32 v95, v94, v80
    v_pk_fma_f32 v[48:49], v[48:49], v[94:95], v[94:95] op_sel:[0,0,1] op_sel_hi:[1,0,1] neg_lo:[0,0,1] neg_hi:[0,0,1]
    v_pk_fma_f32 v[50:51], v[50:51], v[94:95], v[94:95] op_sel:[0,0,1] op_sel_hi:[1,0,1] neg_lo:[0,0,1] neg_hi:[0,0,1]
    v_pk_fma_f32 v[52:53], v[52:53], v[94:95], v[94:95] op_sel:[0,0,1] op_sel_hi:[1,0,1] neg_lo:[0,0,1] neg_hi:[0,0,1]
    s_load_dword s46, s[40:41], 0
    v_pk_fma_f32 v[54:55], v[54:55], v[94:95], v[94:95] op_sel:[0,0,1] op_sel_hi:[1,0,1] neg_lo:[0,0,1] neg_hi:[0,0,1]
    v_pk_fma_f32 v[56:57], v[56:57], v[94:95], v[94:95] op_sel:[0,0,1] op_sel_hi:[1,0,1] neg_lo:[0,0,1] neg_hi:[0,0,1]
    v_pk_fma_f32 v[58:59], v[58:59], v[94:95], v[94:95] op_sel:[0,0,1] op_sel_hi:[1,0,1] neg_lo:[0,0,1] neg_hi:[0,0,1]
    v_pk_fma_f32 v[60:61], v[60:61], v[94:95], v[94:95] op_sel:[0,0,1] op_sel_hi:[1,0,1] neg_lo:[0,0,1] neg_hi:[0,0,1]
    v_pk_fma_f32 v[62:63], v[62:63], v[94:95], v[94:95] op_sel:[0,0,1] op_sel_hi:[1,0,1] neg_lo:[0,0,1] neg_hi:[0,0,1]
    v_exp_f32 v48, v48
    v_exp_f32 v49, v49
    v_exp_f32 v50, v50
    v_exp_f32 v51, v51
    v_exp_f32 v52, v52
    v_exp_f32 v53, v53
    v_exp_f32 v54, v54
    v_exp_f32 v55, v55
    v_exp_f32 v56, v56
    v_exp_f32 v57, v57
    v_exp_f32 v58, v58
    v_exp_f32 v59, v59
    s_add_u32 m0, s70, 0
    s_add_u32 s0, s68, 0
    buffer_load_dwordx4 v6, s[12:15], s0 offen lds
    v_exp_f32 v60, v60
    v_exp_f32 v61, v61
    v_exp_f32 v62, v62
    v_exp_f32 v63, v63
    v_pk_add_f32 v[80:81], v[48:49], v[56:57]
    v_pk_add_f32 v[82:83], v[50:51], v[58:59]
    v_pk_add_f32 v[84:85], v[52:53], v[60:61]
    v_pk_add_f32 v[86:87], v[54:55], v[62:63]
    v_pk_add_f32 v[80:81], v[80:81], v[84:85]
    v_pk_add_f32 v[82:83], v[82:83], v[86:87]
    v_pk_add_f32 v[80:81], v[80:81], v[82:83]
    v_add_f32 v80, v80, v81
    v_rcp_f32_e64 v80, v80
    s_nop 0
    v_pk_mul_f32 v[48:49], v[48:49], v[80:81] op_sel_hi:[1,0]
    v_pk_mul_f32 v[50:51], v[50:51], v[80:81] op_sel_hi:[1,0]
    v_pk_mul_f32 v[52:53], v[52:53], v[80:81] op_sel_hi:[1,0]
    v_pk_mul_f32 v[54:55], v[54:55], v[80:81] op_sel_hi:[1,0]
    v_pk_mul_f32 v[56:57], v[56:57], v[80:81] op_sel_hi:[1,0]
    v_pk_mul_f32 v[58:59], v[58:59], v[80:81] op_sel_hi:[1,0]
    v_pk_mul_f32 v[60:61], v[60:61], v[80:81] op_sel_hi:[1,0]
    v_pk_mul_f32 v[62:63], v[62:63], v[80:81] op_sel_hi:[1,0]
    v_cvt_pk_bf16_f32 v64, v48, v49
    v_cvt_pk_bf16_f32 v65, v50, v51
    buffer_load_dwordx4 v10, s[12:15], s0 offen offset:1024 lds
    v_cvt_pk_bf16_f32 v66, v52, v53
    v_cvt_pk_bf16_f32 v67, v54, v55
    v_cvt_pk_bf16_f32 v68, v56, v57
    v_cvt_pk_bf16_f32 v69, v58, v59
    v_cvt_pk_bf16_f32 v70, v60, v61
    v_cvt_pk_bf16_f32 v71, v62, v63
    ds_write_b128 v15, v[64:67] offset:64
    ds_write_b128 v15, v[68:71] offset:80
    v_max3_f32 v80, v96, v97, v98
    v_max3_f32 v81, v99, v100, v101
    v_max3_f32 v80, v80, v102, v103
    v_max3_f32 v81, v81, v104, v105
    v_max3_f32 v80, v80, v106, v107
    v_max3_f32 v81, v81, v108, v109
    v_max3_f32 v80, v80, v110, v111
    v_max_f32 v80, v80, v81
    v_mul_f32 v95, v94, v80
    v_pk_fma_f32 v[96:97], v[96:97], v[94:95], v[94:95] op_sel:[0,0,1] op_sel_hi:[1,0,1] neg_lo:[0,0,1] neg_hi:[0,0,1]
    v_pk_fma_f32 v[98:99], v[98:99], v[94:95], v[94:95] op_sel:[0,0,1] op_sel_hi:[1,0,1] neg_lo:[0,0,1] neg_hi:[0,0,1]
    v_pk_fma_f32 v[100:101], v[100:101], v[94:95], v[94:95] op_sel:[0,0,1] op_sel_hi:[1,0,1] neg_lo:[0,0,1] neg_hi:[0,0,1]
    v_pk_fma_f32 v[102:103], v[102:103], v[94:95], v[94:95] op_sel:[0,0,1] op_sel_hi:[1,0,1] neg_lo:[0,0,1] neg_hi:[0,0,1]
    v_pk_fma_f32 v[104:105], v[104:105], v[94:95], v[94:95] op_sel:[0,0,1] op_sel_hi:[1,0,1] neg_lo:[0,0,1] neg_hi:[0,0,1]
    v_pk_fma_f32 v[106:107], v[106:107], v[94:95], v[94:95] op_sel:[0,0,1] op_sel_hi:[1,0,1] neg_lo:[0,0,1] neg_hi:[0,0,1]
    v_pk_fma_f32 v[108:109], v[108:109], v[94:95], v[94:95] op_sel:[0,0,1] op_sel_hi:[1,0,1] neg_lo:[0,0,1] neg_hi:[0,0,1]
    v_pk_fma_f32 v[110:111], v[110:111], v[94:95], v[94:95] op_sel:[0,0,1] op_sel_hi:[1,0,1] neg_lo:[0,0,1] neg_hi:[0,0,1]
    v_exp_f32 v96, v96
    v_exp_f32 v97, v97
    s_add_u32 m0, s70, 2048
    s_add_u32 s0, s68, 16384
    buffer_load_dwordx4 v6, s[12:15], s0 offen lds
    v_exp_f32 v98, v98
    v_exp_f32 v99, v99
    v_exp_f32 v100, v100
    v_exp_f32 v101, v101
    v_exp_f32 v102, v102
    v_exp_f32 v103, v103
    v_exp_f32 v104, v104
    v_exp_f32 v105, v105
    v_exp_f32 v106, v106
    v_exp_f32 v107, v107
    v_exp_f32 v108, v108
    v_exp_f32 v109, v109
    v_exp_f32 v110, v110
    v_exp_f32 v111, v111
    buffer_load_dwordx4 v10, s[12:15], s0 offen offset:1024 lds
    v_pk_add_f32 v[80:81], v[96:97], v[104:105]
    v_pk_add_f32 v[82:83], v[98:99], v[106:107]
    v_pk_add_f32 v[84:85], v[100:101], v[108:109]
    v_pk_add_f32 v[86:87], v[102:103], v[110:111]
    v_pk_add_f32 v[80:81], v[80:81], v[84:85]
    v_pk_add_f32 v[82:83], v[82:83], v[86:87]
    v_pk_add_f32 v[80:81], v[80:81], v[82:83]
    v_add_f32 v80, v80, v81
    v_rcp_f32_e64 v80, v80
    s_nop 0
    v_pk_mul_f32 v[96:97], v[96:97], v[80:81] op_sel_hi:[1,0]
    v_pk_mul_f32 v[98:99], v[98:99], v[80:81] op_sel_hi:[1,0]
    v_pk_mul_f32 v[100:101], v[100:101], v[80:81] op_sel_hi:[1,0]
    v_pk_mul_f32 v[102:103], v[102:103], v[80:81] op_sel_hi:[1,0]
    v_pk_mul_f32 v[104:105], v[104:105], v[80:81] op_sel_hi:[1,0]
    v_pk_mul_f32 v[106:107], v[106:107], v[80:81] op_sel_hi:[1,0]
    v_pk_mul_f32 v[108:109], v[108:109], v[80:81] op_sel_hi:[1,0]
    v_pk_mul_f32 v[110:111], v[110:111], v[80:81] op_sel_hi:[1,0]
    v_cvt_pk_bf16_f32 v72, v96, v97
    v_cvt_pk_bf16_f32 v73, v98, v99
    v_cvt_pk_bf16_f32 v74, v100, v101
    v_cvt_pk_bf16_f32 v75, v102, v103
    v_cvt_pk_bf16_f32 v76, v104, v105
    v_cvt_pk_bf16_f32 v77, v106, v107
    v_cvt_pk_bf16_f32 v78, v108, v109
    v_cvt_pk_bf16_f32 v79, v110, v111
    ds_write_b128 v15, v[72:75] offset:128
    ds_write_b128 v15, v[76:79] offset:144
    s_waitcnt lgkmcnt(0)
    s_barrier
    ds_read_b64_tr_b16 v[52:53], v17 offset:0
    ds_read_b64_tr_b16 v[54:55], v17 offset:832
    ds_read_b64_tr_b16 v[48:49], v16 offset:0
    ds_read_b64_tr_b16 v[50:51], v16 offset:832
    ds_read_b64_tr_b16 v[60:61], v17 offset:6656
    ds_read_b64_tr_b16 v[62:63], v17 offset:7488
    ds_read_b64_tr_b16 v[56:57], v16 offset:6656
    ds_read_b64_tr_b16 v[58:59], v16 offset:7488
    ds_read_b64_tr_b16 v[68:69], v17 offset:13312
    ds_read_b64_tr_b16 v[70:71], v17 offset:14144
    ds_read_b64_tr_b16 v[64:65], v16 offset:13312
    ds_read_b64_tr_b16 v[66:67], v16 offset:14144
    ds_read_b64_tr_b16 v[76:77], v17 offset:19968
    ds_read_b64_tr_b16 v[78:79], v17 offset:20800
    ds_read_b64_tr_b16 v[72:73], v16 offset:19968
    ds_read_b64_tr_b16 v[74:75], v16 offset:20800
    s_add_u32 m0, s70, 4096
    s_add_u32 s0, s68, 32768
    buffer_load_dwordx4 v6, s[12:15], s0 offen lds
    buffer_load_dwordx4 v10, s[12:15], s0 offen offset:1024 lds
    s_add_u32 m0, s70, 6144
    s_add_u32 s0, s68, 49152
    buffer_load_dwordx4 v6, s[12:15], s0 offen lds
    buffer_load_dwordx4 v10, s[12:15], s0 offen offset:1024 lds
    s_mov_b32 s100, 0x80008000
    s_mov_b32 s101, 0x80008000
    s_mov_b32 vcc_lo, 0x11111111
    s_mov_b32 vcc_hi, 0x11111111
    s_waitcnt lgkmcnt(14)
    v_mfma_f32_16x16x32_bf16 v[84:87], v[52:55], v[88:91], 0
    s_waitcnt lgkmcnt(12)
    v_mfma_f32_16x16x32_bf16 v[80:83], v[52:55], v[48:51], 0
    s_waitcnt lgkmcnt(10)
    v_mfma_f32_16x16x32_bf16 v[84:87], v[60:63], v[88:91], v[84:87]
    s_waitcnt lgkmcnt(8)
    v_mfma_f32_16x16x32_bf16 v[80:83], v[60:63], v[56:59], v[80:83]
    s_waitcnt lgkmcnt(6)
    v_mfma_f32_16x16x32_bf16 v[84:87], v[68:71], v[88:91], v[84:87]
    s_waitcnt lgkmcnt(4)
    v_mfma_f32_16x16x32_bf16 v[80:83], v[68:71], v[64:67], v[80:83]
    s_waitcnt lgkmcnt(2)
    v_mfma_f32_16x16x32_bf16 v[84:87], v[76:79], v[88:91], v[84:87]
    s_waitcnt lgkmcnt(0)
    v_mfma_f32_16x16x32_bf16 v[80:83], v[76:79], v[72:75], v[80:83]
    s_nop 3
    v_mov_b32_dpp v84, v85 quad_perm:[0,1,2,3] row_mask:0xf bank_mask:2
    v_mov_b32_dpp v84, v86 quad_perm:[0,1,2,3] row_mask:0xf bank_mask:4
    v_mov_b32_dpp v84, v87 quad_perm:[0,1,2,3] row_mask:0xf bank_mask:8
    s_nop 0
    v_mov_b32_dpp v85, v80 row_ror:1 row_mask:0xf bank_mask:1
    v_mov_b32_dpp v85, v81 row_ror:5 row_mask:0xf bank_mask:2
    v_mov_b32_dpp v85, v82 row_ror:9 row_mask:0xf bank_mask:4
    v_mov_b32_dpp v85, v83 row_ror:13 row_mask:0xf bank_mask:8
    v_cndmask_b32 v84, v84, v85, vcc
    s_mov_b64 exec, s[100:101]
    v_mov_b32 v80, 0x3e800000
    v_mov_b32 v81, 0x3e800000
    v_mov_b32 v82, 0x3e800000
    v_mov_b32 v83, 0x3e800000
    v_mov_b32 v84, 0x3e800000
    s_mov_b64 exec, -1
    s_cmp_ge_u32 s46, 24
    s_cbranch_scc1 L_done1
    v_mov_b32 v87, 0
L_poll2:
    buffer_load_dword v86, v87, s[40:43], 0 offen offset:0 sc1
    s_waitcnt vmcnt(0)
    v_cmp_gt_u32 vcc, 24, v86
    s_nop 1
    s_cbranch_vccz L_done1
    s_sub_u32 s56, s56, 1
    s_cbranch_scc0 L_poll2
    s_mov_b32 s56, 0
L_done1:
    buffer_atomic_add_f32 v80, v18, s[32:35], s95 offen offset:0
    buffer_atomic_add_f32 v81, v18, s[32:35], s95 offen offset:256
    buffer_atomic_add_f32 v82, v18, s[32:35], s95 offen offset:512
    buffer_atomic_add_f32 v83, v18, s[32:35], s95 offen offset:768
    buffer_atomic_add_f32 v84, v18, s[32:35], s95 offen offset:1024
    v_mov_b32 v85, s64
    s_cmp_eq_u32 s48, 0
    s_cselect_b32 s57, s62, 117440512
    s_add_u32 s57, s57, 7680
    buffer_atomic_add v85, v28, s[32:35], s57 offen
    s_lshl2_add_u32 s0, s54, s48
    s_min_u32 s0, s0, 12
    s_lshl_b32 s0, s0, 9
    s_add_u32 s0, s0, s62
    buffer_load_dword v125, v125, s[32:35], s0 offen sc1
    buffer_load_dword a43, v124, s[16:19], s44 offen
    buffer_load_dword a44, v124, s[20:23], s44 offen offset:1024
    s_cmp_ge_u32 s50, 28
    s_cselect_b32 s38, 0, s38
    s_cmp_ge_u32 s53, 28
    s_cselect_b32 s18, 0, s18
    s_cselect_b32 s22, 0, s22
    buffer_load_dword a45, v124, s[24:27], s77 offen
    buffer_load_dword a46, v124, s[24:27], s44 offen
    s_waitcnt vmcnt(28)
    s_barrier
    s_sub_u32 s57, s3, s71
    s_and_b32 s57, s57, 0x7fff
    s_add_u32 s57, s57, 32768
    v_lshlrev_b32 v112, 3, v9
    v_add_u32 v113, s57, v112
    ds_read_b64 v[114:115], v113
    s_sub_u32 s58, s74, s69
    s_add_u32 s58, s58, s3
    s_nop 0
    s_add_u32 s58, s58, 65536
    ds_read_b64_tr_b16 a[224:225], v20 offset:0
    ds_read_b64_tr_b16 a[226:227], v20 offset:256
    ds_read_b64_tr_b16 a[228:229], v20 offset:1024
    ds_read_b64_tr_b16 a[230:231], v20 offset:1280
    ds_read_b64_tr_b16 a[232:233], v20 offset:2048
    ds_read_b64_tr_b16 a[234:235], v20 offset:2304
    ds_read_b64_tr_b16 a[236:237], v20 offset:3072
    ds_read_b64_tr_b16 a[238:239], v20 offset:3328
    s_waitcnt lgkmcnt(8)
    buffer_store_dwordx2 v[114:115], v112, s[32:35], s58 offen sc1
    s_add_u32 m0, s70, 98304
    s_add_u32 s0, s68, 131072
    buffer_load_dwordx4 v6, s[12:15], s0 offen lds
    s_waitcnt lgkmcnt(6)
    v_mfma_f32_32x32x16_bf16 v[48:63], a[224:227], v[128:131], 0
    v_mfma_f32_32x32x16_bf16 v[64:79], v[88:91], a[224:227], 0
    ds_read_b64_tr_b16 a[240:241], v20 offset:4096
    ds_read_b64_tr_b16 a[242:243], v20 offset:4352
    s_waitcnt lgkmcnt(6)
    v_mfma_f32_32x32x16_bf16 v[48:63], a[228:231], v[132:135], v[48:63]
    v_mfma_f32_32x32x16_bf16 v[64:79], v[88:91], a[228:231], v[64:79]
    ds_read_b64_tr_b16 a[244:245], v20 offset:5120
    ds_read_b64_tr_b16 a[246:247], v20 offset:5376
    s_waitcnt lgkmcnt(6)
    v_mfma_f32_32x32x16_bf16 v[48:63], a[232:235], v[136:139], v[48:63]
    buffer_load_dwordx4 v10, s[12:15], s0 offen offset:1024 lds
    v_mfma_f32_32x32x16_bf16 v[64:79], v[88:91], a[232:235], v[64:79]
    ds_read_b64_tr_b16 a[224:225], v20 offset:6144
    ds_read_b64_tr_b16 a[226:227], v20 offset:6400
    s_waitcnt lgkmcnt(6)
    v_mfma_f32_32x32x16_bf16 v[48:63], a[236:239], v[140:143], v[48:63]
    v_mfma_f32_32x32x16_bf16 v[64:79], v[88:91], a[236:239], v[64:79]
    ds_read_b64_tr_b16 a[228:229], v20 offset:7168
    ds_read_b64_tr_b16 a[230:231], v20 offset:7424
    s_waitcnt lgkmcnt(6)
    v_mfma_f32_32x32x16_bf16 v[48:63], a[240:243], v[144:147], v[48:63]
    s_add_u32 m0, s70, 100352
    s_add_u32 s0, s68, 147456
    buffer_load_dwordx4 v6, s[12:15], s0 offen lds
    v_mfma_f32_32x32x16_bf16 v[64:79], v[88:91], a[240:243], v[64:79]
    ds_read_b64_tr_b16 a[232:233], v20 offset:8192
    ds_read_b64_tr_b16 a[234:235], v20 offset:8448
    s_waitcnt lgkmcnt(6)
    v_mfma_f32_32x32x16_bf16 v[48:63], a[244:247], v[148:151], v[48:63]
    v_mfma_f32_32x32x16_bf16 v[64:79], v[88:91], a[244:247], v[64:79]
    ds_read_b64_tr_b16 a[236:237], v20 offset:9216
    ds_read_b64_tr_b16 a[238:239], v20 offset:9472
    s_waitcnt lgkmcnt(6)
    v_mfma_f32_32x32x16_bf16 v[48:63], a[224:227], v[152:155], v[48:63]
    buffer_load_dwordx4 v10, s[12:15], s0 offen offset:1024 lds
    v_mfma_f32_32x32x16_bf16 v[64:79], v[88:91], a[224:227], v[64:79]
    ds_read_b64_tr_b16 a[240:241], v20 offset:10240
    ds_read_b64_tr_b16 a[242:243], v20 offset:10496
    s_waitcnt lgkmcnt(6)
    v_mfma_f32_32x32x16_bf16 v[48:63], a[228:231], v[156:159], v[48:63]
    v_mfma_f32_32x32x16_bf16 v[64:79], v[88:91], a[228:231], v[64:79]
    ds_read_b64_tr_b16 a[244:245], v20 offset:11264
    ds_read_b64_tr_b16 a[246:247], v20 offset:11520
    s_waitcnt lgkmcnt(6)
    v_mfma_f32_32x32x16_bf16 v[48:63], a[232:235], v[160:163], v[48:63]
    s_add_u32 m0, s70, 102400
    s_add_u32 s0, s68, 163840
    buffer_load_dwordx4 v6, s[12:15], s0 offen lds
    v_mfma_f32_32x32x16_bf16 v[64:79], v[88:91], a[232:235], v[64:79]
    ds_read_b64_tr_b16 a[224:225], v20 offset:12288
    ds_read_b64_tr_b16 a[226:227], v20 offset:12544
    s_waitcnt lgkmcnt(6)
    v_mfma_f32_32x32x16_bf16 v[48:63], a[236:239], v[164:167], v[48:63]
    v_mfma_f32_32x32x16_bf16 v[64:79], v[88:91], a[236:239], v[64:79]
    ds_read_b64_tr_b16 a[228:229], v20 offset:13312
    ds_read_b64_tr_b16 a[230:231], v20 offset:13568
    s_waitcnt lgkmcnt(6)
    v_mfma_f32_32x32x16_bf16 v[48:63], a[240:243], v[168:171], v[48:63]
    v_mfma_f32_32x32x16_bf16 v[64:79], v[88:91], a[240:243], v[64:79]
    buffer_load_dwordx4 v10, s[12:15], s0 offen offset:1024 lds
    ds_read_b64_tr_b16 a[232:233], v20 offset:14336
    ds_read_b64_tr_b16 a[234:235], v20 offset:14592
    s_waitcnt lgkmcnt(6)
    v_mfma_f32_32x32x16_bf16 v[48:63], a[244:247], v[172:175], v[48:63]
    v_mfma_f32_32x32x16_bf16 v[64:79], v[88:91], a[244:247], v[64:79]
    ds_read_b64_tr_b16 a[236:237], v20 offset:15360
    ds_read_b64_tr_b16 a[238:239], v20 offset:15616
    s_waitcnt lgkmcnt(6)
    v_mfma_f32_32x32x16_bf16 v[48:63], a[224:227], v[176:179], v[48:63]
    v_mfma_f32_32x32x16_bf16 v[64:79], v[88:91], a[224:227], v[64:79]
    s_add_u32 m0, s70, 104448
    s_add_u32 s0, s68, 180224
    buffer_load_dwordx4 v6, s[12:15], s0 offen lds
    ds_read_b64_tr_b16 a[240:241], v20 offset:16384
    ds_read_b64_tr_b16 a[242:243], v20 offset:16640
    s_waitcnt lgkmcnt(6)
    v_mfma_f32_32x32x16_bf16 v[48:63], a[228:231], v[180:183], v[48:63]
    v_mfma_f32_32x32x16_bf16 v[64:79], v[88:91], a[228:231], v[64:79]
    ds_read_b64_tr_b16 a[244:245], v20 offset:17408
    ds_read_b64_tr_b16 a[246:247], v20 offset:17664
    s_waitcnt lgkmcnt(6)
    v_mfma_f32_32x32x16_bf16 v[48:63], a[232:235], v[184:187], v[48:63]
    v_mfma_f32_32x32x16_bf16 v[64:79], v[88:91], a[232:235], v[64:79]
    buffer_load_dwordx4 v10, s[12:15], s0 offen offset:1024 lds
    ds_read_b64_tr_b16 a[224:225], v20 offset:18432
    ds_read_b64_tr_b16 a[226:227], v20 offset:18688
    s_waitcnt lgkmcnt(6)
    v_mfma_f32_32x32x16_bf16 v[48:63], a[236:239], v[188:191], v[48:63]
    v_mfma_f32_32x32x16_bf16 v[64:79], v[88:91], a[236:239], v[64:79]
    ds_read_b64_tr_b16 a[228:229], v20 offset:19456
    ds_read_b64_tr_b16 a[230:231], v20 offset:19712
    s_waitcnt lgkmcnt(6)
    v_mfma_f32_32x32x16_bf16 v[48:63], a[240:243], v[192:195], v[48:63]
    v_mfma_f32_32x32x16_bf16 v[64:79], v[88:91], a[240:243], v[64:79]
    s_add_u32 m0, s69, 65536
    s_add_u32 s0, s66, 0
    buffer_load_dwordx4 v7, s[16:19], s0 offen lds
    ds_read_b64_tr_b16 a[232:233], v20 offset:20480
    ds_read_b64_tr_b16 a[234:235], v20 offset:20736
    s_waitcnt lgkmcnt(6)
    v_mfma_f32_32x32x16_bf16 v[48:63], a[244:247], v[196:199], v[48:63]
    v_mfma_f32_32x32x16_bf16 v[64:79], v[88:91], a[244:247], v[64:79]
    ds_read_b64_tr_b16 a[236:237], v20 offset:21504
    ds_read_b64_tr_b16 a[238:239], v20 offset:21760
    s_waitcnt lgkmcnt(6)
    v_mfma_f32_32x32x16_bf16 v[48:63], a[224:227], v[200:203], v[48:63]
    v_mfma_f32_32x32x16_bf16 v[64:79], v[88:91], a[224:227], v[64:79]
    ds_read_b64_tr_b16 a[240:241], v20 offset:22528
    buffer_load_dwordx4 v11, s[20:23], s0 offen offset:1024 lds
    ds_read_b64_tr_b16 a[242:243], v20 offset:22784
    s_waitcnt lgkmcnt(6)
    v_mfma_f32_32x32x16_bf16 v[48:63], a[228:231], v[204:207], v[48:63]
    v_mfma_f32_32x32x16_bf16 v[64:79], v[88:91], a[228:231], v[64:79]
    ds_read_b64_tr_b16 a[244:245], v20 offset:23552
    ds_read_b64_tr_b16 a[246:247], v20 offset:23808
    s_waitcnt lgkmcnt(6)
    v_mfma_f32_32x32x16_bf16 v[48:63], a[232:235], v[208:211], v[48:63]
    v_mfma_f32_32x32x16_bf16 v[64:79], v[88:91], a[232:235], v[64:79]
    ds_read_b64_tr_b16 a[224:225], v20 offset:24576
    ds_read_b64_tr_b16 a[226:227], v20 offset:24832
    s_waitcnt lgkmcnt(6)
    v_mfma_f32_32x32x16_bf16 v[48:63], a[236:239], v[212:215], v[48:63]
    s_add_u32 m0, s69, 73728
    s_add_u32 s0, s66, 114688
    buffer_load_dwordx4 v7, s[16:19], s0 offen lds
    v_mfma_f32_32x32x16_bf16 v[64:79], v[88:91], a[236:239], v[64:79]
    ds_read_b64_tr_b16 a[228:229], v20 offset:25600
    ds_read_b64_tr_b16 a[230:231], v20 offset:25856
    s_waitcnt lgkmcnt(6)
    v_mfma_f32_32x32x16_bf16 v[48:63], a[240:243], v[216:219], v[48:63]
    v_mfma_f32_32x32x16_bf16 v[64:79], v[88:91], a[240:243], v[64:79]
    ds_read_b64_tr_b16 a[232:233], v20 offset:26624
    ds_read_b64_tr_b16 a[234:235], v20 offset:26880
    s_waitcnt lgkmcnt(6)
    v_mfma_f32_32x32x16_bf16 v[48:63], a[244:247], v[220:223], v[48:63]
    buffer_load_dwordx4 v11, s[20:23], s0 offen offset:1024 lds
    v_mfma_f32_32x32x16_bf16 v[64:79], v[88:91], a[244:247], v[64:79]
    ds_read_b64_tr_b16 a[236:237], v20 offset:27648
    ds_read_b64_tr_b16 a[238:239], v20 offset:27904
    s_waitcnt lgkmcnt(6)
    v_mfma_f32_32x32x16_bf16 v[48:63], a[224:227], v[224:227], v[48:63]
    v_mfma_f32_32x32x16_bf16 v[64:79], v[88:91], a[224:227], v[64:79]
    ds_read_b64_tr_b16 a[240:241], v20 offset:28672
    ds_read_b64_tr_b16 a[242:243], v20 offset:28928
    s_waitcnt lgkmcnt(6)
    v_mfma_f32_32x32x16_bf16 v[48:63], a[228:231], v[228:231], v[48:63]
    s_add_u32 m0, s69, 81920
    s_add_u32 s0, s66, 229376
    buffer_load_dwordx4 v7, s[16:19], s0 offen lds
    v_mfma_f32_32x32x16_bf16 v[64:79], v[88:91], a[228:231], v[64:79]
    ds_read_b64_tr_b16 a[244:245], v20 offset:29696
    ds_read_b64_tr_b16 a[246:247], v20 offset:29952
    s_waitcnt lgkmcnt(6)
    v_mfma_f32_32x32x16_bf16 v[48:63], a[232:235], v[232:235], v[48:63]
    v_mfma_f32_32x32x16_bf16 v[64:79], v[88:91], a[232:235], v[64:79]
    ds_read_b64_tr_b16 a[224:225], v20 offset:30720
    ds_read_b64_tr_b16 a[226:227], v20 offset:30976
    s_waitcnt lgkmcnt(6)
    v_mfma_f32_32x32x16_bf16 v[48:63], a[236:239], v[236:239], v[48:63]
    buffer_load_dwordx4 v11, s[20:23], s0 offen offset:1024 lds
    v_mfma_f32_32x32x16_bf16 v[64:79], v[88:91], a[236:239], v[64:79]
    ds_read_b64_tr_b16 a[228:229], v20 offset:31744
    ds_read_b64_tr_b16 a[230:231], v20 offset:32000
    s_waitcnt lgkmcnt(6)
    v_mfma_f32_32x32x16_bf16 v[48:63], a[240:243], v[240:243], v[48:63]
    v_mfma_f32_32x32x16_bf16 v[64:79], v[88:91], a[240:243], v[64:79]
    s_waitcnt lgkmcnt(4)
    v_mfma_f32_32x32x16_bf16 v[48:63], a[244:247], v[244:247], v[48:63]
    v_mfma_f32_32x32x16_bf16 v[64:79], v[88:91], a[244:247], v[64:79]
    buffer_load_dword v117, v0, s[32:35], 0 offen sc1
    s_waitcnt lgkmcnt(2)
    v_mfma_f32_32x32x16_bf16 v[48:63], a[224:227], v[248:251], v[48:63]
    v_mfma_f32_32x32x16_bf16 v[64:79], v[88:91], a[224:227], v[64:79]
    s_waitcnt lgkmcnt(0)
    v_mfma_f32_32x32x16_bf16 v[48:63], a[228:231], v[252:255], v[48:63]
    v_mfma_f32_32x32x16_bf16 v[64:79], v[88:91], a[228:231], v[64:79]
    s_add_u32 s59, s62, 7680
    v_mov_b32 v112, 0
    buffer_load_dword v113, v112, s[32:35], s59 offen offset:0 sc1
    s_nop 8
    v_mov_b32 v5, v64
    v_mov_b32 v82, 0
    v_mov_b32 v83, 0
    v_cvt_pk_bf16_f32 v80, v64, v64
    v_and_b32 v81, 0xffff0000, v80
    v_sub_f32 v81, v64, v81
    v_cvt_pk_bf16_f32 v81, v81, v81
    s_nop 1
    v_mfma_f32_32x32x16_bf16 v[48:63], v[80:83], v[120:123], v[48:63]
    s_nop 11
    v_cvt_pk_bf16_f32 v80, v48, v49
    v_cvt_pk_bf16_f32 v81, v50, v51
    v_cvt_pk_bf16_f32 v82, v52, v53
    v_cvt_pk_bf16_f32 v83, v54, v55
    v_cvt_pk_bf16_f32 v84, v56, v57
    v_cvt_pk_bf16_f32 v85, v58, v59
    v_cvt_pk_bf16_f32 v86, v60, v61
    v_cvt_pk_bf16_f32 v87, v62, v63
    v_mfma_f32_32x32x16_bf16 v[48:63], a[248:251], v[80:83], 0
    s_nop 0
    v_mfma_f32_32x32x16_bf16 v[64:79], a[252:255], v[84:87], 0
    s_nop 3
    v_max3_f32 v80, v48, v49, v50
    v_max3_f32 v81, v51, v52, v53
    v_max3_f32 v80, v80, v54, v55
    v_max3_f32 v81, v81, v56, v57
    v_max3_f32 v80, v80, v58, v59
    v_max3_f32 v81, v81, v60, v61
    v_max3_f32 v80, v80, v62, v63
    v_max_f32 v80, v80, v81
    v_mul_f32 v95, v94, v80
    v_pk_fma_f32 v[48:49], v[48:49], v[94:95], v[94:95] op_sel:[0,0,1] op_sel_hi:[1,0,1] neg_lo:[0,0,1] neg_hi:[0,0,1]
    v_pk_fma_f32 v[50:51], v[50:51], v[94:95], v[94:95] op_sel:[0,0,1] op_sel_hi:[1,0,1] neg_lo:[0,0,1] neg_hi:[0,0,1]
    v_pk_fma_f32 v[52:53], v[52:53], v[94:95], v[94:95] op_sel:[0,0,1] op_sel_hi:[1,0,1] neg_lo:[0,0,1] neg_hi:[0,0,1]
    v_pk_fma_f32 v[54:55], v[54:55], v[94:95], v[94:95] op_sel:[0,0,1] op_sel_hi:[1,0,1] neg_lo:[0,0,1] neg_hi:[0,0,1]
    v_pk_fma_f32 v[56:57], v[56:57], v[94:95], v[94:95] op_sel:[0,0,1] op_sel_hi:[1,0,1] neg_lo:[0,0,1] neg_hi:[0,0,1]
    v_pk_fma_f32 v[58:59], v[58:59], v[94:95], v[94:95] op_sel:[0,0,1] op_sel_hi:[1,0,1] neg_lo:[0,0,1] neg_hi:[0,0,1]
    v_pk_fma_f32 v[60:61], v[60:61], v[94:95], v[94:95] op_sel:[0,0,1] op_sel_hi:[1,0,1] neg_lo:[0,0,1] neg_hi:[0,0,1]
    v_pk_fma_f32 v[62:63], v[62:63], v[94:95], v[94:95] op_sel:[0,0,1] op_sel_hi:[1,0,1] neg_lo:[0,0,1] neg_hi:[0,0,1]
    v_exp_f32 v48, v48
    v_exp_f32 v49, v49
    v_exp_f32 v50, v50
    v_exp_f32 v51, v51
    v_exp_f32 v52, v52
    v_exp_f32 v53, v53
    v_exp_f32 v54, v54
    v_exp_f32 v55, v55
    v_exp_f32 v56, v56
    v_exp_f32 v57, v57
    v_exp_f32 v58, v58
    v_exp_f32 v59, v59
    v_exp_f32 v60, v60
    v_exp_f32 v61, v61
    v_exp_f32 v62, v62
    v_exp_f32 v63, v63
    v_pk_add_f32 v[80:81], v[48:49], v[56:57]
    v_pk_add_f32 v[82:83], v[50:51], v[58:59]
    v_pk_add_f32 v[84:85], v[52:53], v[60:61]
    v_pk_add_f32 v[86:87], v[54:55], v[62:63]
    v_pk_add_f32 v[80:81], v[80:81], v[84:85]
    v_pk_add_f32 v[82:83], v[82:83], v[86:87]
    v_pk_add_f32 v[80:81], v[80:81], v[82:83]
    v_add_f32 v80, v80, v81
    v_rcp_f32_e64 v80, v80
    s_nop 0
    v_pk_mul_f32 v[48:49], v[48:49], v[80:81] op_sel_hi:[1,0]
    v_pk_mul_f32 v[50:51], v[50:51], v[80:81] op_sel_hi:[1,0]
    v_pk_mul_f32 v[52:53], v[52:53], v[80:81] op_sel_hi:[1,0]
    v_pk_mul_f32 v[54:55], v[54:55], v[80:81] op_sel_hi:[1,0]
    v_pk_mul_f32 v[56:57], v[56:57], v[80:81] op_sel_hi:[1,0]
    v_pk_mul_f32 v[58:59], v[58:59], v[80:81] op_sel_hi:[1,0]
    v_pk_mul_f32 v[60:61], v[60:61], v[80:81] op_sel_hi:[1,0]
    v_pk_mul_f32 v[62:63], v[62:63], v[80:81] op_sel_hi:[1,0]
    v_cvt_pk_bf16_f32 v96, v48, v49
    v_cvt_pk_bf16_f32 v97, v50, v51
    v_cvt_pk_bf16_f32 v98, v52, v53
    v_cvt_pk_bf16_f32 v99, v54, v55
    v_cvt_pk_bf16_f32 v100, v56, v57
    v_cvt_pk_bf16_f32 v101, v58, v59
    v_cvt_pk_bf16_f32 v102, v60, v61
    v_cvt_pk_bf16_f32 v103, v62, v63
    v_max3_f32 v80, v64, v65, v66
    v_max3_f32 v81, v67, v68, v69
    v_max3_f32 v80, v80, v70, v71
    v_max3_f32 v81, v81, v72, v73
    v_max3_f32 v80, v80, v74, v75
    v_max3_f32 v81, v81, v76, v77
    v_max3_f32 v80, v80, v78, v79
    v_max_f32 v80, v80, v81
    v_mul_f32 v95, v94, v80
    v_pk_fma_f32 v[64:65], v[64:65], v[94:95], v[94:95] op_sel:[0,0,1] op_sel_hi:[1,0,1] neg_lo:[0,0,1] neg_hi:[0,0,1]
    v_pk_fma_f32 v[66:67], v[66:67], v[94:95], v[94:95] op_sel:[0,0,1] op_sel_hi:[1,0,1] neg_lo:[0,0,1] neg_hi:[0,0,1]
    v_pk_fma_f32 v[68:69], v[68:69], v[94:95], v[94:95] op_sel:[0,0,1] op_sel_hi:[1,0,1] neg_lo:[0,0,1] neg_hi:[0,0,1]
    v_pk_fma_f32 v[70:71], v[70:71], v[94:95], v[94:95] op_sel:[0,0,1] op_sel_hi:[1,0,1] neg_lo:[0,0,1] neg_hi:[0,0,1]
    v_pk_fma_f32 v[72:73], v[72:73], v[94:95], v[94:95] op_sel:[0,0,1] op_sel_hi:[1,0,1] neg_lo:[0,0,1] neg_hi:[0,0,1]
    v_pk_fma_f32 v[74:75], v[74:75], v[94:95], v[94:95] op_sel:[0,0,1] op_sel_hi:[1,0,1] neg_lo:[0,0,1] neg_hi:[0,0,1]
    v_pk_fma_f32 v[76:77], v[76:77], v[94:95], v[94:95] op_sel:[0,0,1] op_sel_hi:[1,0,1] neg_lo:[0,0,1] neg_hi:[0,0,1]
    v_pk_fma_f32 v[78:79], v[78:79], v[94:95], v[94:95] op_sel:[0,0,1] op_sel_hi:[1,0,1] neg_lo:[0,0,1] neg_hi:[0,0,1]
    v_exp_f32 v64, v64
    v_exp_f32 v65, v65
    v_exp_f32 v66, v66
    v_exp_f32 v67, v67
    v_exp_f32 v68, v68
    v_exp_f32 v69, v69
    v_exp_f32 v70, v70
    v_exp_f32 v71, v71
    v_exp_f32 v72, v72
    v_exp_f32 v73, v73
    v_exp_f32 v74, v74
    v_exp_f32 v75, v75
    v_exp_f32 v76, v76
    v_exp_f32 v77, v77
    v_exp_f32 v78, v78
    v_exp_f32 v79, v79
    v_pk_add_f32 v[80:81], v[64:65], v[72:73]
    v_pk_add_f32 v[82:83], v[66:67], v[74:75]
    v_pk_add_f32 v[84:85], v[68:69], v[76:77]
    v_pk_add_f32 v[86:87], v[70:71], v[78:79]
    v_pk_add_f32 v[80:81], v[80:81], v[84:85]
    v_pk_add_f32 v[82:83], v[82:83], v[86:87]
    v_pk_add_f32 v[80:81], v[80:81], v[82:83]
    v_add_f32 v80, v80, v81
    v_rcp_f32_e64 v80, v80
    s_nop 0
    v_pk_mul_f32 v[64:65], v[64:65], v[80:81] op_sel_hi:[1,0]
    v_pk_mul_f32 v[66:67], v[66:67], v[80:81] op_sel_hi:[1,0]
    v_pk_mul_f32 v[68:69], v[68:69], v[80:81] op_sel_hi:[1,0]
    v_pk_mul_f32 v[70:71], v[70:71], v[80:81] op_sel_hi:[1,0]
    v_pk_mul_f32 v[72:73], v[72:73], v[80:81] op_sel_hi:[1,0]
    v_pk_mul_f32 v[74:75], v[74:75], v[80:81] op_sel_hi:[1,0]
    v_pk_mul_f32 v[76:77], v[76:77], v[80:81] op_sel_hi:[1,0]
    v_pk_mul_f32 v[78:79], v[78:79], v[80:81] op_sel_hi:[1,0]
    v_cvt_pk_bf16_f32 v104, v64, v65
    v_cvt_pk_bf16_f32 v105, v66, v67
    v_cvt_pk_bf16_f32 v106, v68, v69
    v_cvt_pk_bf16_f32 v107, v70, v71
    v_cvt_pk_bf16_f32 v108, v72, v73
    v_cvt_pk_bf16_f32 v109, v74, v75
    v_cvt_pk_bf16_f32 v110, v76, v77
    v_cvt_pk_bf16_f32 v111, v78, v79
L_kv3:

L_done4:
    buffer_load_dwordx4 v[48:51], v1, s[32:35], s95 offen sc1
    buffer_load_dword v52, v18, s[32:35], s95 offen offset:1024 sc1
    s_sub_u32 s56, s56, 1
    s_cselect_b32 s76, 0, 0x88888888
    s_mov_b32 s77, s76
    s_max_i32 s56, s56, 0
    s_waitcnt vmcnt(0)
    v_cmp_neq_f32 vcc, 4.0, v52
    v_cmp_neq_f32 s[44:45], 4.0, v51
    s_and_b64 vcc, vcc, s[100:101]
    s_or_b64 vcc, vcc, s[44:45]
    s_and_b64 vcc, vcc, s[76:77]
    s_cbranch_scc1 L_kv3
    v_cvt_pk_bf16_f32 v48, v48, v49
    v_cvt_pk_bf16_f32 v49, v50, v51
    v_cvt_pk_bf16_f32 v52, v52, v52
    ds_write_b64 v25, v[48:49]
    ds_write_b16 v26, v52 offset:30
    v_and_b32 v29, 63, v113
    v_cmp_ne_u32 vcc, 32, v29
    s_nop 0
    s_cbranch_vccnz L_redo6
L_done5:
    v_readfirstlane_b32 s57, v113
    s_lshl_b32 s59, s64, 5
    s_cmp_eq_u32 s57, s59
    s_cselect_b32 s55, 0, 1
    v_mov_b32 v112, 1
    s_waitcnt lgkmcnt(0)
    s_barrier
    ds_read_b64_tr_b16 v[80:81], v27 offset:0
    ds_read_b64_tr_b16 v[82:83], v27 offset:160
    ds_read_b64_tr_b16 v[84:85], v27 offset:320
    ds_read_b64_tr_b16 v[86:87], v27 offset:480
    ds_read_b64_tr_b16 v[88:89], v27 offset:1280
    ds_read_b64_tr_b16 v[90:91], v27 offset:1440
    ds_read_b64_tr_b16 v[92:93], v27 offset:1600
    ds_read_b64_tr_b16 v[94:95], v27 offset:1760
    s_waitcnt lgkmcnt(6)
    v_mfma_f32_32x32x16_bf16 v[48:63], v[80:83], v[96:99], 0
    s_waitcnt lgkmcnt(4)
    v_mfma_f32_32x32x16_bf16 v[48:63], v[84:87], v[100:103], v[48:63]
    s_waitcnt lgkmcnt(2)
    v_mfma_f32_32x32x16_bf16 v[64:79], v[88:91], v[104:107], 0
    s_waitcnt lgkmcnt(0)
    v_mfma_f32_32x32x16_bf16 v[64:79], v[92:95], v[108:111], v[64:79]
    v_add_f32 v56, 0x358637bd, v56
    v_rcp_f32 v56, v56
    s_nop 0
    v_pk_mul_f32 v[48:49], v[48:49], v[56:57] op_sel_hi:[1,0]
    v_pk_mul_f32 v[50:51], v[50:51], v[56:57] op_sel_hi:[1,0]
    v_pk_mul_f32 v[52:53], v[52:53], v[56:57] op_sel_hi:[1,0]
    v_pk_mul_f32 v[54:55], v[54:55], v[56:57] op_sel_hi:[1,0]
    v_cvt_pk_bf16_f32 v60, v48, v49
    v_cvt_pk_bf16_f32 v61, v50, v51
    v_cvt_pk_bf16_f32 v62, v52, v53
    v_cvt_pk_bf16_f32 v63, v54, v55
    s_nop 0
    v_add_f32 v72, 0x358637bd, v72
    v_rcp_f32_e64 v72, v72
    s_nop 0
    v_pk_mul_f32 v[64:65], v[64:65], v[72:73] op_sel_hi:[1,0]
    v_pk_mul_f32 v[66:67], v[66:67], v[72:73] op_sel_hi:[1,0]
    v_pk_mul_f32 v[68:69], v[68:69], v[72:73] op_sel_hi:[1,0]
    v_pk_mul_f32 v[70:71], v[70:71], v[72:73] op_sel_hi:[1,0]
    v_cvt_pk_bf16_f32 v76, v64, v65
    v_cvt_pk_bf16_f32 v77, v66, v67
    v_cvt_pk_bf16_f32 v78, v68, v69
    v_cvt_pk_bf16_f32 v79, v70, v71
    s_cmp_lg_u32 s55, 0
    s_cbranch_scc1 L_slow_o8
    buffer_store_dwordx4 v[60:63], v1, s[32:35], s78 offen
    buffer_store_dwordx4 v[76:79], v1, s[32:35], s78 offen offset:1024
L_ret_o8:
    buffer_atomic_add v112, v28, s[32:35], s98 offen
    s_add_u32 m0, s69, 90112
    s_add_u32 s0, s66, 344064
    buffer_load_dwordx4 v7, s[16:19], s0 offen lds
    buffer_load_dwordx4 v11, s[20:23], s0 offen offset:1024 lds
    ds_read_b64_tr_b16 a[0:1], v21 offset:0
    ds_read_b64_tr_b16 a[2:3], v21 offset:512
    ds_read_b64_tr_b16 a[4:5], v22 offset:0
    ds_read_b64_tr_b16 a[6:7], v22 offset:512
    ds_read_b64_tr_b16 a[8:9], v21 offset:2048
    ds_read_b64_tr_b16 a[10:11], v21 offset:2560
    ds_read_b64_tr_b16 a[12:13], v22 offset:2048
    ds_read_b64_tr_b16 a[14:15], v22 offset:2560
    ds_read_b64_tr_b16 a[16:17], v21 offset:4096
    ds_read_b64_tr_b16 a[18:19], v21 offset:4608
    ds_read_b64_tr_b16 a[20:21], v22 offset:4096
    ds_read_b64_tr_b16 a[22:23], v22 offset:4608
    ds_read_b64_tr_b16 a[24:25], v21 offset:6144
    ds_read_b64_tr_b16 a[26:27], v21 offset:6656
    ds_read_b64_tr_b16 a[28:29], v22 offset:6144
    ds_read_b64_tr_b16 a[30:31], v22 offset:6656
    ds_read_b64_tr_b16 a[32:33], v21 offset:8192
    ds_read_b64_tr_b16 a[34:35], v21 offset:8704
    ds_read_b64_tr_b16 a[36:37], v22 offset:8192
    ds_read_b64_tr_b16 a[38:39], v22 offset:8704
    ds_read_b64_tr_b16 a[40:41], v21 offset:10240
    ds_read_b64_tr_b16 a[42:43], v21 offset:10752
    ds_read_b64_tr_b16 a[44:45], v22 offset:10240
    ds_read_b64_tr_b16 a[46:47], v22 offset:10752
    ds_read_b64_tr_b16 a[48:49], v21 offset:12288
    ds_read_b64_tr_b16 a[50:51], v21 offset:12800
    ds_read_b64_tr_b16 a[52:53], v22 offset:12288
    ds_read_b64_tr_b16 a[54:55], v22 offset:12800
    ds_read_b64_tr_b16 a[56:57], v21 offset:14336
    ds_read_b64_tr_b16 a[58:59], v21 offset:14848
    ds_read_b64_tr_b16 a[60:61], v22 offset:14336
    ds_read_b64_tr_b16 a[62:63], v22 offset:14848
    v_mov_b32 v30, 1
    s_waitcnt vmcnt(3)
    s_cmp_lg_u32 s55, 0
    s_cbranch_scc1 L_slow_f9
    buffer_store_dword v30, v28, s[32:35], s79 offen offset:0
L_ret_f9:
    ds_read_b64_tr_b16 a[64:65], v23 offset:0
    ds_read_b64_tr_b16 a[66:67], v23 offset:512
    ds_read_b64_tr_b16 a[68:69], v24 offset:0
    ds_read_b64_tr_b16 a[70:71], v24 offset:512
    ds_read_b64_tr_b16 a[72:73], v23 offset:2048
    ds_read_b64_tr_b16 a[74:75], v23 offset:2560
    ds_read_b64_tr_b16 a[76:77], v24 offset:2048
    ds_read_b64_tr_b16 a[78:79], v24 offset:2560
    ds_read_b64_tr_b16 a[80:81], v23 offset:4096
    ds_read_b64_tr_b16 a[82:83], v23 offset:4608
    ds_read_b64_tr_b16 a[84:85], v24 offset:4096
    ds_read_b64_tr_b16 a[86:87], v24 offset:4608
    ds_read_b64_tr_b16 a[88:89], v23 offset:6144
    ds_read_b64_tr_b16 a[90:91], v23 offset:6656
    ds_read_b64_tr_b16 a[92:93], v24 offset:6144
    ds_read_b64_tr_b16 a[94:95], v24 offset:6656
    ds_read_b64_tr_b16 a[96:97], v23 offset:8192
    ds_read_b64_tr_b16 a[98:99], v23 offset:8704
    ds_read_b64_tr_b16 a[100:101], v24 offset:8192
    ds_read_b64_tr_b16 a[102:103], v24 offset:8704
    ds_read_b64_tr_b16 a[104:105], v23 offset:10240
    ds_read_b64_tr_b16 a[106:107], v23 offset:10752
    ds_read_b64_tr_b16 a[108:109], v24 offset:10240
    ds_read_b64_tr_b16 a[110:111], v24 offset:10752
    ds_read_b64_tr_b16 a[112:113], v23 offset:12288
    ds_read_b64_tr_b16 a[114:115], v23 offset:12800
    ds_read_b64_tr_b16 a[116:117], v24 offset:12288
    ds_read_b64_tr_b16 a[118:119], v24 offset:12800
    ds_read_b64_tr_b16 a[120:121], v23 offset:14336
    ds_read_b64_tr_b16 a[122:123], v23 offset:14848
    ds_read_b64_tr_b16 a[124:125], v24 offset:14336
    ds_read_b64_tr_b16 a[126:127], v24 offset:14848
    v_and_b32 v14, 7, v9
    v_lshlrev_b32 v14, 2, v14
    s_lshl_b32 s57, s48, 12
    s_add_u32 s57, s57, 131072
    v_add_u32 v12, s57, v1
    v_xor_b32 v13, 0x2000, v12
    s_getpc_b64 s[8:9]
L_pc2:
    s_sub_u32 s8, s8, L_pc2-interleave_layers__linear_kernel_hedgehog__geglu_ffn__prompt_kernel
    s_subb_u32 s9, s9, 0
    s_lshl2_add_u32 s57, s50, s48
    s_lshl_b32 s57, s57, 7
    s_add_u32 s4, s8, s57
    s_addc_u32 s5, s9, 0
    s_add_u32 s10, s4, L_k3_0-interleave_layers__linear_kernel_hedgehog__geglu_ffn__prompt_kernel
    s_addc_u32 s11, s5, 0
    s_load_dword s6, s[10:11], 0
    s_load_dword s7, s[10:11], 64
L_poll10:
    buffer_load_dword v30, v14, s[32:35], s80 offen offset:0 sc1
    s_sub_u32 s56, s56, 1
    s_cselect_b64 s[76:77], 0, -1
    s_max_i32 s56, s56, 0
    s_waitcnt vmcnt(0)
    v_cmp_eq_u32 vcc, 0, v30
    s_and_b64 vcc, vcc, s[76:77]
    s_cbranch_scc1 L_poll10
    buffer_load_dwordx4 v[128:131], v1, s[32:35], s81 offen offset:0 sc1
    buffer_load_dwordx4 v[132:135], v1, s[32:35], s81 offen offset:1024 sc1
    buffer_load_dwordx4 v[136:139], v1, s[32:35], s81 offen offset:2048 sc1
    buffer_load_dwordx4 v[140:143], v1, s[32:35], s81 offen offset:3072 sc1
    s_add_u32 s58, s81, 4096
    buffer_load_dwordx4 v[144:147], v1, s[32:35], s58 offen offset:0 sc1
    buffer_load_dwordx4 v[148:151], v1, s[32:35], s58 offen offset:1024 sc1
    buffer_load_dwordx4 v[152:155], v1, s[32:35], s58 offen offset:2048 sc1
    buffer_load_dwordx4 v[156:159], v1, s[32:35], s58 offen offset:3072 sc1
    s_waitcnt vmcnt(7) lgkmcnt(0)
    v_mfma_f32_32x32x16_bf16 v[64:79], a[4:7], v[128:131], 0
    s_add_u32 s58, s81, 8192
    buffer_load_dwordx4 v[160:163], v1, s[32:35], s58 offen offset:0 sc1
    v_mfma_f32_32x32x16_bf16 v[32:47], a[0:3], v[128:131], v[32:47]
    s_waitcnt vmcnt(7)
    v_mfma_f32_32x32x16_bf16 v[64:79], a[12:15], v[132:135], v[64:79]
    buffer_load_dwordx4 v[164:167], v1, s[32:35], s58 offen offset:1024 sc1
    v_mfma_f32_32x32x16_bf16 v[32:47], a[8:11], v[132:135], v[32:47]
    s_waitcnt vmcnt(7)
    v_mfma_f32_32x32x16_bf16 v[64:79], a[20:23], v[136:139], v[64:79]
    buffer_load_dwordx4 v[168:171], v1, s[32:35], s58 offen offset:2048 sc1
    v_mfma_f32_32x32x16_bf16 v[32:47], a[16:19], v[136:139], v[32:47]
    s_waitcnt vmcnt(7)
    v_mfma_f32_32x32x16_bf16 v[64:79], a[28:31], v[140:143], v[64:79]
    buffer_load_dwordx4 v[172:175], v1, s[32:35], s58 offen offset:3072 sc1
    s_barrier
    v_mfma_f32_32x32x16_bf16 v[32:47], a[24:27], v[140:143], v[32:47]
    s_waitcnt vmcnt(7)
    v_mfma_f32_32x32x16_bf16 v[64:79], a[36:39], v[144:147], v[64:79]
    s_add_u32 s58, s81, 12288
    buffer_load_dwordx4 v[176:179], v1, s[32:35], s58 offen offset:0 sc1
    v_mfma_f32_32x32x16_bf16 v[32:47], a[32:35], v[144:147], v[32:47]
    s_waitcnt vmcnt(7)
    v_mfma_f32_32x32x16_bf16 v[64:79], a[44:47], v[148:151], v[64:79]
    buffer_load_dwordx4 v[180:183], v1, s[32:35], s58 offen offset:1024 sc1
    v_mfma_f32_32x32x16_bf16 v[32:47], a[40:43], v[148:151], v[32:47]
    s_waitcnt vmcnt(7)
    v_mfma_f32_32x32x16_bf16 v[64:79], a[52:55], v[152:155], v[64:79]
    buffer_load_dwordx4 v[184:187], v1, s[32:35], s58 offen offset:2048 sc1
    v_mfma_f32_32x32x16_bf16 v[32:47], a[48:51], v[152:155], v[32:47]
    s_waitcnt vmcnt(7)
    v_mfma_f32_32x32x16_bf16 v[64:79], a[60:63], v[156:159], v[64:79]
    buffer_load_dwordx4 v[188:191], v1, s[32:35], s58 offen offset:3072 sc1
    v_mfma_f32_32x32x16_bf16 v[32:47], a[56:59], v[156:159], v[32:47]
    s_waitcnt vmcnt(7)
    v_mfma_f32_32x32x16_bf16 v[64:79], a[68:71], v[160:163], v[64:79]
    s_add_u32 m0, s69, 32768
    s_add_u32 s0, s66, 458752
    buffer_load_dwordx4 v7, s[16:19], s0 offen lds
    v_mfma_f32_32x32x16_bf16 v[32:47], a[64:67], v[160:163], v[32:47]
    s_waitcnt vmcnt(7)
    v_mfma_f32_32x32x16_bf16 v[64:79], a[76:79], v[164:167], v[64:79]
    buffer_load_dwordx4 v11, s[20:23], s0 offen offset:1024 lds
    v_mfma_f32_32x32x16_bf16 v[32:47], a[72:75], v[164:167], v[32:47]
    s_waitcnt vmcnt(7)
    v_mfma_f32_32x32x16_bf16 v[64:79], a[84:87], v[168:171], v[64:79]
    s_add_u32 m0, s69, 40960
    s_add_u32 s0, s66, 573440
    buffer_load_dwordx4 v7, s[16:19], s0 offen lds
    v_mfma_f32_32x32x16_bf16 v[32:47], a[80:83], v[168:171], v[32:47]
    s_waitcnt vmcnt(7)
    v_mfma_f32_32x32x16_bf16 v[64:79], a[92:95], v[172:175], v[64:79]
    buffer_load_dwordx4 v11, s[20:23], s0 offen offset:1024 lds
    s_waitcnt vmcnt(7)
    v_mfma_f32_32x32x16_bf16 v[64:79], a[100:103], v[176:179], v[64:79]
    s_add_u32 m0, s70, 0
    s_add_u32 s0, s67, 0
    buffer_load_dwordx4 v6, s[24:27], s0 offen lds
    s_waitcnt vmcnt(7)
    v_mfma_f32_32x32x16_bf16 v[64:79], a[108:111], v[180:183], v[64:79]
    buffer_load_dwordx4 v10, s[24:27], s0 offen offset:1024 lds
    s_waitcnt vmcnt(7)
    v_mfma_f32_32x32x16_bf16 v[64:79], a[116:119], v[184:187], v[64:79]
    s_add_u32 m0, s70, 2048
    s_add_u32 s0, s67, 16384
    buffer_load_dwordx4 v6, s[24:27], s0 offen lds
    s_waitcnt vmcnt(7)
    v_mfma_f32_32x32x16_bf16 v[64:79], a[124:127], v[188:191], v[64:79]
    buffer_load_dwordx4 v10, s[24:27], s0 offen offset:1024 lds
    v_mfma_f32_32x32x16_bf16 v[32:47], a[88:91], v[172:175], v[32:47]
    v_mfma_f32_32x32x16_bf16 v[32:47], a[96:99], v[176:179], v[32:47]
    ds_write_b128 v12, v[64:67] offset:0
    v_mfma_f32_32x32x16_bf16 v[32:47], a[104:107], v[180:183], v[32:47]
    ds_write_b128 v12, v[68:71] offset:1024
    v_mfma_f32_32x32x16_bf16 v[32:47], a[112:115], v[184:187], v[32:47]
    ds_write_b128 v12, v[72:75] offset:2048
    v_mfma_f32_32x32x16_bf16 v[32:47], a[120:123], v[188:191], v[32:47]
    ds_write_b128 v12, v[76:79] offset:3072
    s_waitcnt lgkmcnt(0)
    s_barrier
    ds_read_b128 v[64:67], v13 offset:0
    ds_read_b128 v[68:71], v13 offset:1024
    ds_read_b128 v[72:75], v13 offset:2048
    ds_read_b128 v[76:79], v13 offset:3072
    s_waitcnt lgkmcnt(3)
    s_nop 3
    v_pk_add_f32 v[32:33], v[32:33], v[64:65]
    v_pk_add_f32 v[34:35], v[34:35], v[66:67]
    s_waitcnt lgkmcnt(2)
    v_pk_add_f32 v[36:37], v[36:37], v[68:69]
    v_pk_add_f32 v[38:39], v[38:39], v[70:71]
    s_waitcnt lgkmcnt(1)
    v_pk_add_f32 v[40:41], v[40:41], v[72:73]
    v_pk_add_f32 v[42:43], v[42:43], v[74:75]
    s_waitcnt lgkmcnt(0)
    v_pk_add_f32 v[44:45], v[44:45], v[76:77]
    v_pk_add_f32 v[46:47], v[46:47], v[78:79]
    v_cvt_pk_bf16_f32 v48, v32, v33
    v_cvt_pk_bf16_f32 v49, v34, v35
    v_cvt_pk_bf16_f32 v50, v36, v37
    v_cvt_pk_bf16_f32 v51, v38, v39
    v_cvt_pk_bf16_f32 v52, v40, v41
    v_cvt_pk_bf16_f32 v53, v42, v43
    v_cvt_pk_bf16_f32 v54, v44, v45
    v_cvt_pk_bf16_f32 v55, v46, v47
    s_cmp_lg_u32 s55, 0
    s_cbranch_scc1 L_slow_x11
    buffer_store_dwordx4 v[48:51], v1, s[32:35], s82 offen
    buffer_store_dwordx4 v[52:55], v1, s[32:35], s82 offen offset:1024
L_ret_x11:
    v_pk_add_f32 v[56:57], v[32:33], v[34:35]
    v_pk_mul_f32 v[58:59], v[32:33], v[32:33]
    v_pk_fma_f32 v[58:59], v[34:35], v[34:35], v[58:59]
    v_pk_add_f32 v[56:57], v[56:57], v[36:37]
    v_pk_fma_f32 v[58:59], v[36:37], v[36:37], v[58:59]
    v_pk_add_f32 v[56:57], v[56:57], v[38:39]
    v_pk_fma_f32 v[58:59], v[38:39], v[38:39], v[58:59]
    v_pk_add_f32 v[56:57], v[56:57], v[40:41]
    v_pk_fma_f32 v[58:59], v[40:41], v[40:41], v[58:59]
    v_pk_add_f32 v[56:57], v[56:57], v[42:43]
    v_pk_fma_f32 v[58:59], v[42:43], v[42:43], v[58:59]
    v_pk_add_f32 v[56:57], v[56:57], v[44:45]
    v_pk_fma_f32 v[58:59], v[44:45], v[44:45], v[58:59]
    v_pk_add_f32 v[56:57], v[56:57], v[46:47]
    v_pk_fma_f32 v[58:59], v[46:47], v[46:47], v[58:59]
    v_add_f32 v56, v56, v57
    v_add_f32 v57, v58, v59
    v_mov_b32 v58, v56
    v_mov_b32 v59, v57
    v_lshrrev_b32 v60, 5, v9
    v_lshl_add_u32 v60, v60, 28, v1
    v_permlane32_swap_b32 v56, v58
    v_permlane32_swap_b32 v57, v59
    v_pk_add_f32 v[56:57], v[56:57], v[58:59]
    s_cmp_lg_u32 s55, 0
    s_cbranch_scc1 L_slow_s12
    buffer_store_dwordx2 v[56:57], v60, s[32:35], s83 offen
L_ret_s12:
    v_mov_b32 v30, 1
    s_waitcnt vmcnt(1)
    s_cmp_lg_u32 s55, 0
    s_cbranch_scc1 L_slow_f13
    buffer_store_dword v30, v28, s[32:35], s84 offen offset:0
L_ret_f13:
    v_mov_b32 v30, 1
    s_waitcnt vmcnt(1)
    s_cmp_lg_u32 s55, 0
    s_cbranch_scc1 L_slow_f14
    buffer_store_dword v30, v28, s[32:35], s84 offen offset:1536
L_ret_f14:
L_k3_0:
    v_and_b32 v12, 31, v9
    v_lshlrev_b32 v22, 3, v12
    v_lshlrev_b32 v12, 2, v12
    v_add_u32 v18, s70, v3
    v_xor_b32 v19, 64, v18
    v_add_u32 v20, 131072, v18
    v_add_u32 v21, 131072, v19
    v_and_b32 v23, 7, v9
    v_min_u32 v23, 6, v23
    v_lshlrev_b32 v23, 2, v23
    s_lshl2_add_u32 s1, s49, s48
    s_lshl_b32 s1, s1, 11
    s_add_u32 s1, s1, 28835840
    s_lshl2_add_u32 s2, s48, s62
    s_add_u32 s2, s2, 6144
    s_lshr_b32 s57, s53, 1
    s_mul_i32 s47, s57, 12288
    s_and_b32 s57, s53, 1
    s_lshl_b32 s57, s57, 9
    s_add_u32 s47, s47, s57
    s_add_u32 s47, s47, 11264
    s_cmp_ge_u32 s50, 28
    s_cbranch_scc1 L_idle0
    v_add_u32 v13, 65536, v4
    v_xor_b32 v14, 32, v13
    v_xor_b32 v15, 64, v13
    v_xor_b32 v16, 96, v13
    v_add_u32 v22, 162816, v22
    v_add_u32 v17, 0x8000, v1
    v_mov_b32 v246, 0
    v_mov_b32 v247, 0
    v_mov_b32 v254, 0
    v_mov_b32 v255, 0
L_poll15:
    buffer_load_dword v30, v12, s[32:35], s85 offen offset:0 sc1
    s_sub_u32 s56, s56, 1
    s_cselect_b64 s[76:77], 0, -1
    s_max_i32 s56, s56, 0
    s_waitcnt vmcnt(0)
    v_cmp_eq_u32 vcc, 0, v30
    s_and_b64 vcc, vcc, s[76:77]
    s_cbranch_scc1 L_poll15
    buffer_load_dwordx4 v[176:179], v1, s[32:35], s87 offen offset:0 sc1
    buffer_load_dwordx4 v[180:183], v17, s[32:35], s87 offen offset:0 sc1
    buffer_load_dwordx4 v[184:187], v1, s[32:35], s87 offen offset:1024 sc1
    buffer_load_dwordx4 v[188:191], v17, s[32:35], s87 offen offset:1024 sc1
    s_barrier
    ds_read_b64_tr_b16 a[224:225], v13 offset:0
    ds_read_b64_tr_b16 a[226:227], v13 offset:512
    ds_read_b64_tr_b16 a[228:229], v14 offset:0
    ds_read_b64_tr_b16 a[230:231], v14 offset:512
    ds_read_b64_tr_b16 a[232:233], v15 offset:0
    ds_read_b64_tr_b16 a[234:235], v15 offset:512
    ds_read_b64_tr_b16 a[236:237], v16 offset:0
    ds_read_b64_tr_b16 a[238:239], v16 offset:512
    s_waitcnt vmcnt(3) lgkmcnt(6)
    v_mfma_f32_32x32x16_bf16 v[48:63], a[224:227], v[176:179], 0
    buffer_load_dwordx4 v[192:195], v1, s[32:35], s87 offen offset:2048 sc1
    s_waitcnt vmcnt(3)
    v_mfma_f32_32x32x16_bf16 v[112:127], a[224:227], v[180:183], 0
    ds_read_b64_tr_b16 a[240:241], v13 offset:4096
    ds_read_b64_tr_b16 a[242:243], v13 offset:4608
    s_waitcnt lgkmcnt(6)
    v_mfma_f32_32x32x16_bf16 v[64:79], a[228:231], v[176:179], 0
    buffer_load_dwordx4 v[196:199], v17, s[32:35], s87 offen offset:2048 sc1
    v_mfma_f32_32x32x16_bf16 v[128:143], a[228:231], v[180:183], 0
    ds_read_b64_tr_b16 a[244:245], v14 offset:4096
    ds_read_b64_tr_b16 a[246:247], v14 offset:4608
    ds_read_b64_tr_b16 a[0:1], v18 offset:0
    ds_read_b64_tr_b16 a[2:3], v18 offset:512
    ds_read_b64_tr_b16 a[4:5], v19 offset:0
    ds_read_b64_tr_b16 a[6:7], v19 offset:512
    s_waitcnt lgkmcnt(10)
    v_mfma_f32_32x32x16_bf16 v[80:95], a[232:235], v[176:179], 0
    buffer_load_dwordx4 v[200:203], v1, s[32:35], s87 offen offset:3072 sc1
    v_mfma_f32_32x32x16_bf16 v[144:159], a[232:235], v[180:183], 0
    ds_read_b64_tr_b16 a[224:225], v15 offset:4096
    ds_read_b64_tr_b16 a[226:227], v15 offset:4608
    s_waitcnt lgkmcnt(10)
    v_mfma_f32_32x32x16_bf16 v[96:111], a[236:239], v[176:179], 0
    buffer_load_dwordx4 v[204:207], v17, s[32:35], s87 offen offset:3072 sc1
    v_mfma_f32_32x32x16_bf16 v[160:175], a[236:239], v[180:183], 0
    ds_read_b64_tr_b16 a[228:229], v16 offset:4096
    ds_read_b64_tr_b16 a[230:231], v16 offset:4608
    s_waitcnt vmcnt(5) lgkmcnt(10)
    v_mfma_f32_32x32x16_bf16 v[48:63], a[240:243], v[184:187], v[48:63]
    s_add_u32 s58, s87, 4096
    buffer_load_dwordx4 v[208:211], v1, s[32:35], s58 offen offset:0 sc1
    s_waitcnt vmcnt(5)
    v_mfma_f32_32x32x16_bf16 v[112:127], a[240:243], v[188:191], v[112:127]
    ds_read_b64_tr_b16 a[232:233], v13 offset:8192
    ds_read_b64_tr_b16 a[234:235], v13 offset:8704
    s_waitcnt lgkmcnt(10)
    v_mfma_f32_32x32x16_bf16 v[64:79], a[244:247], v[184:187], v[64:79]
    buffer_load_dwordx4 v[212:215], v17, s[32:35], s58 offen offset:0 sc1
    v_mfma_f32_32x32x16_bf16 v[128:143], a[244:247], v[188:191], v[128:143]
    ds_read_b64_tr_b16 a[236:237], v14 offset:8192
    ds_read_b64_tr_b16 a[238:239], v14 offset:8704
    ds_read_b64_tr_b16 a[8:9], v18 offset:2048
    ds_read_b64_tr_b16 a[10:11], v18 offset:2560
    ds_read_b64_tr_b16 a[12:13], v19 offset:2048
    ds_read_b64_tr_b16 a[14:15], v19 offset:2560
    s_waitcnt lgkmcnt(10)
    v_mfma_f32_32x32x16_bf16 v[80:95], a[224:227], v[184:187], v[80:95]
    buffer_load_dwordx4 v[216:219], v1, s[32:35], s58 offen offset:1024 sc1
    v_mfma_f32_32x32x16_bf16 v[144:159], a[224:227], v[188:191], v[144:159]
    ds_read_b64_tr_b16 a[240:241], v15 offset:8192
    ds_read_b64_tr_b16 a[242:243], v15 offset:8704
    s_waitcnt lgkmcnt(10)
    v_mfma_f32_32x32x16_bf16 v[96:111], a[228:231], v[184:187], v[96:111]
    buffer_load_dwordx4 v[220:223], v17, s[32:35], s58 offen offset:1024 sc1
    v_mfma_f32_32x32x16_bf16 v[160:175], a[228:231], v[188:191], v[160:175]
    ds_read_b64_tr_b16 a[244:245], v16 offset:8192
    ds_read_b64_tr_b16 a[246:247], v16 offset:8704
    s_waitcnt vmcnt(7) lgkmcnt(10)
    v_mfma_f32_32x32x16_bf16 v[48:63], a[232:235], v[192:195], v[48:63]
    buffer_load_dwordx4 v[224:227], v1, s[32:35], s58 offen offset:2048 sc1
    s_waitcnt vmcnt(7)
    v_mfma_f32_32x32x16_bf16 v[112:127], a[232:235], v[196:199], v[112:127]
    ds_read_b64_tr_b16 a[224:225], v13 offset:12288
    ds_read_b64_tr_b16 a[226:227], v13 offset:12800
    s_waitcnt lgkmcnt(10)
    v_mfma_f32_32x32x16_bf16 v[64:79], a[236:239], v[192:195], v[64:79]
    s_add_u32 m0, s69, 49152
    s_add_u32 s0, s66, 688128
    buffer_load_dwordx4 v7, s[16:19], s0 offen lds
    v_mfma_f32_32x32x16_bf16 v[128:143], a[236:239], v[196:199], v[128:143]
    ds_read_b64_tr_b16 a[228:229], v14 offset:12288
    ds_read_b64_tr_b16 a[230:231], v14 offset:12800
    s_waitcnt lgkmcnt(6)
    v_mfma_f32_32x32x16_bf16 v[80:95], a[240:243], v[192:195], v[80:95]
    buffer_load_dwordx4 v[228:231], v17, s[32:35], s58 offen offset:2048 sc1
    v_mfma_f32_32x32x16_bf16 v[144:159], a[240:243], v[196:199], v[144:159]
    ds_read_b64_tr_b16 a[232:233], v15 offset:12288
    ds_read_b64_tr_b16 a[234:235], v15 offset:12800
    s_waitcnt lgkmcnt(6)
    v_mfma_f32_32x32x16_bf16 v[96:111], a[244:247], v[192:195], v[96:111]
    buffer_load_dwordx4 v[232:235], v1, s[32:35], s58 offen offset:3072 sc1
    buffer_load_dwordx4 v[236:239], v17, s[32:35], s58 offen offset:3072 sc1
    v_mfma_f32_32x32x16_bf16 v[160:175], a[244:247], v[196:199], v[160:175]
    ds_read_b64_tr_b16 a[236:237], v16 offset:12288
    ds_read_b64_tr_b16 a[238:239], v16 offset:12800
    s_waitcnt vmcnt(10) lgkmcnt(6)
    v_mfma_f32_32x32x16_bf16 v[48:63], a[224:227], v[200:203], v[48:63]
    s_add_u32 s58, s87, 8192
    buffer_load_dwordx4 v[176:179], v1, s[32:35], s58 offen offset:0 sc1
    s_waitcnt vmcnt(10)
    v_mfma_f32_32x32x16_bf16 v[112:127], a[224:227], v[204:207], v[112:127]
    ds_read_b64_tr_b16 a[240:241], v13 offset:16384
    ds_read_b64_tr_b16 a[242:243], v13 offset:16896
    s_waitcnt lgkmcnt(6)
    v_mfma_f32_32x32x16_bf16 v[64:79], a[228:231], v[200:203], v[64:79]
    s_add_u32 m0, s69, 49152
    s_add_u32 s0, s66, 688128
    buffer_load_dwordx4 v11, s[20:23], s0 offen offset:1024 lds
    v_mfma_f32_32x32x16_bf16 v[128:143], a[228:231], v[204:207], v[128:143]
    ds_read_b64_tr_b16 a[244:245], v14 offset:16384
    ds_read_b64_tr_b16 a[246:247], v14 offset:16896
    s_waitcnt lgkmcnt(6)
    v_mfma_f32_32x32x16_bf16 v[80:95], a[232:235], v[200:203], v[80:95]
    buffer_load_dwordx4 v[180:183], v17, s[32:35], s58 offen offset:0 sc1
    v_mfma_f32_32x32x16_bf16 v[144:159], a[232:235], v[204:207], v[144:159]
    ds_read_b64_tr_b16 a[224:225], v15 offset:16384
    ds_read_b64_tr_b16 a[226:227], v15 offset:16896
    s_waitcnt lgkmcnt(6)
    v_mfma_f32_32x32x16_bf16 v[96:111], a[236:239], v[200:203], v[96:111]
    buffer_load_dwordx4 v[184:187], v1, s[32:35], s58 offen offset:1024 sc1
    buffer_load_dwordx4 v[188:191], v17, s[32:35], s58 offen offset:1024 sc1
    v_mfma_f32_32x32x16_bf16 v[160:175], a[236:239], v[204:207], v[160:175]
    ds_read_b64_tr_b16 a[228:229], v16 offset:16384
    ds_read_b64_tr_b16 a[230:231], v16 offset:16896
    s_waitcnt vmcnt(13) lgkmcnt(6)
    v_mfma_f32_32x32x16_bf16 v[48:63], a[240:243], v[208:211], v[48:63]
    buffer_load_dwordx4 v[192:195], v1, s[32:35], s58 offen offset:2048 sc1
    s_waitcnt vmcnt(13)
    v_mfma_f32_32x32x16_bf16 v[112:127], a[240:243], v[212:215], v[112:127]
    ds_read_b64_tr_b16 a[232:233], v13 offset:20480
    ds_read_b64_tr_b16 a[234:235], v13 offset:20992
    s_waitcnt lgkmcnt(6)
    v_mfma_f32_32x32x16_bf16 v[64:79], a[244:247], v[208:211], v[64:79]
    s_add_u32 m0, s69, 57344
    s_add_u32 s0, s66, 802816
    buffer_load_dwordx4 v7, s[16:19], s0 offen lds
    v_mfma_f32_32x32x16_bf16 v[128:143], a[244:247], v[212:215], v[128:143]
    ds_read_b64_tr_b16 a[236:237], v14 offset:20480
    ds_read_b64_tr_b16 a[238:239], v14 offset:20992
    s_waitcnt lgkmcnt(6)
    v_mfma_f32_32x32x16_bf16 v[80:95], a[224:227], v[208:211], v[80:95]
    buffer_load_dwordx4 v[196:199], v17, s[32:35], s58 offen offset:2048 sc1
    v_mfma_f32_32x32x16_bf16 v[144:159], a[224:227], v[212:215], v[144:159]
    ds_read_b64_tr_b16 a[240:241], v15 offset:20480
    ds_read_b64_tr_b16 a[242:243], v15 offset:20992
    s_waitcnt lgkmcnt(6)
    v_mfma_f32_32x32x16_bf16 v[96:111], a[228:231], v[208:211], v[96:111]
    v_mfma_f32_32x32x16_bf16 v[160:175], a[228:231], v[212:215], v[160:175]
    ds_read_b64_tr_b16 a[244:245], v16 offset:20480
    ds_read_b64_tr_b16 a[246:247], v16 offset:20992
    s_waitcnt vmcnt(14) lgkmcnt(6)
    v_mfma_f32_32x32x16_bf16 v[48:63], a[232:235], v[216:219], v[48:63]
    buffer_load_dwordx4 v[200:203], v1, s[32:35], s58 offen offset:3072 sc1
    s_waitcnt vmcnt(14)
    v_mfma_f32_32x32x16_bf16 v[112:127], a[232:235], v[220:223], v[112:127]
    ds_read_b64_tr_b16 a[224:225], v13 offset:24576
    ds_read_b64_tr_b16 a[226:227], v13 offset:25088
    s_waitcnt lgkmcnt(6)
    v_mfma_f32_32x32x16_bf16 v[64:79], a[236:239], v[216:219], v[64:79]
    s_add_u32 m0, s69, 57344
    s_add_u32 s0, s66, 802816
    buffer_load_dwordx4 v11, s[20:23], s0 offen offset:1024 lds
    v_mfma_f32_32x32x16_bf16 v[128:143], a[236:239], v[220:223], v[128:143]
    ds_read_b64_tr_b16 a[228:229], v14 offset:24576
    ds_read_b64_tr_b16 a[230:231], v14 offset:25088
    s_waitcnt lgkmcnt(6)
    v_mfma_f32_32x32x16_bf16 v[80:95], a[240:243], v[216:219], v[80:95]
    buffer_load_dwordx4 v[204:207], v17, s[32:35], s58 offen offset:3072 sc1
    v_mfma_f32_32x32x16_bf16 v[144:159], a[240:243], v[220:223], v[144:159]
    ds_read_b64_tr_b16 a[232:233], v15 offset:24576
    ds_read_b64_tr_b16 a[234:235], v15 offset:25088
    s_waitcnt lgkmcnt(6)
    v_mfma_f32_32x32x16_bf16 v[96:111], a[244:247], v[216:219], v[96:111]
    s_add_u32 m0, s70, 4096
    s_add_u32 s0, s67, 32768
    buffer_load_dwordx4 v6, s[24:27], s0 offen lds
    v_mfma_f32_32x32x16_bf16 v[160:175], a[244:247], v[220:223], v[160:175]
    ds_read_b64_tr_b16 a[236:237], v16 offset:24576
    ds_read_b64_tr_b16 a[238:239], v16 offset:25088
    s_waitcnt vmcnt(16) lgkmcnt(6)
    v_mfma_f32_32x32x16_bf16 v[48:63], a[224:227], v[224:227], v[48:63]
    s_add_u32 s58, s87, 12288
    buffer_load_dwordx4 v[208:211], v1, s[32:35], s58 offen offset:0 sc1
    s_waitcnt vmcnt(15)
    v_mfma_f32_32x32x16_bf16 v[112:127], a[224:227], v[228:231], v[112:127]
    ds_read_b64_tr_b16 a[240:241], v13 offset:28672
    ds_read_b64_tr_b16 a[242:243], v13 offset:29184
    s_waitcnt lgkmcnt(6)
    v_mfma_f32_32x32x16_bf16 v[64:79], a[228:231], v[224:227], v[64:79]
    s_add_u32 m0, s70, 4096
    s_add_u32 s0, s67, 32768
    buffer_load_dwordx4 v10, s[24:27], s0 offen offset:1024 lds
    v_mfma_f32_32x32x16_bf16 v[128:143], a[228:231], v[228:231], v[128:143]
    ds_read_b64_tr_b16 a[244:245], v14 offset:28672
    ds_read_b64_tr_b16 a[246:247], v14 offset:29184
    s_waitcnt lgkmcnt(6)
    v_mfma_f32_32x32x16_bf16 v[80:95], a[232:235], v[224:227], v[80:95]
    buffer_load_dwordx4 v[212:215], v17, s[32:35], s58 offen offset:0 sc1
    v_mfma_f32_32x32x16_bf16 v[144:159], a[232:235], v[228:231], v[144:159]
    ds_read_b64_tr_b16 a[224:225], v15 offset:28672
    ds_read_b64_tr_b16 a[226:227], v15 offset:29184
    s_waitcnt lgkmcnt(6)
    v_mfma_f32_32x32x16_bf16 v[96:111], a[236:239], v[224:227], v[96:111]
    s_add_u32 m0, s69, 98304
    s_add_u32 s0, s66, 917504
    buffer_load_dwordx4 v7, s[16:19], s0 offen lds
    v_mfma_f32_32x32x16_bf16 v[160:175], a[236:239], v[228:231], v[160:175]
    ds_read_b64_tr_b16 a[228:229], v16 offset:28672
    ds_read_b64_tr_b16 a[230:231], v16 offset:29184
    s_waitcnt vmcnt(17) lgkmcnt(6)
    v_mfma_f32_32x32x16_bf16 v[48:63], a[240:243], v[232:235], v[48:63]
    buffer_load_dwordx4 v[216:219], v1, s[32:35], s58 offen offset:1024 sc1
    s_waitcnt vmcnt(17)
    v_mfma_f32_32x32x16_bf16 v[112:127], a[240:243], v[236:239], v[112:127]
    v_subrev_u32 v13, 32768, v13
    v_subrev_u32 v14, 32768, v14
    v_subrev_u32 v15, 32768, v15
    v_subrev_u32 v16, 32768, v16
    ds_read_b64_tr_b16 a[232:233], v13 offset:0
    ds_read_b64_tr_b16 a[234:235], v13 offset:512
    s_waitcnt lgkmcnt(6)
    v_mfma_f32_32x32x16_bf16 v[64:79], a[244:247], v[232:235], v[64:79]
    s_add_u32 m0, s69, 98304
    s_add_u32 s0, s66, 917504
    buffer_load_dwordx4 v11, s[20:23], s0 offen offset:1024 lds
    v_mfma_f32_32x32x16_bf16 v[128:143], a[244:247], v[236:239], v[128:143]
    ds_read_b64_tr_b16 a[236:237], v14 offset:0
    ds_read_b64_tr_b16 a[238:239], v14 offset:512
    s_waitcnt lgkmcnt(6)
    v_mfma_f32_32x32x16_bf16 v[80:95], a[224:227], v[232:235], v[80:95]
    buffer_load_dwordx4 v[220:223], v17, s[32:35], s58 offen offset:1024 sc1
    v_mfma_f32_32x32x16_bf16 v[144:159], a[224:227], v[236:239], v[144:159]
    ds_read_b64_tr_b16 a[240:241], v15 offset:0
    ds_read_b64_tr_b16 a[242:243], v15 offset:512
    s_waitcnt lgkmcnt(6)
    v_mfma_f32_32x32x16_bf16 v[96:111], a[228:231], v[232:235], v[96:111]
    s_add_u32 m0, s70, 6144
    s_add_u32 s0, s67, 49152
    buffer_load_dwordx4 v6, s[24:27], s0 offen lds
    v_mfma_f32_32x32x16_bf16 v[160:175], a[228:231], v[236:239], v[160:175]
    ds_read_b64_tr_b16 a[244:245], v16 offset:0
    ds_read_b64_tr_b16 a[246:247], v16 offset:512
    s_waitcnt vmcnt(19) lgkmcnt(6)
    v_mfma_f32_32x32x16_bf16 v[48:63], a[232:235], v[176:179], v[48:63]
    buffer_load_dwordx4 v[224:227], v1, s[32:35], s58 offen offset:2048 sc1
    s_waitcnt vmcnt(18)
    v_mfma_f32_32x32x16_bf16 v[112:127], a[232:235], v[180:183], v[112:127]
    ds_read_b64_tr_b16 a[224:225], v13 offset:4096
    ds_read_b64_tr_b16 a[226:227], v13 offset:4608
    s_waitcnt lgkmcnt(6)
    v_mfma_f32_32x32x16_bf16 v[64:79], a[236:239], v[176:179], v[64:79]
    s_add_u32 m0, s70, 6144
    s_add_u32 s0, s67, 49152
    buffer_load_dwordx4 v10, s[24:27], s0 offen offset:1024 lds
    v_mfma_f32_32x32x16_bf16 v[128:143], a[236:239], v[180:183], v[128:143]
    ds_read_b64_tr_b16 a[228:229], v14 offset:4096
    ds_read_b64_tr_b16 a[230:231], v14 offset:4608
    s_waitcnt lgkmcnt(6)
    v_mfma_f32_32x32x16_bf16 v[80:95], a[240:243], v[176:179], v[80:95]
    buffer_load_dwordx4 v[228:231], v17, s[32:35], s58 offen offset:2048 sc1
    v_mfma_f32_32x32x16_bf16 v[144:159], a[240:243], v[180:183], v[144:159]
    ds_read_b64_tr_b16 a[232:233], v15 offset:4096
    ds_read_b64_tr_b16 a[234:235], v15 offset:4608
    s_waitcnt lgkmcnt(6)
    v_mfma_f32_32x32x16_bf16 v[96:111], a[244:247], v[176:179], v[96:111]
    s_add_u32 m0, s69, 106496
    s_add_u32 s0, s66, 1032192
    buffer_load_dwordx4 v7, s[16:19], s0 offen lds
    v_mfma_f32_32x32x16_bf16 v[160:175], a[244:247], v[180:183], v[160:175]
    ds_read_b64_tr_b16 a[236:237], v16 offset:4096
    ds_read_b64_tr_b16 a[238:239], v16 offset:4608
    s_waitcnt vmcnt(20) lgkmcnt(6)
    v_mfma_f32_32x32x16_bf16 v[48:63], a[224:227], v[184:187], v[48:63]
    buffer_load_dwordx4 v[232:235], v1, s[32:35], s58 offen offset:3072 sc1
    s_waitcnt vmcnt(20)
    v_mfma_f32_32x32x16_bf16 v[112:127], a[224:227], v[188:191], v[112:127]
    s_waitcnt vmcnt(15)
    s_barrier
    ds_read_b64_tr_b16 a[240:241], v13 offset:8192
    ds_read_b64_tr_b16 a[242:243], v13 offset:8704
    s_waitcnt lgkmcnt(6)
    v_mfma_f32_32x32x16_bf16 v[64:79], a[228:231], v[184:187], v[64:79]
    s_add_u32 m0, s69, 106496
    s_add_u32 s0, s66, 1032192
    buffer_load_dwordx4 v11, s[20:23], s0 offen offset:1024 lds
    v_mfma_f32_32x32x16_bf16 v[128:143], a[228:231], v[188:191], v[128:143]
    ds_read_b64_tr_b16 a[244:245], v14 offset:8192
    ds_read_b64_tr_b16 a[246:247], v14 offset:8704
    s_waitcnt vmcnt(12)
    ds_read_b64_tr_b16 a[16:17], v18 offset:4096
    ds_read_b64_tr_b16 a[18:19], v18 offset:4608
    ds_read_b64_tr_b16 a[20:21], v19 offset:4096
    ds_read_b64_tr_b16 a[22:23], v19 offset:4608
    s_waitcnt lgkmcnt(10)
    v_mfma_f32_32x32x16_bf16 v[80:95], a[232:235], v[184:187], v[80:95]
    buffer_load_dwordx4 v[236:239], v17, s[32:35], s58 offen offset:3072 sc1
    v_mfma_f32_32x32x16_bf16 v[144:159], a[232:235], v[188:191], v[144:159]
    ds_read_b64_tr_b16 a[224:225], v15 offset:8192
    ds_read_b64_tr_b16 a[226:227], v15 offset:8704
    s_waitcnt lgkmcnt(10)
    v_mfma_f32_32x32x16_bf16 v[96:111], a[236:239], v[184:187], v[96:111]
    s_add_u32 m0, s70, 131072
    s_add_u32 s0, s67, 65536
    buffer_load_dwordx4 v6, s[24:27], s0 offen lds
    v_mfma_f32_32x32x16_bf16 v[160:175], a[236:239], v[188:191], v[160:175]
    ds_read_b64_tr_b16 a[228:229], v16 offset:8192
    ds_read_b64_tr_b16 a[230:231], v16 offset:8704
    s_waitcnt lgkmcnt(10)
    v_mfma_f32_32x32x16_bf16 v[48:63], a[240:243], v[192:195], v[48:63]
    s_add_u32 s58, s87, 16384
    buffer_load_dwordx4 v[176:179], v1, s[32:35], s58 offen offset:0 sc1
    v_mfma_f32_32x32x16_bf16 v[112:127], a[240:243], v[196:199], v[112:127]
    ds_read_b64_tr_b16 a[232:233], v13 offset:12288
    ds_read_b64_tr_b16 a[234:235], v13 offset:12800
    s_waitcnt lgkmcnt(10)
    v_mfma_f32_32x32x16_bf16 v[64:79], a[244:247], v[192:195], v[64:79]
    s_add_u32 m0, s70, 131072
    s_add_u32 s0, s67, 65536
    buffer_load_dwordx4 v10, s[24:27], s0 offen offset:1024 lds
    v_mfma_f32_32x32x16_bf16 v[128:143], a[244:247], v[196:199], v[128:143]
    ds_read_b64_tr_b16 a[236:237], v14 offset:12288
    ds_read_b64_tr_b16 a[238:239], v14 offset:12800
    s_waitcnt lgkmcnt(6)
    v_mfma_f32_32x32x16_bf16 v[80:95], a[224:227], v[192:195], v[80:95]
    buffer_load_dwordx4 v[180:183], v17, s[32:35], s58 offen offset:0 sc1
    v_mfma_f32_32x32x16_bf16 v[144:159], a[224:227], v[196:199], v[144:159]
    ds_read_b64_tr_b16 a[240:241], v15 offset:12288
    ds_read_b64_tr_b16 a[242:243], v15 offset:12800
    s_waitcnt lgkmcnt(6)
    v_mfma_f32_32x32x16_bf16 v[96:111], a[228:231], v[192:195], v[96:111]
    s_add_u32 m0, s69, 114688
    s_add_u32 s0, s66, 1146880
    buffer_load_dwordx4 v7, s[16:19], s0 offen lds
    v_mfma_f32_32x32x16_bf16 v[160:175], a[228:231], v[196:199], v[160:175]
    ds_read_b64_tr_b16 a[244:245], v16 offset:12288
    ds_read_b64_tr_b16 a[246:247], v16 offset:12800
    s_waitcnt lgkmcnt(6)
    v_mfma_f32_32x32x16_bf16 v[48:63], a[232:235], v[200:203], v[48:63]
    buffer_load_dwordx4 v[184:187], v1, s[32:35], s58 offen offset:1024 sc1
    v_mfma_f32_32x32x16_bf16 v[112:127], a[232:235], v[204:207], v[112:127]
    ds_read_b64_tr_b16 a[224:225], v13 offset:16384
    ds_read_b64_tr_b16 a[226:227], v13 offset:16896
    s_waitcnt lgkmcnt(6)
    v_mfma_f32_32x32x16_bf16 v[64:79], a[236:239], v[200:203], v[64:79]
    s_add_u32 m0, s69, 114688
    s_add_u32 s0, s66, 1146880
    buffer_load_dwordx4 v11, s[20:23], s0 offen offset:1024 lds
    v_mfma_f32_32x32x16_bf16 v[128:143], a[236:239], v[204:207], v[128:143]
    ds_read_b64_tr_b16 a[228:229], v14 offset:16384
    ds_read_b64_tr_b16 a[230:231], v14 offset:16896
    s_waitcnt vmcnt(12)
    ds_read_b64_tr_b16 a[24:25], v18 offset:6144
    ds_read_b64_tr_b16 a[26:27], v18 offset:6656
    ds_read_b64_tr_b16 a[28:29], v19 offset:6144
    ds_read_b64_tr_b16 a[30:31], v19 offset:6656
    s_waitcnt lgkmcnt(10)
    v_mfma_f32_32x32x16_bf16 v[80:95], a[240:243], v[200:203], v[80:95]
    buffer_load_dwordx4 v[188:191], v17, s[32:35], s58 offen offset:1024 sc1
    v_mfma_f32_32x32x16_bf16 v[144:159], a[240:243], v[204:207], v[144:159]
    ds_read_b64_tr_b16 a[232:233], v15 offset:16384
    ds_read_b64_tr_b16 a[234:235], v15 offset:16896
    s_waitcnt lgkmcnt(10)
    v_mfma_f32_32x32x16_bf16 v[96:111], a[244:247], v[200:203], v[96:111]
    s_add_u32 m0, s70, 133120
    s_add_u32 s0, s67, 81920
    buffer_load_dwordx4 v6, s[24:27], s0 offen lds
    v_mfma_f32_32x32x16_bf16 v[160:175], a[244:247], v[204:207], v[160:175]
    ds_read_b64_tr_b16 a[236:237], v16 offset:16384
    ds_read_b64_tr_b16 a[238:239], v16 offset:16896
    s_waitcnt lgkmcnt(10)
    v_mfma_f32_32x32x16_bf16 v[48:63], a[224:227], v[208:211], v[48:63]
    buffer_load_dwordx4 v[192:195], v1, s[32:35], s58 offen offset:2048 sc1
    v_mfma_f32_32x32x16_bf16 v[112:127], a[224:227], v[212:215], v[112:127]
    ds_read_b64_tr_b16 a[240:241], v13 offset:20480
    ds_read_b64_tr_b16 a[242:243], v13 offset:20992
    s_waitcnt lgkmcnt(10)
    v_mfma_f32_32x32x16_bf16 v[64:79], a[228:231], v[208:211], v[64:79]
    s_add_u32 m0, s70, 133120
    s_add_u32 s0, s67, 81920
    buffer_load_dwordx4 v10, s[24:27], s0 offen offset:1024 lds
    v_mfma_f32_32x32x16_bf16 v[128:143], a[228:231], v[212:215], v[128:143]
    ds_read_b64_tr_b16 a[244:245], v14 offset:20480
    ds_read_b64_tr_b16 a[246:247], v14 offset:20992
    s_waitcnt lgkmcnt(6)
    v_mfma_f32_32x32x16_bf16 v[80:95], a[232:235], v[208:211], v[80:95]
    buffer_load_dwordx4 v[196:199], v17, s[32:35], s58 offen offset:2048 sc1
    v_mfma_f32_32x32x16_bf16 v[144:159], a[232:235], v[212:215], v[144:159]
    ds_read_b64_tr_b16 a[224:225], v15 offset:20480
    ds_read_b64_tr_b16 a[226:227], v15 offset:20992
    s_waitcnt lgkmcnt(6)
    v_mfma_f32_32x32x16_bf16 v[96:111], a[236:239], v[208:211], v[96:111]
    s_add_u32 m0, s69, 122880
    s_add_u32 s0, s66, 1261568
    buffer_load_dwordx4 v7, s[16:19], s0 offen lds
    v_mfma_f32_32x32x16_bf16 v[160:175], a[236:239], v[212:215], v[160:175]
    ds_read_b64_tr_b16 a[228:229], v16 offset:20480
    ds_read_b64_tr_b16 a[230:231], v16 offset:20992
    s_waitcnt lgkmcnt(6)
    v_mfma_f32_32x32x16_bf16 v[48:63], a[240:243], v[216:219], v[48:63]
    buffer_load_dwordx4 v[200:203], v1, s[32:35], s58 offen offset:3072 sc1
    v_mfma_f32_32x32x16_bf16 v[112:127], a[240:243], v[220:223], v[112:127]
    ds_read_b64_tr_b16 a[232:233], v13 offset:24576
    ds_read_b64_tr_b16 a[234:235], v13 offset:25088
    s_waitcnt lgkmcnt(6)
    v_mfma_f32_32x32x16_bf16 v[64:79], a[244:247], v[216:219], v[64:79]
    s_add_u32 m0, s69, 122880
    s_add_u32 s0, s66, 1261568
    buffer_load_dwordx4 v11, s[20:23], s0 offen offset:1024 lds
    v_mfma_f32_32x32x16_bf16 v[128:143], a[244:247], v[220:223], v[128:143]
    ds_read_b64_tr_b16 a[236:237], v14 offset:24576
    ds_read_b64_tr_b16 a[238:239], v14 offset:25088
    s_waitcnt vmcnt(12)
    ds_read_b64_tr_b16 a[32:33], v20 offset:0
    ds_read_b64_tr_b16 a[34:35], v20 offset:512
    ds_read_b64_tr_b16 a[36:37], v21 offset:0
    ds_read_b64_tr_b16 a[38:39], v21 offset:512
    s_waitcnt lgkmcnt(10)
    v_mfma_f32_32x32x16_bf16 v[80:95], a[224:227], v[216:219], v[80:95]
    buffer_load_dwordx4 v[204:207], v17, s[32:35], s58 offen offset:3072 sc1
    v_mfma_f32_32x32x16_bf16 v[144:159], a[224:227], v[220:223], v[144:159]
    ds_read_b64_tr_b16 a[240:241], v15 offset:24576
    ds_read_b64_tr_b16 a[242:243], v15 offset:25088
    s_waitcnt lgkmcnt(10)
    v_mfma_f32_32x32x16_bf16 v[96:111], a[228:231], v[216:219], v[96:111]
    s_add_u32 m0, s70, 135168
    s_add_u32 s0, s67, 98304
    buffer_load_dwordx4 v6, s[24:27], s0 offen lds
    v_mfma_f32_32x32x16_bf16 v[160:175], a[228:231], v[220:223], v[160:175]
    ds_read_b64_tr_b16 a[244:245], v16 offset:24576
    ds_read_b64_tr_b16 a[246:247], v16 offset:25088
    s_waitcnt lgkmcnt(10)
    v_mfma_f32_32x32x16_bf16 v[48:63], a[232:235], v[224:227], v[48:63]
    s_add_u32 s58, s87, 20480
    buffer_load_dwordx4 v[208:211], v1, s[32:35], s58 offen offset:0 sc1
    v_mfma_f32_32x32x16_bf16 v[112:127], a[232:235], v[228:231], v[112:127]
    ds_read_b64_tr_b16 a[224:225], v13 offset:28672
    ds_read_b64_tr_b16 a[226:227], v13 offset:29184
    s_waitcnt lgkmcnt(10)
    v_mfma_f32_32x32x16_bf16 v[64:79], a[236:239], v[224:227], v[64:79]
    s_add_u32 m0, s70, 135168
    s_add_u32 s0, s67, 98304
    buffer_load_dwordx4 v10, s[24:27], s0 offen offset:1024 lds
    v_mfma_f32_32x32x16_bf16 v[128:143], a[236:239], v[228:231], v[128:143]
    ds_read_b64_tr_b16 a[228:229], v14 offset:28672
    ds_read_b64_tr_b16 a[230:231], v14 offset:29184
    s_waitcnt lgkmcnt(6)
    v_mfma_f32_32x32x16_bf16 v[80:95], a[240:243], v[224:227], v[80:95]
    buffer_load_dwordx4 v[212:215], v17, s[32:35], s58 offen offset:0 sc1
    v_mfma_f32_32x32x16_bf16 v[144:159], a[240:243], v[228:231], v[144:159]
    ds_read_b64_tr_b16 a[232:233], v15 offset:28672
    ds_read_b64_tr_b16 a[234:235], v15 offset:29184
    s_waitcnt lgkmcnt(6)
    v_mfma_f32_32x32x16_bf16 v[96:111], a[244:247], v[224:227], v[96:111]
    s_add_u32 m0, s69, 65536
    s_add_u32 s0, s66, 1376256
    buffer_load_dwordx4 v7, s[16:19], s0 offen lds
    v_mfma_f32_32x32x16_bf16 v[160:175], a[244:247], v[228:231], v[160:175]
    ds_read_b64_tr_b16 a[236:237], v16 offset:28672
    ds_read_b64_tr_b16 a[238:239], v16 offset:29184
    s_waitcnt lgkmcnt(6)
    v_mfma_f32_32x32x16_bf16 v[48:63], a[224:227], v[232:235], v[48:63]
    buffer_load_dwordx4 v[216:219], v1, s[32:35], s58 offen offset:1024 sc1
    v_mfma_f32_32x32x16_bf16 v[112:127], a[224:227], v[236:239], v[112:127]
    s_waitcnt vmcnt(15)
    s_barrier
    v_add_u32 v13, 32768, v13
    v_add_u32 v14, 32768, v14
    v_add_u32 v15, 32768, v15
    v_add_u32 v16, 32768, v16
    ds_read_b64_tr_b16 a[240:241], v13 offset:32768
    ds_read_b64_tr_b16 a[242:243], v13 offset:33280
    s_waitcnt lgkmcnt(6)
    v_mfma_f32_32x32x16_bf16 v[64:79], a[228:231], v[232:235], v[64:79]
    s_add_u32 m0, s69, 65536
    s_add_u32 s0, s66, 1376256
    buffer_load_dwordx4 v11, s[20:23], s0 offen offset:1024 lds
    v_mfma_f32_32x32x16_bf16 v[128:143], a[228:231], v[236:239], v[128:143]
    ds_read_b64_tr_b16 a[244:245], v14 offset:32768
    ds_read_b64_tr_b16 a[246:247], v14 offset:33280
    s_waitcnt vmcnt(12)
    ds_read_b64_tr_b16 a[40:41], v20 offset:2048
    ds_read_b64_tr_b16 a[42:43], v20 offset:2560
    ds_read_b64_tr_b16 a[44:45], v21 offset:2048
    ds_read_b64_tr_b16 a[46:47], v21 offset:2560
    s_waitcnt lgkmcnt(10)
    v_mfma_f32_32x32x16_bf16 v[80:95], a[232:235], v[232:235], v[80:95]
    buffer_load_dwordx4 v[220:223], v17, s[32:35], s58 offen offset:1024 sc1
    v_mfma_f32_32x32x16_bf16 v[144:159], a[232:235], v[236:239], v[144:159]
    ds_read_b64_tr_b16 a[224:225], v15 offset:32768
    ds_read_b64_tr_b16 a[226:227], v15 offset:33280
    s_waitcnt lgkmcnt(10)
    v_mfma_f32_32x32x16_bf16 v[96:111], a[236:239], v[232:235], v[96:111]
    s_add_u32 m0, s70, 0
    s_add_u32 s0, s67, 114688
    buffer_load_dwordx4 v6, s[24:27], s0 offen lds
    v_mfma_f32_32x32x16_bf16 v[160:175], a[236:239], v[236:239], v[160:175]
    ds_read_b64_tr_b16 a[228:229], v16 offset:32768
    ds_read_b64_tr_b16 a[230:231], v16 offset:33280
    s_waitcnt lgkmcnt(10)
    v_mfma_f32_32x32x16_bf16 v[48:63], a[240:243], v[176:179], v[48:63]
    buffer_load_dwordx4 v[224:227], v1, s[32:35], s58 offen offset:2048 sc1
    v_mfma_f32_32x32x16_bf16 v[112:127], a[240:243], v[180:183], v[112:127]
    ds_read_b64_tr_b16 a[232:233], v13 offset:36864
    ds_read_b64_tr_b16 a[234:235], v13 offset:37376
    s_waitcnt lgkmcnt(10)
    v_mfma_f32_32x32x16_bf16 v[64:79], a[244:247], v[176:179], v[64:79]
    s_add_u32 m0, s70, 0
    s_add_u32 s0, s67, 114688
    buffer_load_dwordx4 v10, s[24:27], s0 offen offset:1024 lds
    v_mfma_f32_32x32x16_bf16 v[128:143], a[244:247], v[180:183], v[128:143]
    ds_read_b64_tr_b16 a[236:237], v14 offset:36864
    ds_read_b64_tr_b16 a[238:239], v14 offset:37376
    s_waitcnt lgkmcnt(6)
    v_mfma_f32_32x32x16_bf16 v[80:95], a[224:227], v[176:179], v[80:95]
    buffer_load_dwordx4 v[228:231], v17, s[32:35], s58 offen offset:2048 sc1
    v_mfma_f32_32x32x16_bf16 v[144:159], a[224:227], v[180:183], v[144:159]
    ds_read_b64_tr_b16 a[240:241], v15 offset:36864
    ds_read_b64_tr_b16 a[242:243], v15 offset:37376
    s_waitcnt lgkmcnt(6)
    v_mfma_f32_32x32x16_bf16 v[96:111], a[228:231], v[176:179], v[96:111]
    s_add_u32 m0, s69, 73728
    s_add_u32 s0, s66, 1490944
    buffer_load_dwordx4 v7, s[16:19], s0 offen lds
    buffer_load_dword v29, v246, s[32:35], s2 offen offset:0 sc1
    v_mfma_f32_32x32x16_bf16 v[160:175], a[228:231], v[180:183], v[160:175]
    ds_read_b64_tr_b16 a[244:245], v16 offset:36864
    ds_read_b64_tr_b16 a[246:247], v16 offset:37376
    s_waitcnt lgkmcnt(6)
    v_mfma_f32_32x32x16_bf16 v[48:63], a[232:235], v[184:187], v[48:63]
    buffer_load_dwordx4 v[232:235], v1, s[32:35], s58 offen offset:3072 sc1
    v_mfma_f32_32x32x16_bf16 v[112:127], a[232:235], v[188:191], v[112:127]
    ds_read_b64_tr_b16 a[224:225], v13 offset:40960
    ds_read_b64_tr_b16 a[226:227], v13 offset:41472
    s_waitcnt lgkmcnt(6)
    v_mfma_f32_32x32x16_bf16 v[64:79], a[236:239], v[184:187], v[64:79]
    s_add_u32 m0, s69, 73728
    s_add_u32 s0, s66, 1490944
    buffer_load_dwordx4 v11, s[20:23], s0 offen offset:1024 lds
    v_mfma_f32_32x32x16_bf16 v[128:143], a[236:239], v[188:191], v[128:143]
    ds_read_b64_tr_b16 a[228:229], v14 offset:40960
    ds_read_b64_tr_b16 a[230:231], v14 offset:41472
    s_waitcnt vmcnt(13)
    ds_read_b64_tr_b16 a[48:49], v20 offset:4096
    ds_read_b64_tr_b16 a[50:51], v20 offset:4608
    ds_read_b64_tr_b16 a[52:53], v21 offset:4096
    ds_read_b64_tr_b16 a[54:55], v21 offset:4608
    s_waitcnt lgkmcnt(10)
    v_mfma_f32_32x32x16_bf16 v[80:95], a[240:243], v[184:187], v[80:95]
    buffer_load_dwordx4 v[236:239], v17, s[32:35], s58 offen offset:3072 sc1
    v_mfma_f32_32x32x16_bf16 v[144:159], a[240:243], v[188:191], v[144:159]
    ds_read_b64_tr_b16 a[232:233], v15 offset:40960
    ds_read_b64_tr_b16 a[234:235], v15 offset:41472
    s_waitcnt lgkmcnt(10)
    v_mfma_f32_32x32x16_bf16 v[96:111], a[244:247], v[184:187], v[96:111]
    v_mfma_f32_32x32x16_bf16 v[160:175], a[244:247], v[188:191], v[160:175]
    ds_read_b64_tr_b16 a[236:237], v16 offset:40960
    ds_read_b64_tr_b16 a[238:239], v16 offset:41472
    s_waitcnt lgkmcnt(10)
    v_mfma_f32_32x32x16_bf16 v[48:63], a[224:227], v[192:195], v[48:63]
    s_add_u32 s58, s87, 24576
    buffer_load_dwordx4 v[176:179], v1, s[32:35], s58 offen offset:0 sc1
    v_mfma_f32_32x32x16_bf16 v[112:127], a[224:227], v[196:199], v[112:127]
    ds_read_b64_tr_b16 a[240:241], v13 offset:45056
    ds_read_b64_tr_b16 a[242:243], v13 offset:45568
    s_waitcnt lgkmcnt(10)
    v_mfma_f32_32x32x16_bf16 v[64:79], a[228:231], v[192:195], v[64:79]
    s_add_u32 m0, s69, 81920
    s_add_u32 s0, s66, 1605632
    buffer_load_dwordx4 v7, s[16:19], s0 offen lds
    v_mfma_f32_32x32x16_bf16 v[128:143], a[228:231], v[196:199], v[128:143]
    ds_read_b64_tr_b16 a[244:245], v14 offset:45056
    ds_read_b64_tr_b16 a[246:247], v14 offset:45568
    s_waitcnt lgkmcnt(6)
    v_mfma_f32_32x32x16_bf16 v[80:95], a[232:235], v[192:195], v[80:95]
    buffer_load_dwordx4 v[180:183], v17, s[32:35], s58 offen offset:0 sc1
    v_mfma_f32_32x32x16_bf16 v[144:159], a[232:235], v[196:199], v[144:159]
    ds_read_b64_tr_b16 a[224:225], v15 offset:45056
    ds_read_b64_tr_b16 a[226:227], v15 offset:45568
    s_waitcnt lgkmcnt(6)
    v_mfma_f32_32x32x16_bf16 v[96:111], a[236:239], v[192:195], v[96:111]
    v_mfma_f32_32x32x16_bf16 v[160:175], a[236:239], v[196:199], v[160:175]
    ds_read_b64_tr_b16 a[228:229], v16 offset:45056
    ds_read_b64_tr_b16 a[230:231], v16 offset:45568
    s_waitcnt lgkmcnt(6)
    v_mfma_f32_32x32x16_bf16 v[48:63], a[240:243], v[200:203], v[48:63]
    buffer_load_dwordx4 v[184:187], v1, s[32:35], s58 offen offset:1024 sc1
    v_mfma_f32_32x32x16_bf16 v[112:127], a[240:243], v[204:207], v[112:127]
    ds_read_b64_tr_b16 a[232:233], v13 offset:49152
    ds_read_b64_tr_b16 a[234:235], v13 offset:49664
    s_waitcnt lgkmcnt(6)
    v_mfma_f32_32x32x16_bf16 v[64:79], a[244:247], v[200:203], v[64:79]
    s_add_u32 m0, s69, 81920
    s_add_u32 s0, s66, 1605632
    buffer_load_dwordx4 v11, s[20:23], s0 offen offset:1024 lds
    v_mfma_f32_32x32x16_bf16 v[128:143], a[244:247], v[204:207], v[128:143]
    ds_read_b64_tr_b16 a[236:237], v14 offset:49152
    ds_read_b64_tr_b16 a[238:239], v14 offset:49664
    s_waitcnt vmcnt(11)
    ds_read_b64_tr_b16 a[56:57], v18 offset:0
    ds_read_b64_tr_b16 a[58:59], v18 offset:512
    ds_read_b64_tr_b16 a[60:61], v19 offset:0
    ds_read_b64_tr_b16 a[62:63], v19 offset:512
    s_waitcnt lgkmcnt(10)
    v_mfma_f32_32x32x16_bf16 v[80:95], a[224:227], v[200:203], v[80:95]
    buffer_load_dwordx4 v[188:191], v17, s[32:35], s58 offen offset:1024 sc1
    v_mfma_f32_32x32x16_bf16 v[144:159], a[224:227], v[204:207], v[144:159]
    ds_read_b64_tr_b16 a[240:241], v15 offset:49152
    ds_read_b64_tr_b16 a[242:243], v15 offset:49664
    s_waitcnt lgkmcnt(10)
    v_mfma_f32_32x32x16_bf16 v[96:111], a[228:231], v[200:203], v[96:111]
    s_add_u32 m0, s70, 2048
    s_add_u32 s0, s67, 131072
    buffer_load_dwordx4 v6, s[24:27], s0 offen lds
    v_mfma_f32_32x32x16_bf16 v[160:175], a[228:231], v[204:207], v[160:175]
    ds_read_b64_tr_b16 a[244:245], v16 offset:49152
    ds_read_b64_tr_b16 a[246:247], v16 offset:49664
    s_waitcnt lgkmcnt(10)
    v_mfma_f32_32x32x16_bf16 v[48:63], a[232:235], v[208:211], v[48:63]
    buffer_load_dwordx4 v[192:195], v1, s[32:35], s58 offen offset:2048 sc1
    v_mfma_f32_32x32x16_bf16 v[112:127], a[232:235], v[212:215], v[112:127]
    ds_read_b64_tr_b16 a[224:225], v13 offset:53248
    ds_read_b64_tr_b16 a[226:227], v13 offset:53760
    s_waitcnt lgkmcnt(10)
    v_mfma_f32_32x32x16_bf16 v[64:79], a[236:239], v[208:211], v[64:79]
    s_add_u32 m0, s70, 2048
    s_add_u32 s0, s67, 131072
    buffer_load_dwordx4 v10, s[24:27], s0 offen offset:1024 lds
    v_mfma_f32_32x32x16_bf16 v[128:143], a[236:239], v[212:215], v[128:143]
    ds_read_b64_tr_b16 a[228:229], v14 offset:53248
    ds_read_b64_tr_b16 a[230:231], v14 offset:53760
    s_waitcnt lgkmcnt(6)
    v_mfma_f32_32x32x16_bf16 v[80:95], a[240:243], v[208:211], v[80:95]
    buffer_load_dwordx4 v[196:199], v17, s[32:35], s58 offen offset:2048 sc1
    v_mfma_f32_32x32x16_bf16 v[144:159], a[240:243], v[212:215], v[144:159]
    ds_read_b64_tr_b16 a[232:233], v15 offset:53248
    ds_read_b64_tr_b16 a[234:235], v15 offset:53760
    s_waitcnt lgkmcnt(6)
    v_mfma_f32_32x32x16_bf16 v[96:111], a[244:247], v[208:211], v[96:111]
    s_add_u32 m0, s69, 90112
    s_add_u32 s0, s66, 1720320
    buffer_load_dwordx4 v7, s[16:19], s0 offen lds
    v_mfma_f32_32x32x16_bf16 v[160:175], a[244:247], v[212:215], v[160:175]
    ds_read_b64_tr_b16 a[236:237], v16 offset:53248
    ds_read_b64_tr_b16 a[238:239], v16 offset:53760
    s_waitcnt lgkmcnt(6)
    v_mfma_f32_32x32x16_bf16 v[48:63], a[224:227], v[216:219], v[48:63]
    buffer_load_dwordx4 v[200:203], v1, s[32:35], s58 offen offset:3072 sc1
    v_mfma_f32_32x32x16_bf16 v[112:127], a[224:227], v[220:223], v[112:127]
    s_waitcnt vmcnt(13)
    s_barrier
    ds_read_b64_tr_b16 a[240:241], v13 offset:57344
    ds_read_b64_tr_b16 a[242:243], v13 offset:57856
    s_waitcnt lgkmcnt(6)
    v_mfma_f32_32x32x16_bf16 v[64:79], a[228:231], v[216:219], v[64:79]
    s_add_u32 m0, s69, 90112
    s_add_u32 s0, s66, 1720320
    buffer_load_dwordx4 v11, s[20:23], s0 offen offset:1024 lds
    v_mfma_f32_32x32x16_bf16 v[128:143], a[228:231], v[220:223], v[128:143]
    ds_read_b64_tr_b16 a[244:245], v14 offset:57344
    ds_read_b64_tr_b16 a[246:247], v14 offset:57856
    s_waitcnt lgkmcnt(6)
    v_mfma_f32_32x32x16_bf16 v[80:95], a[232:235], v[216:219], v[80:95]
    buffer_load_dwordx4 v[204:207], v17, s[32:35], s58 offen offset:3072 sc1
    v_mfma_f32_32x32x16_bf16 v[144:159], a[232:235], v[220:223], v[144:159]
    ds_read_b64_tr_b16 a[224:225], v15 offset:57344
    ds_read_b64_tr_b16 a[226:227], v15 offset:57856
    s_waitcnt lgkmcnt(6)
    v_mfma_f32_32x32x16_bf16 v[96:111], a[236:239], v[216:219], v[96:111]
    s_add_u32 m0, s70, 4096
    s_add_u32 s0, s67, 147456
    buffer_load_dwordx4 v6, s[24:27], s0 offen lds
    v_cmp_eq_u32 vcc, 0, v29
    s_nop 0
    s_cbranch_vccnz L_redo17
L_done16:
    buffer_load_dwordx4 v[240:243], v1, s[32:35], s1 offen offset:0 sc1
    buffer_load_dwordx4 v[248:251], v1, s[32:35], s1 offen offset:1024 sc1
    v_mfma_f32_32x32x16_bf16 v[160:175], a[236:239], v[220:223], v[160:175]
    ds_read_b64_tr_b16 a[228:229], v16 offset:57344
    ds_read_b64_tr_b16 a[230:231], v16 offset:57856
    s_waitcnt lgkmcnt(6)
    v_mfma_f32_32x32x16_bf16 v[48:63], a[240:243], v[224:227], v[48:63]
    s_add_u32 s58, s87, 28672
    buffer_load_dwordx4 v[208:211], v1, s[32:35], s58 offen offset:0 sc1
    v_mfma_f32_32x32x16_bf16 v[112:127], a[240:243], v[228:231], v[112:127]
    ds_read_b64_tr_b16 a[232:233], v13 offset:61440
    ds_read_b64_tr_b16 a[234:235], v13 offset:61952
    s_waitcnt lgkmcnt(6)
    v_mfma_f32_32x32x16_bf16 v[64:79], a[244:247], v[224:227], v[64:79]
    s_add_u32 m0, s70, 4096
    s_add_u32 s0, s67, 147456
    buffer_load_dwordx4 v10, s[24:27], s0 offen offset:1024 lds
    v_mfma_f32_32x32x16_bf16 v[128:143], a[244:247], v[228:231], v[128:143]
    ds_read_b64_tr_b16 a[236:237], v14 offset:61440
    ds_read_b64_tr_b16 a[238:239], v14 offset:61952
    s_waitcnt lgkmcnt(6)
    v_mfma_f32_32x32x16_bf16 v[80:95], a[224:227], v[224:227], v[80:95]
    buffer_load_dwordx4 v[212:215], v17, s[32:35], s58 offen offset:0 sc1
    v_mfma_f32_32x32x16_bf16 v[144:159], a[224:227], v[228:231], v[144:159]
    ds_read_b64_tr_b16 a[240:241], v15 offset:61440
    ds_read_b64_tr_b16 a[242:243], v15 offset:61952
    s_waitcnt lgkmcnt(6)
    v_mfma_f32_32x32x16_bf16 v[96:111], a[228:231], v[224:227], v[96:111]
    s_add_u32 m0, s70, 6144
    s_add_u32 s0, s67, 163840
    buffer_load_dwordx4 v6, s[24:27], s0 offen lds
    v_mfma_f32_32x32x16_bf16 v[160:175], a[228:231], v[228:231], v[160:175]
    ds_read_b64_tr_b16 a[244:245], v16 offset:61440
    ds_read_b64_tr_b16 a[246:247], v16 offset:61952
    s_waitcnt lgkmcnt(6)
    v_mfma_f32_32x32x16_bf16 v[48:63], a[232:235], v[232:235], v[48:63]
    buffer_load_dwordx4 v[216:219], v1, s[32:35], s58 offen offset:1024 sc1
    s_waitcnt vmcnt(22)
    v_mfma_f32_32x32x16_bf16 v[112:127], a[232:235], v[236:239], v[112:127]
    ds_read_b64_tr_b16 a[224:225], v13 offset:0
    ds_read_b64_tr_b16 a[226:227], v13 offset:512
    s_waitcnt lgkmcnt(6)
    v_mfma_f32_32x32x16_bf16 v[64:79], a[236:239], v[232:235], v[64:79]
    s_add_u32 m0, s70, 6144
    s_add_u32 s0, s67, 163840
    buffer_load_dwordx4 v10, s[24:27], s0 offen offset:1024 lds
    v_mfma_f32_32x32x16_bf16 v[128:143], a[236:239], v[236:239], v[128:143]
    ds_read_b64_tr_b16 a[228:229], v14 offset:0
    ds_read_b64_tr_b16 a[230:231], v14 offset:512
    s_waitcnt vmcnt(14)
    ds_read_b64_tr_b16 a[64:65], v18 offset:2048
    ds_read_b64_tr_b16 a[66:67], v18 offset:2560
    ds_read_b64_tr_b16 a[68:69], v19 offset:2048
    ds_read_b64_tr_b16 a[70:71], v19 offset:2560
    s_waitcnt lgkmcnt(10)
    v_mfma_f32_32x32x16_bf16 v[80:95], a[240:243], v[232:235], v[80:95]
    buffer_load_dwordx4 v[220:223], v17, s[32:35], s58 offen offset:1024 sc1
    v_mfma_f32_32x32x16_bf16 v[144:159], a[240:243], v[236:239], v[144:159]
    ds_read_b64_tr_b16 a[232:233], v15 offset:0
    ds_read_b64_tr_b16 a[234:235], v15 offset:512
    s_waitcnt lgkmcnt(10)
    v_mfma_f32_32x32x16_bf16 v[96:111], a[244:247], v[232:235], v[96:111]
    s_add_u32 m0, s70, 131072
    s_add_u32 s0, s67, 180224
    buffer_load_dwordx4 v6, s[24:27], s0 offen lds
    v_lshlrev_b32 v12, 2, v12
    buffer_load_dwordx4 a[100:103], v12, s[32:35], s47 offen sc1
    v_mfma_f32_32x32x16_bf16 v[160:175], a[244:247], v[236:239], v[160:175]
    ds_read_b64_tr_b16 a[236:237], v16 offset:0
    ds_read_b64_tr_b16 a[238:239], v16 offset:512
    s_waitcnt lgkmcnt(10)
    v_mfma_f32_32x32x16_bf16 v[48:63], a[224:227], v[176:179], v[48:63]
    buffer_load_dwordx4 v[224:227], v1, s[32:35], s58 offen offset:2048 sc1
    v_mfma_f32_32x32x16_bf16 v[112:127], a[224:227], v[180:183], v[112:127]
    ds_read_b64_tr_b16 a[240:241], v13 offset:4096
    ds_read_b64_tr_b16 a[242:243], v13 offset:4608
    s_waitcnt lgkmcnt(10)
    v_mfma_f32_32x32x16_bf16 v[64:79], a[228:231], v[176:179], v[64:79]
    s_add_u32 m0, s70, 131072
    s_add_u32 s0, s67, 180224
    buffer_load_dwordx4 v10, s[24:27], s0 offen offset:1024 lds
    v_mfma_f32_32x32x16_bf16 v[128:143], a[228:231], v[180:183], v[128:143]
    ds_read_b64_tr_b16 a[244:245], v14 offset:4096
    ds_read_b64_tr_b16 a[246:247], v14 offset:4608
    s_waitcnt lgkmcnt(6)
    v_mfma_f32_32x32x16_bf16 v[80:95], a[232:235], v[176:179], v[80:95]
    buffer_load_dwordx4 v[228:231], v17, s[32:35], s58 offen offset:2048 sc1
    v_mfma_f32_32x32x16_bf16 v[144:159], a[232:235], v[180:183], v[144:159]
    ds_read_b64_tr_b16 a[224:225], v15 offset:4096
    ds_read_b64_tr_b16 a[226:227], v15 offset:4608
    s_waitcnt lgkmcnt(6)
    v_mfma_f32_32x32x16_bf16 v[96:111], a[236:239], v[176:179], v[96:111]
    s_add_u32 m0, s70, 133120
    s_add_u32 s0, s67, 196608
    buffer_load_dwordx4 v6, s[24:27], s0 offen lds
    v_mfma_f32_32x32x16_bf16 v[160:175], a[236:239], v[180:183], v[160:175]
    ds_read_b64_tr_b16 a[228:229], v16 offset:4096
    ds_read_b64_tr_b16 a[230:231], v16 offset:4608
    s_waitcnt lgkmcnt(6)
    v_mfma_f32_32x32x16_bf16 v[48:63], a[240:243], v[184:187], v[48:63]
    buffer_load_dwordx4 v[232:235], v1, s[32:35], s58 offen offset:3072 sc1
    v_mfma_f32_32x32x16_bf16 v[112:127], a[240:243], v[188:191], v[112:127]
    s_waitcnt vmcnt(18)
    s_barrier
    ds_read_b64_tr_b16 a[128:129], v13 offset:8192
    ds_read_b64_tr_b16 a[130:131], v13 offset:8704
    s_waitcnt lgkmcnt(6)
    v_mfma_f32_32x32x16_bf16 v[64:79], a[244:247], v[184:187], v[64:79]
    s_add_u32 m0, s70, 133120
    s_add_u32 s0, s67, 196608
    buffer_load_dwordx4 v10, s[24:27], s0 offen offset:1024 lds
    v_mfma_f32_32x32x16_bf16 v[128:143], a[244:247], v[188:191], v[128:143]
    ds_read_b64_tr_b16 a[144:145], v13 offset:12288
    ds_read_b64_tr_b16 a[146:147], v13 offset:12800
    s_waitcnt vmcnt(13)
    ds_read_b64_tr_b16 a[72:73], v18 offset:4096
    ds_read_b64_tr_b16 a[74:75], v18 offset:4608
    ds_read_b64_tr_b16 a[76:77], v19 offset:4096
    ds_read_b64_tr_b16 a[78:79], v19 offset:4608
    s_waitcnt lgkmcnt(10)
    v_mfma_f32_32x32x16_bf16 v[80:95], a[224:227], v[184:187], v[80:95]
    buffer_load_dwordx4 v[236:239], v17, s[32:35], s58 offen offset:3072 sc1
    v_mfma_f32_32x32x16_bf16 v[144:159], a[224:227], v[188:191], v[144:159]
    ds_read_b64_tr_b16 a[160:161], v13 offset:16384
    ds_read_b64_tr_b16 a[162:163], v13 offset:16896
    s_waitcnt lgkmcnt(10)
    v_mfma_f32_32x32x16_bf16 v[96:111], a[228:231], v[184:187], v[96:111]
    v_mfma_f32_32x32x16_bf16 v[160:175], a[228:231], v[188:191], v[160:175]
    ds_read_b64_tr_b16 a[176:177], v13 offset:20480
    ds_read_b64_tr_b16 a[178:179], v13 offset:20992
L_tail_0:
    s_add_u32 m0, s70, 135168
    s_add_u32 s0, s67, 212992
    buffer_load_dwordx4 v6, s[24:27], s0 offen lds
    s_waitcnt lgkmcnt(10)
    v_mfma_f32_32x32x16_bf16 v[48:63], a[128:131], v[192:195], v[48:63]
    ds_read_b64_tr_b16 a[192:193], v13 offset:24576
    ds_read_b64_tr_b16 a[194:195], v13 offset:25088
    ds_read_b64_tr_b16 a[208:209], v13 offset:28672
    ds_read_b64_tr_b16 a[210:211], v13 offset:29184
    s_waitcnt lgkmcnt(12)
    v_mfma_f32_32x32x16_bf16 v[48:63], a[144:147], v[200:203], v[48:63]
    buffer_load_dwordx4 v10, s[24:27], s0 offen offset:1024 lds
    ds_read_b64_tr_b16 a[132:133], v14 offset:8192
    ds_read_b64_tr_b16 a[134:135], v14 offset:8704
    ds_read_b64_tr_b16 a[148:149], v14 offset:12288
    ds_read_b64_tr_b16 a[150:151], v14 offset:12800
    s_waitcnt lgkmcnt(10)
    v_mfma_f32_32x32x16_bf16 v[48:63], a[160:163], v[208:211], v[48:63]
    ds_read_b64_tr_b16 a[164:165], v14 offset:16384
    ds_read_b64_tr_b16 a[166:167], v14 offset:16896
    ds_read_b64_tr_b16 a[180:181], v14 offset:20480
    ds_read_b64_tr_b16 a[182:183], v14 offset:20992
    s_waitcnt vmcnt(13) lgkmcnt(12)
    v_mfma_f32_32x32x16_bf16 v[48:63], a[176:179], v[216:219], v[48:63]
    s_add_u32 m0, s70, 32768
    s_add_u32 s0, s67, 229376
    buffer_load_dwordx4 v6, s[24:27], s0 offen lds
    ds_read_b64_tr_b16 a[196:197], v14 offset:24576
    ds_read_b64_tr_b16 a[198:199], v14 offset:25088
    ds_read_b64_tr_b16 a[212:213], v14 offset:28672
    ds_read_b64_tr_b16 a[214:215], v14 offset:29184
    v_mov_b32 v244, v243
    v_mov_b32 v245, v243
    v_mov_b32 v252, v251
    v_mov_b32 v253, v251
    s_waitcnt vmcnt(9) lgkmcnt(14)
    v_mfma_f32_32x32x16_bf16 v[48:63], a[192:195], v[224:227], v[48:63]
    buffer_load_dwordx4 v10, s[24:27], s0 offen offset:1024 lds
    ds_read_b64_tr_b16 a[136:137], v15 offset:8192
    ds_read_b64_tr_b16 a[138:139], v15 offset:8704
    ds_read_b64_tr_b16 a[152:153], v15 offset:12288
    ds_read_b64_tr_b16 a[154:155], v15 offset:12800
    v_accvgpr_read_b32 v184, a100
    v_accvgpr_read_b32 v185, a101
    v_accvgpr_read_b32 v186, a102
    v_accvgpr_read_b32 v187, a103
    v_min3_u32 v29, v184, v185, v186
    v_min_u32 v29, v29, v187
    v_cmp_eq_u32 vcc, 0, v29
    s_nop 0
    s_cbranch_vccnz L_redo20
L_done19:
    v_cvt_pk_bf16_f32 v176, v184, v184
    v_and_b32 v177, 0xffff0000, v176
    v_sub_f32 v177, v184, v177
    v_cvt_pk_bf16_f32 v177, v177, v177
    v_accvgpr_write_b32 a96, v176
    v_accvgpr_write_b32 a97, v177
    ds_write_b64 v22, v[176:177] offset:0
    v_cvt_pk_bf16_f32 v178, v185, v185
    v_and_b32 v179, 0xffff0000, v178
    v_sub_f32 v179, v185, v179
    v_cvt_pk_bf16_f32 v179, v179, v179
    v_accvgpr_write_b32 a98, v178
    s_add_u32 m0, s70, 34816
    s_add_u32 s0, s67, 245760
    buffer_load_dwordx4 v6, s[24:27], s0 offen lds
    v_accvgpr_write_b32 a99, v179
    ds_write_b64 v22, v[178:179] offset:256
    v_cvt_pk_bf16_f32 v180, v186, v186
    v_and_b32 v181, 0xffff0000, v180
    v_sub_f32 v181, v186, v181
    v_cvt_pk_bf16_f32 v181, v181, v181
    v_accvgpr_write_b32 a100, v180
    v_accvgpr_write_b32 a101, v181
    ds_write_b64 v22, v[180:181] offset:512
    v_cvt_pk_bf16_f32 v182, v187, v187
    v_and_b32 v183, 0xffff0000, v182
    v_sub_f32 v183, v187, v183
    v_cvt_pk_bf16_f32 v183, v183, v183
    v_accvgpr_write_b32 a102, v182
    v_accvgpr_write_b32 a103, v183
    ds_write_b64 v22, v[182:183] offset:768
    v_accvgpr_write_b32 a104, 0
    v_accvgpr_write_b32 a105, 0
    s_waitcnt vmcnt(7) lgkmcnt(14)
    v_mfma_f32_32x32x16_bf16 v[48:63], a[208:211], v[232:235], v[48:63]
    buffer_load_dwordx4 v10, s[24:27], s0 offen offset:1024 lds
    ds_read_b64_tr_b16 a[168:169], v15 offset:16384
    ds_read_b64_tr_b16 a[170:171], v15 offset:16896
    ds_read_b64_tr_b16 a[184:185], v15 offset:20480
    ds_read_b64_tr_b16 a[186:187], v15 offset:20992
    v_mfma_f32_32x32x16_bf16 v[48:63], a[96:99], v[244:247], v[48:63]
    s_nop 11
    v_pk_mul_f32 v[176:177], v[48:49], v[48:49]
    v_pk_mul_f32 v[178:179], v[50:51], v[50:51]
    v_pk_mul_f32 v[180:181], v[52:53], v[52:53]
    v_pk_mul_f32 v[182:183], v[54:55], v[54:55]
    v_pk_fma_f32 v[176:177], v[176:177], v[240:241], v[240:241] op_sel:[0,1,0] op_sel_hi:[1,1,0]
    v_pk_fma_f32 v[178:179], v[178:179], v[240:241], v[240:241] op_sel:[0,1,0] op_sel_hi:[1,1,0]
    v_pk_fma_f32 v[180:181], v[180:181], v[240:241], v[240:241] op_sel:[0,1,0] op_sel_hi:[1,1,0]
    s_add_u32 m0, s70, 36864
    s_add_u32 s0, s67, 262144
    buffer_load_dwordx4 v6, s[24:27], s0 offen lds
    v_pk_fma_f32 v[182:183], v[182:183], v[240:241], v[240:241] op_sel:[0,1,0] op_sel_hi:[1,1,0]
    v_pk_mul_f32 v[176:177], v[176:177], v[48:49]
    v_pk_mul_f32 v[178:179], v[178:179], v[50:51]
    v_pk_mul_f32 v[180:181], v[180:181], v[52:53]
    v_pk_mul_f32 v[182:183], v[182:183], v[54:55]
    v_pk_mul_f32 v[48:49], v[48:49], v[56:57]
    v_pk_mul_f32 v[50:51], v[50:51], v[58:59]
    v_pk_mul_f32 v[52:53], v[52:53], v[60:61]
    v_pk_mul_f32 v[54:55], v[54:55], v[62:63]
    v_mfma_f32_32x32x16_bf16 v[64:79], a[132:135], v[192:195], v[64:79]
    ds_read_b64_tr_b16 a[200:201], v15 offset:24576
    ds_read_b64_tr_b16 a[202:203], v15 offset:25088
    ds_read_b64_tr_b16 a[216:217], v15 offset:28672
    ds_read_b64_tr_b16 a[218:219], v15 offset:29184
    buffer_load_dwordx4 v10, s[24:27], s0 offen offset:1024 lds
    v_exp_f32 v176, v176
    v_exp_f32 v177, v177
    v_exp_f32 v178, v178
    v_exp_f32 v179, v179
    v_mfma_f32_32x32x16_bf16 v[64:79], a[148:151], v[200:203], v[64:79]
    ds_read_b64_tr_b16 a[140:141], v16 offset:8192
    ds_read_b64_tr_b16 a[142:143], v16 offset:8704
    ds_read_b64_tr_b16 a[156:157], v16 offset:12288
    ds_read_b64_tr_b16 a[158:159], v16 offset:12800
    v_exp_f32 v180, v180
    s_add_u32 m0, s70, 38912
    s_add_u32 s0, s67, 278528
    buffer_load_dwordx4 v6, s[24:27], s0 offen lds
    v_exp_f32 v181, v181
    v_exp_f32 v182, v182
    v_exp_f32 v183, v183
    v_mfma_f32_32x32x16_bf16 v[64:79], a[164:167], v[208:211], v[64:79]
    ds_read_b64_tr_b16 a[172:173], v16 offset:16384
    ds_read_b64_tr_b16 a[174:175], v16 offset:16896
    ds_read_b64_tr_b16 a[188:189], v16 offset:20480
    ds_read_b64_tr_b16 a[190:191], v16 offset:20992
    v_fma_f32 v176, v176, v242, v242
    v_fma_f32 v177, v177, v242, v242
    buffer_load_dwordx4 v10, s[24:27], s0 offen offset:1024 lds
    v_fma_f32 v178, v178, v242, v242
    v_fma_f32 v179, v179, v242, v242
    v_fma_f32 v180, v180, v242, v242
    v_fma_f32 v181, v181, v242, v242
    s_waitcnt lgkmcnt(14)
    v_mfma_f32_32x32x16_bf16 v[64:79], a[180:183], v[216:219], v[64:79]
    ds_read_b64_tr_b16 a[204:205], v16 offset:24576
    ds_read_b64_tr_b16 a[206:207], v16 offset:25088
    ds_read_b64_tr_b16 a[220:221], v16 offset:28672
    ds_read_b64_tr_b16 a[222:223], v16 offset:29184
    v_fma_f32 v182, v182, v242, v242
    v_fma_f32 v183, v183, v242, v242
    v_rcp_f32 v176, v176
    v_rcp_f32 v177, v177
    s_add_u32 m0, s70, 98304
    s_add_u32 s0, s67, 294912
    buffer_load_dwordx4 v6, s[24:27], s0 offen lds
    v_rcp_f32 v178, v178
    v_mfma_f32_32x32x16_bf16 v[64:79], a[196:199], v[224:227], v[64:79]
    v_rcp_f32 v179, v179
    v_rcp_f32 v180, v180
    v_rcp_f32 v181, v181
    v_mfma_f32_32x32x16_bf16 v[64:79], a[212:215], v[232:235], v[64:79]
    buffer_load_dwordx4 v10, s[24:27], s0 offen offset:1024 lds
    v_rcp_f32 v182, v182
    v_rcp_f32 v183, v183
    v_mul_f32 v48, v48, v176
    v_mul_f32 v49, v49, v177
    v_mul_f32 v50, v50, v178
    v_mfma_f32_32x32x16_bf16 v[64:79], a[98:101], v[244:247], v[64:79]
    v_mul_f32 v51, v51, v179
    v_mul_f32 v52, v52, v180
    v_mul_f32 v53, v53, v181
    v_mul_f32 v54, v54, v182
    v_mul_f32_e64 v55, v55, v183
    v_cvt_pk_bf16_f32 v56, v48, v49
    v_cvt_pk_bf16_f32 v57, v50, v51
    v_cvt_pk_bf16_f32 v58, v52, v53
    v_cvt_pk_bf16_f32 v59, v54, v55
    buffer_store_dwordx4 v[56:59], v1, s[32:35], s91 offen offset:0 sc1
    s_waitcnt lgkmcnt(0)
    s_barrier
    v_pk_mul_f32 v[176:177], v[64:65], v[64:65]
    v_pk_mul_f32 v[178:179], v[66:67], v[66:67]
    v_pk_mul_f32 v[180:181], v[68:69], v[68:69]
    v_pk_mul_f32 v[182:183], v[70:71], v[70:71]
    v_pk_fma_f32 v[176:177], v[176:177], v[240:241], v[240:241] op_sel:[0,1,0] op_sel_hi:[1,1,0]
    v_pk_fma_f32 v[178:179], v[178:179], v[240:241], v[240:241] op_sel:[0,1,0] op_sel_hi:[1,1,0]
    v_pk_fma_f32 v[180:181], v[180:181], v[240:241], v[240:241] op_sel:[0,1,0] op_sel_hi:[1,1,0]
    s_add_u32 m0, s70, 100352
    s_add_u32 s0, s67, 311296
    buffer_load_dwordx4 v6, s[24:27], s0 offen lds
    v_pk_fma_f32 v[182:183], v[182:183], v[240:241], v[240:241] op_sel:[0,1,0] op_sel_hi:[1,1,0]
    v_pk_mul_f32 v[176:177], v[176:177], v[64:65]
    v_pk_mul_f32 v[178:179], v[178:179], v[66:67]
    v_pk_mul_f32 v[180:181], v[180:181], v[68:69]
    v_pk_mul_f32 v[182:183], v[182:183], v[70:71]
    v_pk_mul_f32 v[64:65], v[64:65], v[72:73]
    v_pk_mul_f32 v[66:67], v[66:67], v[74:75]
    v_pk_mul_f32 v[68:69], v[68:69], v[76:77]
    v_pk_mul_f32 v[70:71], v[70:71], v[78:79]
    v_mfma_f32_32x32x16_bf16 v[80:95], a[136:139], v[192:195], v[80:95]
    buffer_load_dwordx4 v10, s[24:27], s0 offen offset:1024 lds
    v_exp_f32 v176, v176
    v_exp_f32 v177, v177
    v_exp_f32 v178, v178
    s_add_u32 m0, s70, 102400
    s_add_u32 s0, s67, 327680
    buffer_load_dwordx4 v6, s[24:27], s0 offen lds
    v_exp_f32 v179, v179
    v_mfma_f32_32x32x16_bf16 v[80:95], a[152:155], v[200:203], v[80:95]
    buffer_load_dwordx4 v10, s[24:27], s0 offen offset:1024 lds
    v_exp_f32 v180, v180
    v_exp_f32 v181, v181
    v_exp_f32 v182, v182
    v_exp_f32 v183, v183
    v_mfma_f32_32x32x16_bf16 v[80:95], a[168:171], v[208:211], v[80:95]
    s_add_u32 m0, s70, 104448
    s_add_u32 s0, s67, 344064
    buffer_load_dwordx4 v6, s[24:27], s0 offen lds
    v_fma_f32 v176, v176, v242, v242
    v_fma_f32 v177, v177, v242, v242
    v_fma_f32 v178, v178, v242, v242
    v_fma_f32 v179, v179, v242, v242
    v_fma_f32 v180, v180, v242, v242
    v_fma_f32 v181, v181, v242, v242
    buffer_load_dwordx4 v10, s[24:27], s0 offen offset:1024 lds
    v_mfma_f32_32x32x16_bf16 v[80:95], a[184:187], v[216:219], v[80:95]
    v_fma_f32 v182, v182, v242, v242
    v_fma_f32 v183, v183, v242, v242
    v_rcp_f32 v176, v176
    s_add_u32 m0, s70, 65536
    s_add_u32 s0, s67, 360448
    buffer_load_dwordx4 v6, s[24:27], s0 offen lds
    v_rcp_f32 v177, v177
    v_rcp_f32 v178, v178
    v_mfma_f32_32x32x16_bf16 v[80:95], a[200:203], v[224:227], v[80:95]
    buffer_load_dwordx4 v10, s[24:27], s0 offen offset:1024 lds
    v_rcp_f32 v179, v179
    v_rcp_f32 v180, v180
    v_rcp_f32 v181, v181
    v_mfma_f32_32x32x16_bf16 v[80:95], a[216:219], v[232:235], v[80:95]
    s_add_u32 m0, s70, 67584
    s_add_u32 s0, s67, 376832
    buffer_load_dwordx4 v6, s[24:27], s0 offen lds
    v_rcp_f32 v182, v182
    v_rcp_f32 v183, v183
    v_mul_f32 v64, v64, v176
    v_mul_f32 v65, v65, v177
    v_mul_f32 v66, v66, v178
    buffer_load_dwordx4 v10, s[24:27], s0 offen offset:1024 lds
    v_mfma_f32_32x32x16_bf16 v[80:95], a[100:103], v[244:247], v[80:95]
    v_mul_f32 v67, v67, v179
    v_mul_f32 v68, v68, v180
    v_mul_f32 v69, v69, v181
    v_mul_f32 v70, v70, v182
    v_mul_f32 v71, v71, v183
    v_cvt_pk_bf16_f32 v72, v64, v65
    v_cvt_pk_bf16_f32 v73, v66, v67
    v_cvt_pk_bf16_f32 v74, v68, v69
    v_cvt_pk_bf16_f32 v75, v70, v71
    buffer_store_dwordx4 v[72:75], v1, s[32:35], s91 offen offset:1024 sc1
    s_nop 1
    s_nop 0
    v_pk_mul_f32 v[176:177], v[80:81], v[80:81]
    v_pk_mul_f32 v[178:179], v[82:83], v[82:83]
    v_pk_mul_f32 v[180:181], v[84:85], v[84:85]
    v_pk_mul_f32 v[182:183], v[86:87], v[86:87]
    v_pk_fma_f32 v[176:177], v[176:177], v[240:241], v[240:241] op_sel:[0,1,0] op_sel_hi:[1,1,0]
    v_pk_fma_f32 v[178:179], v[178:179], v[240:241], v[240:241] op_sel:[0,1,0] op_sel_hi:[1,1,0]
    v_pk_fma_f32 v[180:181], v[180:181], v[240:241], v[240:241] op_sel:[0,1,0] op_sel_hi:[1,1,0]
    s_add_u32 m0, s70, 0
    s_add_u32 s0, s67, 425984
    buffer_load_dwordx4 v6, s[24:27], s0 offen lds
    s_nop 0
    v_pk_fma_f32 v[182:183], v[182:183], v[240:241], v[240:241] op_sel:[0,1,0] op_sel_hi:[1,1,0]
    v_pk_mul_f32 v[176:177], v[176:177], v[80:81]
    v_pk_mul_f32 v[178:179], v[178:179], v[82:83]
    v_pk_mul_f32 v[180:181], v[180:181], v[84:85]
    v_pk_mul_f32 v[182:183], v[182:183], v[86:87]
    v_pk_mul_f32 v[80:81], v[80:81], v[88:89]
    v_pk_mul_f32 v[82:83], v[82:83], v[90:91]
    v_pk_mul_f32 v[84:85], v[84:85], v[92:93]
    v_pk_mul_f32 v[86:87], v[86:87], v[94:95]
    v_mfma_f32_32x32x16_bf16 v[96:111], a[140:143], v[192:195], v[96:111]
    buffer_load_dwordx4 v10, s[24:27], s0 offen offset:1024 lds
    v_exp_f32 v176, v176
    v_exp_f32 v177, v177
    v_exp_f32 v178, v178
    v_exp_f32 v179, v179
    v_mfma_f32_32x32x16_bf16 v[96:111], a[156:159], v[200:203], v[96:111]
    s_add_u32 m0, s70, 2048
    s_add_u32 s0, s67, 442368
    buffer_load_dwordx4 v6, s[24:27], s0 offen lds
    v_exp_f32 v180, v180
    v_exp_f32 v181, v181
    v_exp_f32 v182, v182
    v_exp_f32 v183, v183
    v_mfma_f32_32x32x16_bf16 v[96:111], a[172:175], v[208:211], v[96:111]
    buffer_load_dwordx4 v10, s[24:27], s0 offen offset:1024 lds
    v_fma_f32 v176, v176, v242, v242
    v_fma_f32 v177, v177, v242, v242
    v_fma_f32 v178, v178, v242, v242
    v_fma_f32 v179, v179, v242, v242
    v_fma_f32 v180, v180, v242, v242
    v_fma_f32 v181, v181, v242, v242
    s_add_u32 m0, s70, 69632
    s_add_u32 s0, s67, 393216
    buffer_load_dwordx4 v6, s[24:27], s0 offen lds
    v_mfma_f32_32x32x16_bf16 v[96:111], a[188:191], v[216:219], v[96:111]
    v_fma_f32 v182, v182, v242, v242
    v_fma_f32 v183, v183, v242, v242
    v_rcp_f32 v176, v176
    v_rcp_f32 v177, v177
    buffer_load_dwordx4 v10, s[24:27], s0 offen offset:1024 lds
    v_rcp_f32 v178, v178
    v_mfma_f32_32x32x16_bf16 v[96:111], a[204:207], v[224:227], v[96:111]
    v_rcp_f32 v179, v179
    v_rcp_f32 v180, v180
    s_add_u32 m0, s70, 71680
    s_add_u32 s0, s67, 409600
    buffer_load_dwordx4 v6, s[24:27], s0 offen lds
    v_rcp_f32 v181, v181
    v_mfma_f32_32x32x16_bf16 v[96:111], a[220:223], v[232:235], v[96:111]
    v_rcp_f32 v182, v182
    v_rcp_f32 v183, v183
    buffer_load_dwordx4 v10, s[24:27], s0 offen offset:1024 lds
    v_mul_f32 v80, v80, v176
    v_mul_f32 v81, v81, v177
    v_mul_f32 v82, v82, v178
    v_mfma_f32_32x32x16_bf16 v[96:111], a[102:105], v[244:247], v[96:111]
    v_mul_f32 v83, v83, v179
    v_mul_f32 v84, v84, v180
    v_mul_f32 v85, v85, v181
    v_mul_f32 v86, v86, v182
    v_mul_f32 v87, v87, v183
    v_cvt_pk_bf16_f32 v88, v80, v81
    v_cvt_pk_bf16_f32 v89, v82, v83
    v_cvt_pk_bf16_f32 v90, v84, v85
    v_cvt_pk_bf16_f32 v91, v86, v87
    buffer_store_dwordx4 v[88:91], v1, s[32:35], s91 offen offset:2048 sc1
    s_nop 1
    s_nop 0
    v_pk_mul_f32 v[176:177], v[96:97], v[96:97]
    v_pk_mul_f32 v[178:179], v[98:99], v[98:99]
    v_pk_mul_f32 v[180:181], v[100:101], v[100:101]
    v_pk_mul_f32 v[182:183], v[102:103], v[102:103]
    v_pk_fma_f32 v[176:177], v[176:177], v[240:241], v[240:241] op_sel:[0,1,0] op_sel_hi:[1,1,0]
    v_pk_fma_f32 v[178:179], v[178:179], v[240:241], v[240:241] op_sel:[0,1,0] op_sel_hi:[1,1,0]
    v_pk_fma_f32 v[180:181], v[180:181], v[240:241], v[240:241] op_sel:[0,1,0] op_sel_hi:[1,1,0]
    v_pk_fma_f32 v[182:183], v[182:183], v[240:241], v[240:241] op_sel:[0,1,0] op_sel_hi:[1,1,0]
    v_pk_mul_f32 v[176:177], v[176:177], v[96:97]
    v_pk_mul_f32 v[178:179], v[178:179], v[98:99]
    v_pk_mul_f32 v[180:181], v[180:181], v[100:101]
    v_pk_mul_f32 v[182:183], v[182:183], v[102:103]
    v_pk_mul_f32 v[96:97], v[96:97], v[104:105]
    v_pk_mul_f32 v[98:99], v[98:99], v[106:107]
    v_pk_mul_f32 v[100:101], v[100:101], v[108:109]
    v_pk_mul_f32 v[102:103], v[102:103], v[110:111]
    v_mfma_f32_32x32x16_bf16 v[112:127], a[128:131], v[196:199], v[112:127]
    v_exp_f32 v176, v176
    v_exp_f32 v177, v177
    v_exp_f32 v178, v178
    v_exp_f32 v179, v179
    v_mfma_f32_32x32x16_bf16 v[112:127], a[144:147], v[204:207], v[112:127]
    v_exp_f32 v180, v180
    v_exp_f32 v181, v181
    v_exp_f32 v182, v182
    v_exp_f32 v183, v183
    v_mfma_f32_32x32x16_bf16 v[112:127], a[160:163], v[212:215], v[112:127]
    v_fma_f32 v176, v176, v242, v242
    v_fma_f32 v177, v177, v242, v242
    v_fma_f32 v178, v178, v242, v242
    v_fma_f32 v179, v179, v242, v242
    v_fma_f32 v180, v180, v242, v242
    v_fma_f32 v181, v181, v242, v242
    v_mfma_f32_32x32x16_bf16 v[112:127], a[176:179], v[220:223], v[112:127]
    v_fma_f32 v182, v182, v242, v242
    v_fma_f32 v183, v183, v242, v242
    v_rcp_f32 v176, v176
    v_rcp_f32 v177, v177
    v_rcp_f32 v178, v178
    v_mfma_f32_32x32x16_bf16 v[112:127], a[192:195], v[228:231], v[112:127]
    v_rcp_f32 v179, v179
    v_rcp_f32 v180, v180
    v_rcp_f32 v181, v181
    s_waitcnt vmcnt(33)
    v_mfma_f32_32x32x16_bf16 v[112:127], a[208:211], v[236:239], v[112:127]
    v_rcp_f32 v182, v182
    v_rcp_f32 v183, v183
    v_mul_f32 v96, v96, v176
    v_mul_f32 v97, v97, v177
    v_mul_f32 v98, v98, v178
    v_mfma_f32_32x32x16_bf16 v[112:127], a[96:99], v[252:255], v[112:127]
    v_mul_f32 v99, v99, v179
    v_mul_f32 v100, v100, v180
    v_mul_f32 v101, v101, v181
    v_mul_f32 v102, v102, v182
    v_mul_f32_e64 v103, v103, v183
    v_cvt_pk_bf16_f32 v104, v96, v97
    v_cvt_pk_bf16_f32 v105, v98, v99
    v_cvt_pk_bf16_f32 v106, v100, v101
    v_cvt_pk_bf16_f32 v107, v102, v103
    buffer_store_dwordx4 v[104:107], v1, s[32:35], s91 offen offset:3072 sc1
    s_add_u32 s76, s91, 114688
    s_nop 0
    s_nop 0
    v_pk_mul_f32 v[176:177], v[112:113], v[112:113]
    v_pk_mul_f32 v[178:179], v[114:115], v[114:115]
    v_pk_mul_f32 v[180:181], v[116:117], v[116:117]
    v_pk_mul_f32 v[182:183], v[118:119], v[118:119]
    v_pk_fma_f32 v[176:177], v[176:177], v[248:249], v[248:249] op_sel:[0,1,0] op_sel_hi:[1,1,0]
    v_pk_fma_f32 v[178:179], v[178:179], v[248:249], v[248:249] op_sel:[0,1,0] op_sel_hi:[1,1,0]
    v_pk_fma_f32 v[180:181], v[180:181], v[248:249], v[248:249] op_sel:[0,1,0] op_sel_hi:[1,1,0]
    v_pk_fma_f32 v[182:183], v[182:183], v[248:249], v[248:249] op_sel:[0,1,0] op_sel_hi:[1,1,0]
    v_pk_mul_f32 v[176:177], v[176:177], v[112:113]
    v_pk_mul_f32 v[178:179], v[178:179], v[114:115]
    v_pk_mul_f32 v[180:181], v[180:181], v[116:117]
    v_pk_mul_f32 v[182:183], v[182:183], v[118:119]
    v_pk_mul_f32 v[112:113], v[112:113], v[120:121]
    v_pk_mul_f32 v[114:115], v[114:115], v[122:123]
    v_pk_mul_f32 v[116:117], v[116:117], v[124:125]
    v_pk_mul_f32 v[118:119], v[118:119], v[126:127]
    v_mfma_f32_32x32x16_bf16 v[128:143], a[132:135], v[196:199], v[128:143]
    v_exp_f32 v176, v176
    v_exp_f32 v177, v177
    v_exp_f32 v178, v178
    v_exp_f32 v179, v179
    v_mfma_f32_32x32x16_bf16 v[128:143], a[148:151], v[204:207], v[128:143]
    v_exp_f32 v180, v180
    v_exp_f32 v181, v181
    v_exp_f32 v182, v182
    v_exp_f32 v183, v183
    v_mfma_f32_32x32x16_bf16 v[128:143], a[164:167], v[212:215], v[128:143]
    v_fma_f32 v176, v176, v250, v250
    v_fma_f32 v177, v177, v250, v250
    v_fma_f32 v178, v178, v250, v250
    v_fma_f32 v179, v179, v250, v250
    v_fma_f32 v180, v180, v250, v250
    v_fma_f32 v181, v181, v250, v250
    v_mfma_f32_32x32x16_bf16 v[128:143], a[180:183], v[220:223], v[128:143]
    v_fma_f32 v182, v182, v250, v250
    v_fma_f32 v183, v183, v250, v250
    v_rcp_f32 v176, v176
    v_rcp_f32 v177, v177
    v_rcp_f32 v178, v178
    v_mfma_f32_32x32x16_bf16 v[128:143], a[196:199], v[228:231], v[128:143]
    v_rcp_f32 v179, v179
    v_rcp_f32 v180, v180
    v_rcp_f32 v181, v181
    v_mfma_f32_32x32x16_bf16 v[128:143], a[212:215], v[236:239], v[128:143]
    v_rcp_f32 v182, v182
    v_rcp_f32 v183, v183
    v_mul_f32 v112, v112, v176
    v_mul_f32 v113, v113, v177
    v_mul_f32 v114, v114, v178
    v_mfma_f32_32x32x16_bf16 v[128:143], a[98:101], v[252:255], v[128:143]
    v_mul_f32 v115, v115, v179
    v_mul_f32 v116, v116, v180
    v_mul_f32 v117, v117, v181
    v_mul_f32 v118, v118, v182
    v_mul_f32 v119, v119, v183
    v_cvt_pk_bf16_f32 v120, v112, v113
    v_cvt_pk_bf16_f32 v121, v114, v115
    v_cvt_pk_bf16_f32 v122, v116, v117
    v_cvt_pk_bf16_f32 v123, v118, v119
    buffer_store_dwordx4 v[120:123], v1, s[32:35], s76 offen offset:0 sc1
    s_nop 1
    s_nop 0
    v_pk_mul_f32 v[176:177], v[128:129], v[128:129]
    v_pk_mul_f32 v[178:179], v[130:131], v[130:131]
    v_pk_mul_f32 v[180:181], v[132:133], v[132:133]
    v_pk_mul_f32 v[182:183], v[134:135], v[134:135]
    v_pk_fma_f32 v[176:177], v[176:177], v[248:249], v[248:249] op_sel:[0,1,0] op_sel_hi:[1,1,0]
    v_pk_fma_f32 v[178:179], v[178:179], v[248:249], v[248:249] op_sel:[0,1,0] op_sel_hi:[1,1,0]
    v_pk_fma_f32 v[180:181], v[180:181], v[248:249], v[248:249] op_sel:[0,1,0] op_sel_hi:[1,1,0]
    v_pk_fma_f32 v[182:183], v[182:183], v[248:249], v[248:249] op_sel:[0,1,0] op_sel_hi:[1,1,0]
    v_pk_mul_f32 v[176:177], v[176:177], v[128:129]
    v_pk_mul_f32 v[178:179], v[178:179], v[130:131]
    v_pk_mul_f32 v[180:181], v[180:181], v[132:133]
    v_pk_mul_f32 v[182:183], v[182:183], v[134:135]
    v_pk_mul_f32 v[128:129], v[128:129], v[136:137]
    v_pk_mul_f32 v[130:131], v[130:131], v[138:139]
    v_pk_mul_f32 v[132:133], v[132:133], v[140:141]
    v_pk_mul_f32 v[134:135], v[134:135], v[142:143]
    v_mfma_f32_32x32x16_bf16 v[144:159], a[136:139], v[196:199], v[144:159]
    v_exp_f32 v176, v176
    v_exp_f32 v177, v177
    v_exp_f32 v178, v178
    v_exp_f32 v179, v179
    v_mfma_f32_32x32x16_bf16 v[144:159], a[152:155], v[204:207], v[144:159]
    v_exp_f32 v180, v180
    v_exp_f32 v181, v181
    v_exp_f32 v182, v182
    v_exp_f32 v183, v183
    v_mfma_f32_32x32x16_bf16 v[144:159], a[168:171], v[212:215], v[144:159]
    v_fma_f32 v176, v176, v250, v250
    v_fma_f32 v177, v177, v250, v250
    v_fma_f32 v178, v178, v250, v250
    v_fma_f32 v179, v179, v250, v250
    v_fma_f32 v180, v180, v250, v250
    v_fma_f32 v181, v181, v250, v250
    v_mfma_f32_32x32x16_bf16 v[144:159], a[184:187], v[220:223], v[144:159]
    v_fma_f32 v182, v182, v250, v250
    v_fma_f32 v183, v183, v250, v250
    v_rcp_f32 v176, v176
    v_rcp_f32 v177, v177
    v_rcp_f32 v178, v178
    v_mfma_f32_32x32x16_bf16 v[144:159], a[200:203], v[228:231], v[144:159]
    v_rcp_f32 v179, v179
    v_rcp_f32 v180, v180
    v_rcp_f32 v181, v181
    v_mfma_f32_32x32x16_bf16 v[144:159], a[216:219], v[236:239], v[144:159]
    v_rcp_f32 v182, v182
    v_rcp_f32 v183, v183
    v_mul_f32 v128, v128, v176
    v_mul_f32 v129, v129, v177
    v_mul_f32 v130, v130, v178
    v_mfma_f32_32x32x16_bf16 v[144:159], a[100:103], v[252:255], v[144:159]
    v_mul_f32 v131, v131, v179
    v_mul_f32 v132, v132, v180
    v_mul_f32 v133, v133, v181
    v_mul_f32 v134, v134, v182
    v_mul_f32 v135, v135, v183
    v_cvt_pk_bf16_f32 v136, v128, v129
    v_cvt_pk_bf16_f32 v137, v130, v131
    v_cvt_pk_bf16_f32 v138, v132, v133
    v_cvt_pk_bf16_f32 v139, v134, v135
    buffer_store_dwordx4 v[136:139], v1, s[32:35], s76 offen offset:1024 sc1
    v_mov_b32 v30, 1
    s_waitcnt vmcnt(2)
    s_cmp_lg_u32 s55, 0
    s_cbranch_scc1 L_slow_f22
    buffer_store_dword v30, v28, s[32:35], s92 offen offset:0
L_ret_f22:
    v_pk_mul_f32 v[176:177], v[144:145], v[144:145]
    v_pk_mul_f32 v[178:179], v[146:147], v[146:147]
    v_pk_mul_f32 v[180:181], v[148:149], v[148:149]
    v_pk_mul_f32 v[182:183], v[150:151], v[150:151]
    v_pk_fma_f32 v[176:177], v[176:177], v[248:249], v[248:249] op_sel:[0,1,0] op_sel_hi:[1,1,0]
    v_pk_fma_f32 v[178:179], v[178:179], v[248:249], v[248:249] op_sel:[0,1,0] op_sel_hi:[1,1,0]
    v_pk_fma_f32 v[180:181], v[180:181], v[248:249], v[248:249] op_sel:[0,1,0] op_sel_hi:[1,1,0]
    v_pk_fma_f32 v[182:183], v[182:183], v[248:249], v[248:249] op_sel:[0,1,0] op_sel_hi:[1,1,0]
    v_pk_mul_f32 v[176:177], v[176:177], v[144:145]
    v_pk_mul_f32 v[178:179], v[178:179], v[146:147]
    v_pk_mul_f32 v[180:181], v[180:181], v[148:149]
    v_pk_mul_f32 v[182:183], v[182:183], v[150:151]
    v_pk_mul_f32 v[144:145], v[144:145], v[152:153]
    v_pk_mul_f32 v[146:147], v[146:147], v[154:155]
    v_pk_mul_f32 v[148:149], v[148:149], v[156:157]
    v_pk_mul_f32 v[150:151], v[150:151], v[158:159]
    v_mfma_f32_32x32x16_bf16 v[160:175], a[140:143], v[196:199], v[160:175]
    v_exp_f32 v176, v176
    v_exp_f32 v177, v177
    v_exp_f32 v178, v178
    v_exp_f32 v179, v179
    v_mfma_f32_32x32x16_bf16 v[160:175], a[156:159], v[204:207], v[160:175]
    v_exp_f32 v180, v180
    v_exp_f32 v181, v181
    v_exp_f32 v182, v182
    v_exp_f32 v183, v183
    v_mfma_f32_32x32x16_bf16 v[160:175], a[172:175], v[212:215], v[160:175]
    v_fma_f32 v176, v176, v250, v250
    v_fma_f32 v177, v177, v250, v250
    v_fma_f32 v178, v178, v250, v250
    v_fma_f32 v179, v179, v250, v250
    v_fma_f32 v180, v180, v250, v250
    v_fma_f32 v181, v181, v250, v250
    buffer_load_dword v17, v23, s[32:35], s93 offen offset:0 sc1
    v_mfma_f32_32x32x16_bf16 v[160:175], a[188:191], v[220:223], v[160:175]
    v_fma_f32 v182, v182, v250, v250
    v_fma_f32 v183, v183, v250, v250
    v_rcp_f32 v176, v176
    v_rcp_f32 v177, v177
    v_rcp_f32 v178, v178
    v_mfma_f32_32x32x16_bf16 v[160:175], a[204:207], v[228:231], v[160:175]
    v_rcp_f32 v179, v179
    v_rcp_f32 v180, v180
    v_rcp_f32 v181, v181
    v_mfma_f32_32x32x16_bf16 v[160:175], a[220:223], v[236:239], v[160:175]
    v_rcp_f32 v182, v182
    v_rcp_f32 v183, v183
    v_mul_f32 v144, v144, v176
    v_mul_f32 v145, v145, v177
    v_mul_f32 v146, v146, v178
    v_mfma_f32_32x32x16_bf16 v[160:175], a[102:105], v[252:255], v[160:175]
    v_mul_f32 v147, v147, v179
    v_mul_f32 v148, v148, v180
    v_mul_f32 v149, v149, v181
    v_mul_f32 v150, v150, v182
    v_mul_f32 v151, v151, v183
    v_cvt_pk_bf16_f32 v152, v144, v145
    v_cvt_pk_bf16_f32 v153, v146, v147
    v_cvt_pk_bf16_f32 v154, v148, v149
    v_cvt_pk_bf16_f32 v155, v150, v151
    buffer_store_dwordx4 v[152:155], v1, s[32:35], s76 offen offset:2048 sc1
    s_nop 1
    s_nop 0
    v_pk_mul_f32 v[176:177], v[160:161], v[160:161]
    v_pk_mul_f32 v[178:179], v[162:163], v[162:163]
    v_pk_mul_f32 v[180:181], v[164:165], v[164:165]
    v_pk_mul_f32 v[182:183], v[166:167], v[166:167]
    v_pk_fma_f32 v[176:177], v[176:177], v[248:249], v[248:249] op_sel:[0,1,0] op_sel_hi:[1,1,0]
    v_pk_fma_f32 v[178:179], v[178:179], v[248:249], v[248:249] op_sel:[0,1,0] op_sel_hi:[1,1,0]
    v_pk_fma_f32 v[180:181], v[180:181], v[248:249], v[248:249] op_sel:[0,1,0] op_sel_hi:[1,1,0]
    v_pk_fma_f32 v[182:183], v[182:183], v[248:249], v[248:249] op_sel:[0,1,0] op_sel_hi:[1,1,0]
    v_pk_mul_f32 v[176:177], v[176:177], v[160:161]
    v_pk_mul_f32 v[178:179], v[178:179], v[162:163]
    v_pk_mul_f32 v[180:181], v[180:181], v[164:165]
    v_pk_mul_f32 v[182:183], v[182:183], v[166:167]
    v_pk_mul_f32 v[160:161], v[160:161], v[168:169]
    v_pk_mul_f32 v[162:163], v[162:163], v[170:171]
    v_pk_mul_f32 v[164:165], v[164:165], v[172:173]
    v_pk_mul_f32 v[166:167], v[166:167], v[174:175]
    v_exp_f32 v176, v176
    v_exp_f32 v177, v177
    v_exp_f32 v178, v178
    v_exp_f32 v179, v179
    s_waitcnt vmcnt(1)
    v_cmp_eq_u32 vcc, 0, v17
    s_nop 0
    s_cbranch_vccnz L_redo24
L_done23:
    s_add_u32 s58, s94, 0
    buffer_load_dwordx4 v[48:51], v1, s[32:35], s58 offen offset:0 sc1
    v_exp_f32 v180, v180
    v_exp_f32 v181, v181
    v_exp_f32 v182, v182
    v_exp_f32 v183, v183
    v_pk_fma_f32 v[176:177], v[176:177], v[250:251], v[250:251] op_sel_hi:[1,0,0]
    buffer_load_dwordx4 v[52:55], v1, s[32:35], s58 offen offset:1024 sc1
    v_pk_fma_f32 v[178:179], v[178:179], v[250:251], v[250:251] op_sel_hi:[1,0,0]
    v_pk_fma_f32 v[180:181], v[180:181], v[250:251], v[250:251] op_sel_hi:[1,0,0]
    v_pk_fma_f32 v[182:183], v[182:183], v[250:251], v[250:251] op_sel_hi:[1,0,0]
    v_rcp_f32 v176, v176
    v_rcp_f32 v177, v177
    v_rcp_f32 v178, v178
    buffer_load_dwordx4 v[56:59], v1, s[32:35], s58 offen offset:2048 sc1
    v_rcp_f32 v179, v179
    v_rcp_f32 v180, v180
    v_rcp_f32 v181, v181
    v_rcp_f32 v182, v182
    buffer_load_dwordx4 v[60:63], v1, s[32:35], s58 offen offset:3072 sc1
    v_rcp_f32_e64 v183, v183
    v_pk_mul_f32 v[160:161], v[160:161], v[176:177]
    v_pk_mul_f32 v[162:163], v[162:163], v[178:179]
    v_pk_mul_f32 v[164:165], v[164:165], v[180:181]
    v_pk_mul_f32 v[166:167], v[166:167], v[182:183]
    v_cvt_pk_bf16_f32 v168, v160, v161
    v_cvt_pk_bf16_f32 v169, v162, v163
    v_cvt_pk_bf16_f32 v170, v164, v165
    v_cvt_pk_bf16_f32 v171, v166, v167
    buffer_store_dwordx4 v[168:171], v1, s[32:35], s76 offen offset:3072 sc1
L_k4_0:
    s_add_u32 s58, s94, 4096
    buffer_load_dwordx4 v[64:67], v1, s[32:35], s58 offen offset:0 sc1
    buffer_load_dwordx4 v[68:71], v1, s[32:35], s58 offen offset:1024 sc1
    buffer_load_dwordx4 v[72:75], v1, s[32:35], s58 offen offset:2048 sc1
    buffer_load_dwordx4 v[76:79], v1, s[32:35], s58 offen offset:3072 sc1
    s_add_u32 s58, s94, 8192
    buffer_load_dwordx4 v[80:83], v1, s[32:35], s58 offen offset:0 sc1
    buffer_load_dwordx4 v[84:87], v1, s[32:35], s58 offen offset:1024 sc1
    buffer_load_dwordx4 v[88:91], v1, s[32:35], s58 offen offset:2048 sc1
    buffer_load_dwordx4 v[92:95], v1, s[32:35], s58 offen offset:3072 sc1
    v_add_u32 v24, 65536, v18
    v_add_u32 v25, 65536, v19
    s_waitcnt vmcnt(12)
    v_mfma_f32_32x32x16_bf16 v[144:159], a[4:7], v[48:51], 0
    s_add_u32 s58, s94, 12288
    buffer_load_dwordx4 v[96:99], v1, s[32:35], s58 offen offset:0 sc1
    v_mfma_f32_32x32x16_bf16 v[112:127], a[0:3], v[48:51], 0
    s_and_b32 s57, s48, 2
    s_waitcnt vmcnt(12)
    v_mfma_f32_32x32x16_bf16 v[144:159], a[12:15], v[52:55], v[144:159]
    buffer_load_dwordx4 v[100:103], v1, s[32:35], s58 offen offset:1024 sc1
    v_mfma_f32_32x32x16_bf16 v[112:127], a[8:11], v[52:55], v[112:127]
    s_lshl_b32 s57, s57, 14
    ds_read_b64_tr_b16 a[80:81], v18 offset:6144
    ds_read_b64_tr_b16 a[82:83], v18 offset:6656
    ds_read_b64_tr_b16 a[84:85], v19 offset:6144
    ds_read_b64_tr_b16 a[86:87], v19 offset:6656
    s_waitcnt vmcnt(12)
    v_mfma_f32_32x32x16_bf16 v[144:159], a[20:23], v[56:59], v[144:159]
    buffer_load_dwordx4 v[104:107], v1, s[32:35], s58 offen offset:2048 sc1
    v_mfma_f32_32x32x16_bf16 v[112:127], a[16:19], v[56:59], v[112:127]
    v_mov_b32 v30, 1
    s_waitcnt vmcnt(11)
    s_cmp_lg_u32 s55, 0
    s_cbranch_scc1 L_slow_f29
    buffer_store_dword v30, v28, s[36:39], s92 offen offset:128
L_ret_f29:
    s_and_b32 s76, s48, 1
    ds_read_b64_tr_b16 a[88:89], v20 offset:0
    ds_read_b64_tr_b16 a[90:91], v20 offset:512
    ds_read_b64_tr_b16 a[92:93], v21 offset:0
    ds_read_b64_tr_b16 a[94:95], v21 offset:512
    v_mfma_f32_32x32x16_bf16 v[144:159], a[28:31], v[60:63], v[144:159]
    buffer_load_dwordx4 v[108:111], v1, s[32:35], s58 offen offset:3072 sc1
    v_mfma_f32_32x32x16_bf16 v[112:127], a[24:27], v[60:63], v[112:127]
    s_lshl_b32 s76, s76, 12
    ds_read_b64_tr_b16 a[96:97], v20 offset:2048
    ds_read_b64_tr_b16 a[98:99], v20 offset:2560
    ds_read_b64_tr_b16 a[100:101], v21 offset:2048
    ds_read_b64_tr_b16 a[102:103], v21 offset:2560
    s_waitcnt vmcnt(12)
    v_mfma_f32_32x32x16_bf16 v[144:159], a[36:39], v[64:67], v[144:159]
    s_add_u32 s58, s94, 16384
    buffer_load_dwordx4 v[176:179], v1, s[32:35], s58 offen offset:0 sc1
    v_mfma_f32_32x32x16_bf16 v[112:127], a[32:35], v[64:67], v[112:127]
    s_add_u32 s57, s57, s76
    ds_read_b64_tr_b16 a[104:105], v20 offset:4096
    ds_read_b64_tr_b16 a[106:107], v20 offset:4608
    ds_read_b64_tr_b16 a[108:109], v21 offset:4096
    ds_read_b64_tr_b16 a[110:111], v21 offset:4608
    s_waitcnt vmcnt(12)
    v_mfma_f32_32x32x16_bf16 v[144:159], a[44:47], v[68:71], v[144:159]
    buffer_load_dwordx4 v[180:183], v1, s[32:35], s58 offen offset:1024 sc1
    v_mfma_f32_32x32x16_bf16 v[112:127], a[40:43], v[68:71], v[112:127]
    v_add_u32_e64 v12, s57, v1
    ds_read_b64_tr_b16 a[112:113], v18 offset:32768
    ds_read_b64_tr_b16 a[114:115], v18 offset:33280
    ds_read_b64_tr_b16 a[116:117], v19 offset:32768
    ds_read_b64_tr_b16 a[118:119], v19 offset:33280
    s_waitcnt vmcnt(12)
    v_mfma_f32_32x32x16_bf16 v[144:159], a[52:55], v[72:75], v[144:159]
    buffer_load_dwordx4 v[184:187], v1, s[32:35], s58 offen offset:2048 sc1
    v_mfma_f32_32x32x16_bf16 v[112:127], a[48:51], v[72:75], v[112:127]
    v_xor_b32 v13, 0x5000, v12
    ds_read_b64_tr_b16 a[120:121], v18 offset:34816
    ds_read_b64_tr_b16 a[122:123], v18 offset:35328
    ds_read_b64_tr_b16 a[124:125], v19 offset:34816
    ds_read_b64_tr_b16 a[126:127], v19 offset:35328
    s_waitcnt vmcnt(12)
    v_mfma_f32_32x32x16_bf16 v[144:159], a[60:63], v[76:79], v[144:159]
    buffer_load_dwordx4 v[188:191], v1, s[32:35], s58 offen offset:3072 sc1
    v_mfma_f32_32x32x16_bf16 v[112:127], a[56:59], v[76:79], v[112:127]
    v_xor_b32 v14, 0xa000, v12
    ds_read_b64_tr_b16 a[128:129], v18 offset:36864
    ds_read_b64_tr_b16 a[130:131], v18 offset:37376
    ds_read_b64_tr_b16 a[132:133], v19 offset:36864
    ds_read_b64_tr_b16 a[134:135], v19 offset:37376
    s_waitcnt vmcnt(12)
    v_mfma_f32_32x32x16_bf16 v[144:159], a[68:71], v[80:83], v[144:159]
    s_add_u32 s58, s94, 20480
    buffer_load_dwordx4 v[192:195], v1, s[32:35], s58 offen offset:0 sc1
    v_mfma_f32_32x32x16_bf16 v[112:127], a[64:67], v[80:83], v[112:127]
    v_xor_b32 v15, 0xf000, v12
    ds_read_b64_tr_b16 a[136:137], v18 offset:38912
    ds_read_b64_tr_b16 a[138:139], v18 offset:39424
    ds_read_b64_tr_b16 a[140:141], v19 offset:38912
    ds_read_b64_tr_b16 a[142:143], v19 offset:39424
    s_waitcnt vmcnt(12)
    v_mfma_f32_32x32x16_bf16 v[144:159], a[76:79], v[84:87], v[144:159]
    buffer_load_dwordx4 v[196:199], v1, s[32:35], s58 offen offset:1024 sc1
    v_mfma_f32_32x32x16_bf16 v[112:127], a[72:75], v[84:87], v[112:127]
    s_lshl_b32 s57, s48, 14
    ds_read_b64_tr_b16 a[144:145], v24 offset:32768
    ds_read_b64_tr_b16 a[146:147], v24 offset:33280
    ds_read_b64_tr_b16 a[148:149], v25 offset:32768
    ds_read_b64_tr_b16 a[150:151], v25 offset:33280
    s_waitcnt vmcnt(12) lgkmcnt(14)
    v_mfma_f32_32x32x16_bf16 v[144:159], a[84:87], v[88:91], v[144:159]
    buffer_load_dword v17, v23, s[32:35], s93 offen offset:128 sc1
    buffer_load_dwordx4 v[200:203], v1, s[32:35], s58 offen offset:2048 sc1
    v_mfma_f32_32x32x16_bf16 v[112:127], a[80:83], v[88:91], v[112:127]
    v_add_u32_e64 v16, s57, v1
    ds_read_b64_tr_b16 a[152:153], v24 offset:34816
    ds_read_b64_tr_b16 a[154:155], v24 offset:35328
    ds_read_b64_tr_b16 a[156:157], v25 offset:34816
    ds_read_b64_tr_b16 a[158:159], v25 offset:35328
    s_waitcnt vmcnt(13)
    v_mfma_f32_32x32x16_bf16 v[144:159], a[92:95], v[92:95], v[144:159]
    buffer_load_dwordx4 v[204:207], v1, s[32:35], s58 offen offset:3072 sc1
    v_mfma_f32_32x32x16_bf16 v[112:127], a[88:91], v[92:95], v[112:127]
    ds_read_b64_tr_b16 a[160:161], v24 offset:36864
    ds_read_b64_tr_b16 a[162:163], v24 offset:37376
    ds_read_b64_tr_b16 a[164:165], v25 offset:36864
    ds_read_b64_tr_b16 a[166:167], v25 offset:37376
    s_waitcnt vmcnt(13)
    v_mfma_f32_32x32x16_bf16 v[144:159], a[100:103], v[96:99], v[144:159]
    s_add_u32 s58, s94, 24576
    buffer_load_dwordx4 v[208:211], v1, s[32:35], s58 offen offset:0 sc1
    v_mfma_f32_32x32x16_bf16 v[112:127], a[96:99], v[96:99], v[112:127]
    ds_read_b64_tr_b16 a[168:169], v24 offset:38912
    ds_read_b64_tr_b16 a[170:171], v24 offset:39424
    ds_read_b64_tr_b16 a[172:173], v25 offset:38912
    ds_read_b64_tr_b16 a[174:175], v25 offset:39424
    s_waitcnt vmcnt(13)
    v_mfma_f32_32x32x16_bf16 v[144:159], a[108:111], v[100:103], v[144:159]
    buffer_load_dwordx4 v[212:215], v1, s[32:35], s58 offen offset:1024 sc1
    v_mfma_f32_32x32x16_bf16 v[112:127], a[104:107], v[100:103], v[112:127]
    ds_read_b64_tr_b16 a[176:177], v24 offset:0
    ds_read_b64_tr_b16 a[178:179], v24 offset:512
    ds_read_b64_tr_b16 a[180:181], v25 offset:0
    ds_read_b64_tr_b16 a[182:183], v25 offset:512
    s_waitcnt vmcnt(13)
    v_mfma_f32_32x32x16_bf16 v[144:159], a[116:119], v[104:107], v[144:159]
    buffer_load_dwordx4 v[216:219], v1, s[32:35], s58 offen offset:2048 sc1
    v_mfma_f32_32x32x16_bf16 v[112:127], a[112:115], v[104:107], v[112:127]
    ds_read_b64_tr_b16 a[184:185], v24 offset:2048
    ds_read_b64_tr_b16 a[186:187], v24 offset:2560
    ds_read_b64_tr_b16 a[188:189], v25 offset:2048
    ds_read_b64_tr_b16 a[190:191], v25 offset:2560
    s_waitcnt vmcnt(12) lgkmcnt(14)
    v_mfma_f32_32x32x16_bf16 v[144:159], a[124:127], v[108:111], v[144:159]
    buffer_load_dwordx4 v[220:223], v1, s[32:35], s58 offen offset:3072 sc1
    v_mfma_f32_32x32x16_bf16 v[112:127], a[120:123], v[108:111], v[112:127]
    ds_read_b64_tr_b16 a[192:193], v24 offset:4096
    ds_read_b64_tr_b16 a[194:195], v24 offset:4608
    ds_read_b64_tr_b16 a[196:197], v25 offset:4096
    ds_read_b64_tr_b16 a[198:199], v25 offset:4608
    s_waitcnt vmcnt(12)
    v_mfma_f32_32x32x16_bf16 v[144:159], a[132:135], v[176:179], v[144:159]
    s_waitcnt vmcnt(6)
    v_cmp_eq_u32 vcc, 0, v17
    s_nop 0
    s_cbranch_vccnz L_redo31
L_done30:
    s_add_u32 s58, s94, 114688
    buffer_load_dwordx4 v[224:227], v1, s[32:35], s58 offen offset:0 sc1
    v_mfma_f32_32x32x16_bf16 v[112:127], a[128:131], v[176:179], v[112:127]
    ds_read_b64_tr_b16 a[200:201], v24 offset:6144
    ds_read_b64_tr_b16 a[202:203], v24 offset:6656
    ds_read_b64_tr_b16 a[204:205], v25 offset:6144
    ds_read_b64_tr_b16 a[206:207], v25 offset:6656
    v_mfma_f32_32x32x16_bf16 v[144:159], a[140:143], v[180:183], v[144:159]
    buffer_load_dwordx4 v[228:231], v1, s[32:35], s58 offen offset:1024 sc1
    v_mfma_f32_32x32x16_bf16 v[112:127], a[136:139], v[180:183], v[112:127]
    ds_read_b64_tr_b16 a[208:209], v18 offset:0
    ds_read_b64_tr_b16 a[210:211], v18 offset:512
    ds_read_b64_tr_b16 a[212:213], v19 offset:0
    ds_read_b64_tr_b16 a[214:215], v19 offset:512
    v_mfma_f32_32x32x16_bf16 v[144:159], a[148:151], v[184:187], v[144:159]
    buffer_load_dwordx4 v[232:235], v1, s[32:35], s58 offen offset:2048 sc1
    v_mfma_f32_32x32x16_bf16 v[112:127], a[144:147], v[184:187], v[112:127]
    ds_read_b64_tr_b16 a[216:217], v18 offset:2048
    ds_read_b64_tr_b16 a[218:219], v18 offset:2560
    ds_read_b64_tr_b16 a[220:221], v19 offset:2048
    ds_read_b64_tr_b16 a[222:223], v19 offset:2560
    v_mfma_f32_32x32x16_bf16 v[144:159], a[156:159], v[188:191], v[144:159]
    buffer_load_dwordx4 v[236:239], v1, s[32:35], s58 offen offset:3072 sc1
    v_mfma_f32_32x32x16_bf16 v[112:127], a[152:155], v[188:191], v[112:127]
    s_waitcnt lgkmcnt(14)
    v_mfma_f32_32x32x16_bf16 v[144:159], a[164:167], v[192:195], v[144:159]
    s_add_u32 s58, s94, 118784
    buffer_load_dwordx4 v[240:243], v1, s[32:35], s58 offen offset:0 sc1
    v_mfma_f32_32x32x16_bf16 v[112:127], a[160:163], v[192:195], v[112:127]
    v_mfma_f32_32x32x16_bf16 v[144:159], a[172:175], v[196:199], v[144:159]
    buffer_load_dwordx4 v[244:247], v1, s[32:35], s58 offen offset:1024 sc1
    v_mfma_f32_32x32x16_bf16 v[112:127], a[168:171], v[196:199], v[112:127]
    s_waitcnt vmcnt(11)
    v_mfma_f32_32x32x16_bf16 v[144:159], a[180:183], v[200:203], v[144:159]
    buffer_load_dwordx4 v[248:251], v1, s[32:35], s58 offen offset:2048 sc1
    v_mfma_f32_32x32x16_bf16 v[112:127], a[176:179], v[200:203], v[112:127]
    s_waitcnt vmcnt(11)
    v_mfma_f32_32x32x16_bf16 v[144:159], a[188:191], v[204:207], v[144:159]
    buffer_load_dwordx4 v[252:255], v1, s[32:35], s58 offen offset:3072 sc1
    v_mfma_f32_32x32x16_bf16 v[112:127], a[184:187], v[204:207], v[112:127]
    s_waitcnt vmcnt(11) lgkmcnt(12)
    v_mfma_f32_32x32x16_bf16 v[144:159], a[196:199], v[208:211], v[144:159]
    s_add_u32 s58, s94, 122880
    buffer_load_dwordx4 v[48:51], v1, s[32:35], s58 offen offset:0 sc1
    v_mfma_f32_32x32x16_bf16 v[112:127], a[192:195], v[208:211], v[112:127]
    s_waitcnt lgkmcnt(0)
    s_barrier
    s_waitcnt vmcnt(11)
    v_mfma_f32_32x32x16_bf16 v[144:159], a[204:207], v[212:215], v[144:159]
    buffer_load_dwordx4 v[52:55], v1, s[32:35], s58 offen offset:1024 sc1
    v_mfma_f32_32x32x16_bf16 v[112:127], a[200:203], v[212:215], v[112:127]
    s_waitcnt vmcnt(11)
    v_mfma_f32_32x32x16_bf16 v[144:159], a[212:215], v[216:219], v[144:159]
    buffer_load_dwordx4 v[56:59], v1, s[32:35], s58 offen offset:2048 sc1
    v_mfma_f32_32x32x16_bf16 v[112:127], a[208:211], v[216:219], v[112:127]
    s_add_u32 s57, s63, 10240
    v_mov_b32 v18, 0
    buffer_load_dword v19, v18, s[32:35], s57 offen offset:0 sc1
    s_waitcnt vmcnt(12)
    v_mfma_f32_32x32x16_bf16 v[144:159], a[220:223], v[220:223], v[144:159]
    buffer_load_dwordx4 v[60:63], v1, s[32:35], s58 offen offset:3072 sc1
    v_mfma_f32_32x32x16_bf16 v[112:127], a[216:219], v[220:223], v[112:127]
    s_waitcnt vmcnt(12)
    v_mfma_f32_32x32x16_bf16 v[160:175], a[4:7], v[224:227], 0
    s_add_u32 s58, s94, 126976
    buffer_load_dwordx4 v[64:67], v1, s[32:35], s58 offen offset:0 sc1
    v_mfma_f32_32x32x16_bf16 v[128:143], a[0:3], v[224:227], 0
    s_waitcnt vmcnt(12)
    v_mfma_f32_32x32x16_bf16 v[160:175], a[12:15], v[228:231], v[160:175]
    buffer_load_dwordx4 v[68:71], v1, s[32:35], s58 offen offset:1024 sc1
    v_mfma_f32_32x32x16_bf16 v[128:143], a[8:11], v[228:231], v[128:143]
    s_waitcnt vmcnt(12)
    v_mfma_f32_32x32x16_bf16 v[160:175], a[20:23], v[232:235], v[160:175]
    buffer_load_dwordx4 v[72:75], v1, s[32:35], s58 offen offset:2048 sc1
    v_mfma_f32_32x32x16_bf16 v[128:143], a[16:19], v[232:235], v[128:143]
    buffer_load_dword v30, v0, s[32:35], 0 offen sc1
    s_waitcnt vmcnt(13)
    v_mfma_f32_32x32x16_bf16 v[160:175], a[28:31], v[236:239], v[160:175]
    buffer_load_dwordx4 v[76:79], v1, s[32:35], s58 offen offset:3072 sc1
    v_mfma_f32_32x32x16_bf16 v[128:143], a[24:27], v[236:239], v[128:143]
    s_waitcnt vmcnt(13)
    v_mfma_f32_32x32x16_bf16 v[160:175], a[36:39], v[240:243], v[160:175]
    s_add_u32 s58, s94, 131072
    buffer_load_dwordx4 v[80:83], v1, s[32:35], s58 offen offset:0 sc1
    v_mfma_f32_32x32x16_bf16 v[128:143], a[32:35], v[240:243], v[128:143]
    ds_write_b128 v14, v[144:147] offset:0
    s_waitcnt vmcnt(13)
    v_mfma_f32_32x32x16_bf16 v[160:175], a[44:47], v[244:247], v[160:175]
    buffer_load_dwordx4 v[84:87], v1, s[32:35], s58 offen offset:1024 sc1
    v_mfma_f32_32x32x16_bf16 v[128:143], a[40:43], v[244:247], v[128:143]
    ds_write_b128 v14, v[148:151] offset:1024
    s_waitcnt vmcnt(13)
    v_mfma_f32_32x32x16_bf16 v[160:175], a[52:55], v[248:251], v[160:175]
    buffer_load_dwordx4 v[88:91], v1, s[32:35], s58 offen offset:2048 sc1
    v_mfma_f32_32x32x16_bf16 v[128:143], a[48:51], v[248:251], v[128:143]
    ds_write_b128 v14, v[152:155] offset:2048
    s_waitcnt vmcnt(13)
    v_mfma_f32_32x32x16_bf16 v[160:175], a[60:63], v[252:255], v[160:175]
    buffer_load_dwordx4 v[92:95], v1, s[32:35], s58 offen offset:3072 sc1
    v_mfma_f32_32x32x16_bf16 v[128:143], a[56:59], v[252:255], v[128:143]
    ds_write_b128 v14, v[156:159] offset:3072
    s_waitcnt vmcnt(13)
    v_mfma_f32_32x32x16_bf16 v[160:175], a[68:71], v[48:51], v[160:175]
    s_add_u32 s58, s94, 135168
    buffer_load_dwordx4 v[96:99], v1, s[32:35], s58 offen offset:0 sc1
    v_mfma_f32_32x32x16_bf16 v[128:143], a[64:67], v[48:51], v[128:143]
    s_bitcmp1_b32 s48, 0
    s_cbranch_scc1 L_slow_a33
    v_add_f32 v32, v32, v112
    v_add_f32 v33, v33, v113
    v_add_f32 v34, v34, v114
    v_add_f32 v35, v35, v115
    s_branch L_ret_a33
L_slow_a33:
    ds_write_b128 v12, v[112:115] offset:0
L_ret_a33:
    s_waitcnt vmcnt(13)
    v_mfma_f32_32x32x16_bf16 v[160:175], a[76:79], v[52:55], v[160:175]
    buffer_load_dwordx4 v[100:103], v1, s[32:35], s58 offen offset:1024 sc1
    v_mfma_f32_32x32x16_bf16 v[128:143], a[72:75], v[52:55], v[128:143]
    s_bitcmp1_b32 s48, 0
    s_cbranch_scc1 L_slow_a34
    v_add_f32 v36, v36, v116
    v_add_f32 v37, v37, v117
    v_add_f32 v38, v38, v118
    v_add_f32 v39, v39, v119
    s_branch L_ret_a34
L_slow_a34:
    ds_write_b128 v12, v[116:119] offset:1024
L_ret_a34:
    s_waitcnt vmcnt(13)
    v_mfma_f32_32x32x16_bf16 v[160:175], a[84:87], v[56:59], v[160:175]
    buffer_load_dwordx4 v[104:107], v1, s[32:35], s58 offen offset:2048 sc1
    v_mfma_f32_32x32x16_bf16 v[128:143], a[80:83], v[56:59], v[128:143]
    s_bitcmp1_b32 s48, 0
    s_cbranch_scc1 L_slow_a35
    v_add_f32 v40, v40, v120
    v_add_f32 v41, v41, v121
    v_add_f32 v42, v42, v122
    v_add_f32 v43, v43, v123
    s_branch L_ret_a35
L_slow_a35:
    ds_write_b128 v12, v[120:123] offset:2048
L_ret_a35:
    s_waitcnt vmcnt(12)
    v_mfma_f32_32x32x16_bf16 v[160:175], a[92:95], v[60:63], v[160:175]
    buffer_load_dwordx4 v[108:111], v1, s[32:35], s58 offen offset:3072 sc1
    v_mfma_f32_32x32x16_bf16 v[128:143], a[88:91], v[60:63], v[128:143]
    s_bitcmp1_b32 s48, 0
    s_cbranch_scc1 L_slow_a36
    v_add_f32 v44, v44, v124
    v_add_f32 v45, v45, v125
    v_add_f32 v46, v46, v126
    v_add_f32 v47, v47, v127
    s_branch L_ret_a36
L_slow_a36:
    ds_write_b128 v12, v[124:127] offset:3072
L_ret_a36:
    s_waitcnt vmcnt(12)
    v_mfma_f32_32x32x16_bf16 v[160:175], a[100:103], v[64:67], v[160:175]
    s_add_u32 s58, s94, 139264
    buffer_load_dwordx4 v[176:179], v1, s[32:35], s58 offen offset:0 sc1
    v_mfma_f32_32x32x16_bf16 v[128:143], a[96:99], v[64:67], v[128:143]
    v_and_b32 v29, 63, v19
    v_cmp_ne_u32 vcc, 16, v29
    s_nop 0
    s_cbranch_vccnz L_redo38
L_done37:
    s_waitcnt vmcnt(12)
    v_mfma_f32_32x32x16_bf16 v[160:175], a[108:111], v[68:71], v[160:175]
    buffer_load_dwordx4 v[180:183], v1, s[32:35], s58 offen offset:1024 sc1
    v_mfma_f32_32x32x16_bf16 v[128:143], a[104:107], v[68:71], v[128:143]
    s_waitcnt vmcnt(12)
    v_mfma_f32_32x32x16_bf16 v[160:175], a[116:119], v[72:75], v[160:175]
    buffer_load_dwordx4 v[184:187], v1, s[32:35], s58 offen offset:2048 sc1
    v_mfma_f32_32x32x16_bf16 v[128:143], a[112:115], v[72:75], v[128:143]
    s_waitcnt vmcnt(11)
    v_mfma_f32_32x32x16_bf16 v[160:175], a[124:127], v[76:79], v[160:175]
    buffer_load_dwordx4 v[188:191], v1, s[32:35], s58 offen offset:3072 sc1
    v_mfma_f32_32x32x16_bf16 v[128:143], a[120:123], v[76:79], v[128:143]
    s_waitcnt vmcnt(11)
    v_mfma_f32_32x32x16_bf16 v[160:175], a[132:135], v[80:83], v[160:175]
    s_add_u32 s0, s71, 0
    s_and_b32 s0, s0, 0x7000
    s_add_u32 m0, s69, 65536
    s_lshl1_add_u32 s0, s0, s74
    buffer_load_dwordx4 v1, s[32:35], s0 offen sc1 lds
    v_mfma_f32_32x32x16_bf16 v[128:143], a[128:131], v[80:83], v[128:143]
    s_waitcnt vmcnt(11)
    v_mfma_f32_32x32x16_bf16 v[160:175], a[140:143], v[84:87], v[160:175]
    buffer_load_dwordx4 v1, s[32:35], s0 offen offset:1024 sc1 lds
    v_mfma_f32_32x32x16_bf16 v[128:143], a[136:139], v[84:87], v[128:143]
    s_waitcnt vmcnt(11)
    v_mfma_f32_32x32x16_bf16 v[160:175], a[148:151], v[88:91], v[160:175]
    s_add_u32 s0, s71, 4096
    s_and_b32 s0, s0, 0x7000
    s_add_u32 m0, s69, 73728
    s_lshl1_add_u32 s0, s0, s74
    buffer_load_dwordx4 v1, s[32:35], s0 offen sc1 lds
    v_mfma_f32_32x32x16_bf16 v[128:143], a[144:147], v[88:91], v[128:143]
    s_waitcnt vmcnt(11)
    v_mfma_f32_32x32x16_bf16 v[160:175], a[156:159], v[92:95], v[160:175]
    buffer_load_dwordx4 v1, s[32:35], s0 offen offset:1024 sc1 lds
    v_mfma_f32_32x32x16_bf16 v[128:143], a[152:155], v[92:95], v[128:143]
    s_waitcnt vmcnt(11)
    v_mfma_f32_32x32x16_bf16 v[160:175], a[164:167], v[96:99], v[160:175]
    s_add_u32 s0, s71, 8192
    s_and_b32 s0, s0, 0x7000
    s_add_u32 m0, s69, 81920
    s_lshl1_add_u32 s0, s0, s74
    buffer_load_dwordx4 v1, s[32:35], s0 offen sc1 lds
    v_mfma_f32_32x32x16_bf16 v[128:143], a[160:163], v[96:99], v[128:143]
    s_waitcnt vmcnt(11)
    v_mfma_f32_32x32x16_bf16 v[160:175], a[172:175], v[100:103], v[160:175]
    buffer_load_dwordx4 v1, s[32:35], s0 offen offset:1024 sc1 lds
    v_mfma_f32_32x32x16_bf16 v[128:143], a[168:171], v[100:103], v[128:143]
    s_waitcnt vmcnt(11)
    v_mfma_f32_32x32x16_bf16 v[160:175], a[180:183], v[104:107], v[160:175]
    s_add_u32 s0, s71, 12288
    s_and_b32 s0, s0, 0x7000
    s_add_u32 m0, s69, 90112
    s_lshl1_add_u32 s0, s0, s74
    buffer_load_dwordx4 v1, s[32:35], s0 offen sc1 lds
    v_mfma_f32_32x32x16_bf16 v[128:143], a[176:179], v[104:107], v[128:143]
    s_waitcnt vmcnt(11)
    v_mfma_f32_32x32x16_bf16 v[160:175], a[188:191], v[108:111], v[160:175]
    buffer_load_dwordx4 v1, s[32:35], s0 offen offset:1024 sc1 lds
    s_waitcnt vmcnt(11)
    v_mfma_f32_32x32x16_bf16 v[160:175], a[196:199], v[176:179], v[160:175]
    s_add_u32 s0, s71, 16384
    s_and_b32 s0, s0, 0x7000
    s_add_u32 m0, s69, 98304
    s_lshl1_add_u32 s0, s0, s74
    buffer_load_dwordx4 v1, s[32:35], s0 offen sc1 lds
    s_waitcnt vmcnt(11)
    v_mfma_f32_32x32x16_bf16 v[160:175], a[204:207], v[180:183], v[160:175]
    buffer_load_dwordx4 v1, s[32:35], s0 offen offset:1024 sc1 lds
    s_waitcnt vmcnt(11)
    v_mfma_f32_32x32x16_bf16 v[160:175], a[212:215], v[184:187], v[160:175]
    s_add_u32 s0, s71, 20480
    s_and_b32 s0, s0, 0x7000
    s_add_u32 m0, s69, 106496
    s_lshl1_add_u32 s0, s0, s74
    buffer_load_dwordx4 v1, s[32:35], s0 offen sc1 lds
    s_waitcnt vmcnt(11)
    v_mfma_f32_32x32x16_bf16 v[160:175], a[220:223], v[188:191], v[160:175]
    buffer_load_dwordx4 v1, s[32:35], s0 offen offset:1024 sc1 lds
    v_mfma_f32_32x32x16_bf16 v[128:143], a[184:187], v[108:111], v[128:143]
    v_mfma_f32_32x32x16_bf16 v[128:143], a[192:195], v[176:179], v[128:143]
    ds_write_b128 v15, v[160:163] offset:0
    v_mfma_f32_32x32x16_bf16 v[128:143], a[200:203], v[180:183], v[128:143]
    ds_write_b128 v15, v[164:167] offset:1024
    v_mfma_f32_32x32x16_bf16 v[128:143], a[208:211], v[184:187], v[128:143]
    ds_write_b128 v15, v[168:171] offset:2048
    v_mfma_f32_32x32x16_bf16 v[128:143], a[216:219], v[188:191], v[128:143]
    ds_write_b128 v15, v[172:175] offset:3072
    s_bitcmp0_b32 s48, 0
    s_cbranch_scc1 L_slow_a40
    s_nop 8
    v_pk_add_f32 v[32:33], v[32:33], v[128:129]
    v_pk_add_f32 v[34:35], v[34:35], v[130:131]
    v_pk_add_f32 v[36:37], v[36:37], v[132:133]
    v_pk_add_f32 v[38:39], v[38:39], v[134:135]
    v_pk_add_f32 v[40:41], v[40:41], v[136:137]
    v_pk_add_f32 v[42:43], v[42:43], v[138:139]
    v_pk_add_f32 v[44:45], v[44:45], v[140:141]
    v_pk_add_f32 v[46:47], v[46:47], v[142:143]
    s_branch L_ret_a40
L_slow_a40:
    s_nop 8
    ds_write_b128 v13, v[128:131] offset:0
    ds_write_b128 v13, v[132:135] offset:1024
    ds_write_b128 v13, v[136:139] offset:2048
    ds_write_b128 v13, v[140:143] offset:3072
L_ret_a40:
    s_add_u32 s0, s71, 24576
    s_and_b32 s0, s0, 0x7000
    s_add_u32 m0, s69, 114688
    s_lshl1_add_u32 s0, s0, s74
    buffer_load_dwordx4 v1, s[32:35], s0 offen sc1 lds
    buffer_load_dwordx4 v1, s[32:35], s0 offen offset:1024 sc1 lds
    s_add_u32 s0, s71, 28672
    s_and_b32 s0, s0, 0x7000
    s_add_u32 m0, s69, 122880
    s_lshl1_add_u32 s0, s0, s74
    buffer_load_dwordx4 v1, s[32:35], s0 offen sc1 lds
    buffer_load_dwordx4 v1, s[32:35], s0 offen offset:1024 sc1 lds
    s_waitcnt lgkmcnt(0)
    s_barrier
    ds_read_b128 v[128:131], v16 offset:4096
    ds_read_b128 v[132:135], v16 offset:5120
    ds_read_b128 v[136:139], v16 offset:6144
    ds_read_b128 v[140:143], v16 offset:7168
    ds_read_b128 v[144:147], v16 offset:8192
    ds_read_b128 v[148:151], v16 offset:9216
    ds_read_b128 v[152:155], v16 offset:10240
    ds_read_b128 v[156:159], v16 offset:11264
    ds_read_b128 v[160:163], v16 offset:12288
    ds_read_b128 v[164:167], v16 offset:13312
    ds_read_b128 v[168:171], v16 offset:14336
    ds_read_b128 v[172:175], v16 offset:15360
    s_waitcnt lgkmcnt(11)
    v_pk_add_f32 v[32:33], v[32:33], v[128:129]
    v_pk_add_f32 v[34:35], v[34:35], v[130:131]
    s_waitcnt lgkmcnt(10)
    v_pk_add_f32 v[36:37], v[36:37], v[132:133]
    v_pk_add_f32 v[38:39], v[38:39], v[134:135]
    s_waitcnt lgkmcnt(9)
    v_pk_add_f32 v[40:41], v[40:41], v[136:137]
    v_pk_add_f32 v[42:43], v[42:43], v[138:139]
    s_waitcnt lgkmcnt(8)
    v_pk_add_f32 v[44:45], v[44:45], v[140:141]
    v_pk_add_f32 v[46:47], v[46:47], v[142:143]
    s_waitcnt lgkmcnt(7)
    v_pk_add_f32 v[32:33], v[32:33], v[144:145]
    v_pk_add_f32 v[34:35], v[34:35], v[146:147]
    s_waitcnt lgkmcnt(6)
    v_pk_add_f32 v[36:37], v[36:37], v[148:149]
    v_pk_add_f32 v[38:39], v[38:39], v[150:151]
    s_waitcnt lgkmcnt(5)
    v_pk_add_f32 v[40:41], v[40:41], v[152:153]
    v_pk_add_f32 v[42:43], v[42:43], v[154:155]
    s_waitcnt lgkmcnt(4)
    v_pk_add_f32 v[44:45], v[44:45], v[156:157]
    v_pk_add_f32 v[46:47], v[46:47], v[158:159]
    s_waitcnt lgkmcnt(3)
    v_pk_add_f32 v[32:33], v[32:33], v[160:161]
    v_pk_add_f32 v[34:35], v[34:35], v[162:163]
    s_waitcnt lgkmcnt(2)
    v_pk_add_f32 v[36:37], v[36:37], v[164:165]
    v_pk_add_f32 v[38:39], v[38:39], v[166:167]
    s_waitcnt lgkmcnt(1)
    v_pk_add_f32 v[40:41], v[40:41], v[168:169]
    v_pk_add_f32 v[42:43], v[42:43], v[170:171]
    s_waitcnt lgkmcnt(0)
    v_pk_add_f32 v[44:45], v[44:45], v[172:173]
    v_pk_add_f32 v[46:47], v[46:47], v[174:175]
    v_cvt_pk_bf16_f32 v48, v32, v33
    v_cvt_pk_bf16_f32 v49, v34, v35
    v_cvt_pk_bf16_f32 v50, v36, v37
    v_cvt_pk_bf16_f32 v51, v38, v39
    v_cvt_pk_bf16_f32 v52, v40, v41
    v_cvt_pk_bf16_f32 v53, v42, v43
    v_cvt_pk_bf16_f32 v54, v44, v45
    v_cvt_pk_bf16_f32 v55, v46, v47
    s_cmp_lg_u32 s55, 0
    s_cbranch_scc1 L_slow_x41
    buffer_store_dwordx4 v[48:51], v1, s[32:35], s82 offen
    buffer_store_dwordx4 v[52:55], v1, s[32:35], s82 offen offset:1024
L_ret_x41:
    v_pk_add_f32 v[56:57], v[32:33], v[34:35]
    v_pk_mul_f32 v[58:59], v[32:33], v[32:33]
    v_pk_fma_f32 v[58:59], v[34:35], v[34:35], v[58:59]
    v_pk_add_f32 v[56:57], v[56:57], v[36:37]
    v_pk_fma_f32 v[58:59], v[36:37], v[36:37], v[58:59]
    v_pk_add_f32 v[56:57], v[56:57], v[38:39]
    v_pk_fma_f32 v[58:59], v[38:39], v[38:39], v[58:59]
    v_pk_add_f32 v[56:57], v[56:57], v[40:41]
    v_pk_fma_f32 v[58:59], v[40:41], v[40:41], v[58:59]
    v_pk_add_f32 v[56:57], v[56:57], v[42:43]
    v_pk_fma_f32 v[58:59], v[42:43], v[42:43], v[58:59]
    v_pk_add_f32 v[56:57], v[56:57], v[44:45]
    v_pk_fma_f32 v[58:59], v[44:45], v[44:45], v[58:59]
    v_pk_add_f32 v[56:57], v[56:57], v[46:47]
    v_pk_fma_f32 v[58:59], v[46:47], v[46:47], v[58:59]
    v_add_f32 v56, v56, v57
    v_add_f32 v57, v58, v59
    v_mov_b32 v58, v56
    v_mov_b32 v59, v57
    v_lshrrev_b32 v60, 5, v9
    v_lshl_add_u32 v60, v60, 28, v1
    v_permlane32_swap_b32 v56, v58
    v_permlane32_swap_b32 v57, v59
    v_pk_add_f32 v[56:57], v[56:57], v[58:59]
    s_cmp_lg_u32 s55, 0
    s_cbranch_scc1 L_slow_s42
    buffer_store_dwordx2 v[56:57], v60, s[32:35], s83 offen
L_ret_s42:
    v_mov_b32 v30, 1
    s_waitcnt vmcnt(1)
    s_cmp_lg_u32 s55, 0
    s_cbranch_scc1 L_slow_f43
    buffer_store_dword v30, v28, s[32:35], s84 offen offset:1024
L_ret_f43:
    v_mov_b32 v30, 1
    s_waitcnt vmcnt(1)
    s_cmp_lg_u32 s55, 0
    s_cbranch_scc1 L_slow_f44
    buffer_store_dword v30, v28, s[32:35], s84 offen offset:2560
L_ret_f44:
    v_add_u32 v12, 65536, v2
    v_add_u32 v20, 32768, v2
    v_lshrrev_b32 v29, 5, v9
    v_and_b32 v30, 31, v9
    v_lshlrev_b32 v13, 4, v30
    v_add_u32 v13, 161792, v13
    s_lshl_b32 s57, s48, 5
    v_add_u32 v30, s57, v30
    v_mul_u32_u24 v30, 208, v30
    v_add_u32 v30, 131072, v30
    v_lshl_add_u32 v15, v29, 5, v30
    v_lshl_add_u32 v14, v29, 4, v30
    v_bfe_u32 v30, v9, 2, 2
    v_lshl_add_u32 v30, v29, 4, v30
    v_mul_u32_u24 v27, 40, v30
    v_and_b32 v30, 0x38, v2
    v_min_u32 v30, 32, v30
    v_add_u32 v27, v27, v30
    v_add_u32 v27, 158720, v27
    v_bfe_u32 v30, v9, 2, 2
    v_lshrrev_b32 v29, 4, v9
    v_lshl_add_u32 v25, v30, 2, v29
    v_lshl_add_u32 v26, v29, 2, v30
    v_mul_u32_u24 v25, 40, v25
    v_mul_u32_u24 v26, 40, v26
    v_and_b32 v30, 3, v9
    v_lshl_add_u32 v25, v30, 3, v25
    v_lshl_add_u32 v26, v30, 1, v26
    s_mul_i32 s58, s48, 640
    s_add_u32 s58, s58, 158720
    v_add_u32 v25, s58, v25
    v_add_u32 v26, s58, v26
    v_lshrrev_b32 v29, 4, v9
    v_bfe_u32 v30, v9, 2, 2
    v_lshl_add_u32 v30, v29, 3, v30
    v_mul_u32_u24 v30, 208, v30
    v_and_b32 v16, 3, v9
    v_lshl_add_u32 v30, v16, 3, v30
    s_lshr_b32 s58, s48, 1
    s_lshl_b32 s59, s58, 5
    s_add_u32 s59, s59, 131072
    v_add_u32 v16, s59, v30
    s_add_u32 s57, s57, 131136
    v_add_u32 v17, s57, v30
    v_lshlrev_b32 v18, 2, v9
    s_lshl_b32 s58, s58, 14
    v_add_u32 v21, s58, v3
    v_xor_b32 v22, 64, v21
    v_add_u32 v23, 98304, v21
    v_add_u32 v24, 98304, v22
    v_and_b32 v126, 15, v9
    v_lshlrev_b32 v126, 2, v126
    s_add_u32 s65, s69, s71
    s_sub_u32 s73, s74, s69
    s_add_u32 s73, s73, 65536
    s_add_u32 s58, s88, s71
    ds_read_b128 v[112:115], v13
    ds_read_b128 v[116:119], v13 offset:512
L_k1_1:
    s_add_u32 s10, s4, L_k1_1-interleave_layers__linear_kernel_hedgehog__geglu_ffn__prompt_kernel
    s_addc_u32 s11, s5, 0
    s_load_dword s6, s[10:11], 0
    s_load_dword s7, s[10:11], 64
L_poll45:
    buffer_load_dword v30, v126, s[32:35], s86 offen offset:1024 sc1
    s_sub_u32 s56, s56, 1
    s_cselect_b64 s[76:77], 0, -1
    s_max_i32 s56, s56, 0
    s_waitcnt vmcnt(0)
    v_cmp_eq_u32 vcc, 0, v30
    s_and_b64 vcc, vcc, s[76:77]
    s_cbranch_scc1 L_poll45
    buffer_load_dwordx4 v[128:131], v1, s[32:35], s58 offen offset:0 sc1
    buffer_load_dwordx4 v[132:135], v1, s[32:35], s58 offen offset:1024 sc1
    buffer_load_dwordx4 v[136:139], v1, s[32:35], s58 offen offset:2048 sc1
    buffer_load_dwordx4 v[140:143], v1, s[32:35], s58 offen offset:3072 sc1
    s_add_u32 s58, s71, 4096
    s_and_b32 s58, s58, 0x7fff
    s_add_u32 s58, s58, s88
    buffer_load_dwordx4 v[144:147], v1, s[32:35], s58 offen offset:0 sc1
    buffer_load_dwordx4 v[148:151], v1, s[32:35], s58 offen offset:1024 sc1
    buffer_load_dwordx4 v[152:155], v1, s[32:35], s58 offen offset:2048 sc1
    buffer_load_dwordx4 v[156:159], v1, s[32:35], s58 offen offset:3072 sc1
    s_barrier
    s_nop 0
    ds_read_b64_tr_b16 a[224:225], v12 offset:0
    ds_read_b64_tr_b16 a[226:227], v12 offset:256
    ds_read_b64_tr_b16 a[228:229], v12 offset:1024
    ds_read_b64_tr_b16 a[230:231], v12 offset:1280
    ds_read_b64_tr_b16 a[232:233], v12 offset:2048
    ds_read_b64_tr_b16 a[234:235], v12 offset:2304
    ds_read_b64_tr_b16 a[236:237], v12 offset:3072
    ds_read_b64_tr_b16 a[238:239], v12 offset:3328
    s_waitcnt vmcnt(7) lgkmcnt(0)
    v_mfma_f32_32x32x16_bf16 v[48:63], a[224:227], v[128:131], 0
    s_add_u32 s58, s71, 8192
    s_and_b32 s58, s58, 0x7fff
    s_add_u32 s58, s58, s88
    buffer_load_dwordx4 v[160:163], v1, s[32:35], s58 offen offset:0 sc1
    v_mfma_f32_32x32x16_bf16 v[64:79], a[228:231], v[128:131], 0
    ds_read_b64_tr_b16 a[240:241], v12 offset:4096
    ds_read_b64_tr_b16 a[242:243], v12 offset:4352
    ds_read_b64_tr_b16 a[244:245], v12 offset:5120
    ds_read_b64_tr_b16 a[246:247], v12 offset:5376
    s_waitcnt vmcnt(7)
    v_mfma_f32_32x32x16_bf16 v[48:63], a[232:235], v[132:135], v[48:63]
    buffer_load_dwordx4 v[164:167], v1, s[32:35], s58 offen offset:1024 sc1
    v_mfma_f32_32x32x16_bf16 v[64:79], a[236:239], v[132:135], v[64:79]
    ds_read_b64_tr_b16 a[224:225], v12 offset:6144
    ds_read_b64_tr_b16 a[226:227], v12 offset:6400
    ds_read_b64_tr_b16 a[228:229], v12 offset:7168
    ds_read_b64_tr_b16 a[230:231], v12 offset:7424
    s_waitcnt vmcnt(7) lgkmcnt(6)
    v_mfma_f32_32x32x16_bf16 v[48:63], a[240:243], v[136:139], v[48:63]
    buffer_load_dwordx4 v[168:171], v1, s[32:35], s58 offen offset:2048 sc1
    buffer_load_dword v127, v126, s[32:35], s86 offen offset:2560 sc1
    s_waitcnt lgkmcnt(4)
    v_mfma_f32_32x32x16_bf16 v[64:79], a[244:247], v[136:139], v[64:79]
    ds_read_b64_tr_b16 a[232:233], v12 offset:8192
    ds_read_b64_tr_b16 a[234:235], v12 offset:8448
    ds_read_b64_tr_b16 a[236:237], v12 offset:9216
    ds_read_b64_tr_b16 a[238:239], v12 offset:9472
    s_waitcnt vmcnt(8) lgkmcnt(6)
    v_mfma_f32_32x32x16_bf16 v[48:63], a[224:227], v[140:143], v[48:63]
    buffer_load_dwordx4 v[172:175], v1, s[32:35], s58 offen offset:3072 sc1
    s_waitcnt lgkmcnt(4)
    v_mfma_f32_32x32x16_bf16 v[64:79], a[228:231], v[140:143], v[64:79]
    ds_read_b64_tr_b16 a[240:241], v12 offset:10240
    ds_read_b64_tr_b16 a[242:243], v12 offset:10496
    ds_read_b64_tr_b16 a[244:245], v12 offset:11264
    ds_read_b64_tr_b16 a[246:247], v12 offset:11520
    s_waitcnt vmcnt(8) lgkmcnt(6)
    v_mfma_f32_32x32x16_bf16 v[48:63], a[232:235], v[144:147], v[48:63]
    s_add_u32 s58, s71, 12288
    s_and_b32 s58, s58, 0x7fff
    s_add_u32 s58, s58, s88
    buffer_load_dwordx4 v[176:179], v1, s[32:35], s58 offen offset:0 sc1
    s_waitcnt lgkmcnt(4)
    v_mfma_f32_32x32x16_bf16 v[64:79], a[236:239], v[144:147], v[64:79]
    ds_read_b64_tr_b16 a[224:225], v12 offset:12288
    ds_read_b64_tr_b16 a[226:227], v12 offset:12544
    ds_read_b64_tr_b16 a[228:229], v12 offset:13312
    ds_read_b64_tr_b16 a[230:231], v12 offset:13568
    s_waitcnt vmcnt(8) lgkmcnt(6)
    v_mfma_f32_32x32x16_bf16 v[48:63], a[240:243], v[148:151], v[48:63]
    buffer_load_dwordx4 v[180:183], v1, s[32:35], s58 offen offset:1024 sc1
    s_waitcnt lgkmcnt(4)
    v_mfma_f32_32x32x16_bf16 v[64:79], a[244:247], v[148:151], v[64:79]
    ds_read_b64_tr_b16 a[232:233], v12 offset:14336
    ds_read_b64_tr_b16 a[234:235], v12 offset:14592
    ds_read_b64_tr_b16 a[236:237], v12 offset:15360
    ds_read_b64_tr_b16 a[238:239], v12 offset:15616
    s_waitcnt vmcnt(8) lgkmcnt(6)
    v_mfma_f32_32x32x16_bf16 v[48:63], a[224:227], v[152:155], v[48:63]
    buffer_load_dwordx4 v[184:187], v1, s[32:35], s58 offen offset:2048 sc1
    s_waitcnt lgkmcnt(4)
    v_mfma_f32_32x32x16_bf16 v[64:79], a[228:231], v[152:155], v[64:79]
    ds_read_b64_tr_b16 a[240:241], v12 offset:16384
    ds_read_b64_tr_b16 a[242:243], v12 offset:16640
    ds_read_b64_tr_b16 a[244:245], v12 offset:17408
    ds_read_b64_tr_b16 a[246:247], v12 offset:17664
    s_waitcnt vmcnt(8) lgkmcnt(6)
    v_mfma_f32_32x32x16_bf16 v[48:63], a[232:235], v[156:159], v[48:63]
    buffer_load_dwordx4 v[188:191], v1, s[32:35], s58 offen offset:3072 sc1
    s_waitcnt lgkmcnt(4)
    v_mfma_f32_32x32x16_bf16 v[64:79], a[236:239], v[156:159], v[64:79]
    ds_read_b64_tr_b16 a[224:225], v12 offset:18432
    ds_read_b64_tr_b16 a[226:227], v12 offset:18688
    ds_read_b64_tr_b16 a[228:229], v12 offset:19456
    ds_read_b64_tr_b16 a[230:231], v12 offset:19712
    s_waitcnt vmcnt(8) lgkmcnt(6)
    v_mfma_f32_32x32x16_bf16 v[48:63], a[240:243], v[160:163], v[48:63]
    s_add_u32 s58, s71, 16384
    s_and_b32 s58, s58, 0x7fff
    s_add_u32 s58, s58, s88
    buffer_load_dwordx4 v[192:195], v1, s[32:35], s58 offen offset:0 sc1
    s_waitcnt lgkmcnt(4)
    v_mfma_f32_32x32x16_bf16 v[64:79], a[244:247], v[160:163], v[64:79]
    ds_read_b64_tr_b16 a[232:233], v12 offset:20480
    ds_read_b64_tr_b16 a[234:235], v12 offset:20736
    ds_read_b64_tr_b16 a[236:237], v12 offset:21504
    ds_read_b64_tr_b16 a[238:239], v12 offset:21760
    s_waitcnt vmcnt(8) lgkmcnt(6)
    v_mfma_f32_32x32x16_bf16 v[48:63], a[224:227], v[164:167], v[48:63]
    buffer_load_dwordx4 v[196:199], v1, s[32:35], s58 offen offset:1024 sc1
    s_waitcnt lgkmcnt(4)
    v_mfma_f32_32x32x16_bf16 v[64:79], a[228:231], v[164:167], v[64:79]
    ds_read_b64_tr_b16 a[240:241], v12 offset:22528
    ds_read_b64_tr_b16 a[242:243], v12 offset:22784
    ds_read_b64_tr_b16 a[244:245], v12 offset:23552
    ds_read_b64_tr_b16 a[246:247], v12 offset:23808
    s_waitcnt vmcnt(8) lgkmcnt(6)
    v_mfma_f32_32x32x16_bf16 v[48:63], a[232:235], v[168:171], v[48:63]
    buffer_load_dwordx4 v[200:203], v1, s[32:35], s58 offen offset:2048 sc1
    s_waitcnt vmcnt(8)
    v_cmp_eq_u32 vcc, 0, v127
    s_nop 0
    s_cbranch_vccnz L_redo47
L_done46:
    buffer_load_dwordx4 v[92:95], v1, s[32:35], s90 offen offset:0 sc1
    s_waitcnt lgkmcnt(4)
    v_mfma_f32_32x32x16_bf16 v[64:79], a[236:239], v[168:171], v[64:79]
    ds_read_b64_tr_b16 a[224:225], v12 offset:24576
    ds_read_b64_tr_b16 a[226:227], v12 offset:24832
    ds_read_b64_tr_b16 a[228:229], v12 offset:25600
    ds_read_b64_tr_b16 a[230:231], v12 offset:25856
    s_waitcnt vmcnt(8) lgkmcnt(6)
    v_mfma_f32_32x32x16_bf16 v[48:63], a[240:243], v[172:175], v[48:63]
    buffer_load_dwordx4 v[204:207], v1, s[32:35], s58 offen offset:3072 sc1
    buffer_load_dwordx4 v[96:99], v1, s[32:35], s90 offen offset:1024 sc1
    s_waitcnt lgkmcnt(4)
    v_mfma_f32_32x32x16_bf16 v[64:79], a[244:247], v[172:175], v[64:79]
    ds_read_b64_tr_b16 a[232:233], v12 offset:26624
    ds_read_b64_tr_b16 a[234:235], v12 offset:26880
    ds_read_b64_tr_b16 a[236:237], v12 offset:27648
    ds_read_b64_tr_b16 a[238:239], v12 offset:27904
    s_waitcnt vmcnt(9) lgkmcnt(6)
    v_mfma_f32_32x32x16_bf16 v[48:63], a[224:227], v[176:179], v[48:63]
    s_add_u32 s58, s71, 20480
    s_and_b32 s58, s58, 0x7fff
    s_add_u32 s58, s58, s88
    buffer_load_dwordx4 v[208:211], v1, s[32:35], s58 offen offset:0 sc1
    buffer_load_dwordx4 v[100:103], v1, s[32:35], s90 offen offset:2048 sc1
    s_waitcnt lgkmcnt(4)
    v_mfma_f32_32x32x16_bf16 v[64:79], a[228:231], v[176:179], v[64:79]
    ds_read_b64_tr_b16 a[240:241], v12 offset:28672
    ds_read_b64_tr_b16 a[242:243], v12 offset:28928
    ds_read_b64_tr_b16 a[244:245], v12 offset:29696
    ds_read_b64_tr_b16 a[246:247], v12 offset:29952
    s_waitcnt vmcnt(10) lgkmcnt(6)
    v_mfma_f32_32x32x16_bf16 v[48:63], a[232:235], v[180:183], v[48:63]
    buffer_load_dwordx4 v[212:215], v1, s[32:35], s58 offen offset:1024 sc1
    buffer_load_dwordx4 v[104:107], v1, s[32:35], s90 offen offset:3072 sc1
    s_waitcnt lgkmcnt(4)
    v_mfma_f32_32x32x16_bf16 v[64:79], a[236:239], v[180:183], v[64:79]
    ds_read_b64_tr_b16 a[224:225], v12 offset:30720
    ds_read_b64_tr_b16 a[226:227], v12 offset:30976
    ds_read_b64_tr_b16 a[228:229], v12 offset:31744
    ds_read_b64_tr_b16 a[230:231], v12 offset:32000
    s_waitcnt vmcnt(11) lgkmcnt(6)
    v_mfma_f32_32x32x16_bf16 v[48:63], a[240:243], v[184:187], v[48:63]
    buffer_load_dwordx4 v[216:219], v1, s[32:35], s58 offen offset:2048 sc1
    s_waitcnt lgkmcnt(4)
    v_mfma_f32_32x32x16_bf16 v[64:79], a[244:247], v[184:187], v[64:79]
    ds_read_b64_tr_b16 a[232:233], v12 offset:32768
    ds_read_b64_tr_b16 a[234:235], v12 offset:33024
    ds_read_b64_tr_b16 a[236:237], v12 offset:33792
    ds_read_b64_tr_b16 a[238:239], v12 offset:34048
    s_waitcnt vmcnt(11) lgkmcnt(6)
    v_mfma_f32_32x32x16_bf16 v[48:63], a[224:227], v[188:191], v[48:63]
    buffer_load_dwordx4 v[220:223], v1, s[32:35], s58 offen offset:3072 sc1
    s_waitcnt lgkmcnt(4)
    v_mfma_f32_32x32x16_bf16 v[64:79], a[228:231], v[188:191], v[64:79]
    ds_read_b64_tr_b16 a[240:241], v12 offset:34816
    ds_read_b64_tr_b16 a[242:243], v12 offset:35072
    ds_read_b64_tr_b16 a[244:245], v12 offset:35840
    ds_read_b64_tr_b16 a[246:247], v12 offset:36096
    s_waitcnt vmcnt(11) lgkmcnt(6)
    v_mfma_f32_32x32x16_bf16 v[48:63], a[232:235], v[192:195], v[48:63]
    s_add_u32 s58, s71, 24576
    s_and_b32 s58, s58, 0x7fff
    s_add_u32 s58, s58, s88
    buffer_load_dwordx4 v[224:227], v1, s[32:35], s58 offen offset:0 sc1
    s_waitcnt lgkmcnt(4)
    v_mfma_f32_32x32x16_bf16 v[64:79], a[236:239], v[192:195], v[64:79]
    ds_read_b64_tr_b16 a[224:225], v12 offset:36864
    ds_read_b64_tr_b16 a[226:227], v12 offset:37120
    ds_read_b64_tr_b16 a[228:229], v12 offset:37888
    ds_read_b64_tr_b16 a[230:231], v12 offset:38144
    s_waitcnt vmcnt(11) lgkmcnt(6)
    v_mfma_f32_32x32x16_bf16 v[48:63], a[240:243], v[196:199], v[48:63]
    buffer_load_dwordx4 v[228:231], v1, s[32:35], s58 offen offset:1024 sc1
    s_waitcnt lgkmcnt(4)
    v_mfma_f32_32x32x16_bf16 v[64:79], a[244:247], v[196:199], v[64:79]
    ds_read_b64_tr_b16 a[232:233], v12 offset:38912
    ds_read_b64_tr_b16 a[234:235], v12 offset:39168
    ds_read_b64_tr_b16 a[236:237], v12 offset:39936
    ds_read_b64_tr_b16 a[238:239], v12 offset:40192
    s_waitcnt vmcnt(11) lgkmcnt(6)
    v_mfma_f32_32x32x16_bf16 v[48:63], a[224:227], v[200:203], v[48:63]
    buffer_load_dwordx4 v[232:235], v1, s[32:35], s58 offen offset:2048 sc1
    s_waitcnt lgkmcnt(4)
    v_mfma_f32_32x32x16_bf16 v[64:79], a[228:231], v[200:203], v[64:79]
    ds_read_b64_tr_b16 a[240:241], v12 offset:40960
    ds_read_b64_tr_b16 a[242:243], v12 offset:41216
    ds_read_b64_tr_b16 a[244:245], v12 offset:41984
    ds_read_b64_tr_b16 a[246:247], v12 offset:42240
    s_waitcnt vmcnt(10) lgkmcnt(6)
    v_mfma_f32_32x32x16_bf16 v[48:63], a[232:235], v[204:207], v[48:63]
    buffer_load_dwordx4 v[236:239], v1, s[32:35], s58 offen offset:3072 sc1
    s_waitcnt lgkmcnt(4)
    v_mfma_f32_32x32x16_bf16 v[64:79], a[236:239], v[204:207], v[64:79]
    ds_read_b64_tr_b16 a[224:225], v12 offset:43008
    ds_read_b64_tr_b16 a[226:227], v12 offset:43264
    ds_read_b64_tr_b16 a[228:229], v12 offset:44032
    ds_read_b64_tr_b16 a[230:231], v12 offset:44288
    s_waitcnt vmcnt(9) lgkmcnt(6)
    v_mfma_f32_32x32x16_bf16 v[48:63], a[240:243], v[208:211], v[48:63]
    s_add_u32 s58, s71, 28672
    s_and_b32 s58, s58, 0x7fff
    s_add_u32 s58, s58, s88
    buffer_load_dwordx4 v[240:243], v1, s[32:35], s58 offen offset:0 sc1
    s_waitcnt lgkmcnt(4)
    v_mfma_f32_32x32x16_bf16 v[64:79], a[244:247], v[208:211], v[64:79]
    ds_read_b64_tr_b16 a[232:233], v12 offset:45056
    ds_read_b64_tr_b16 a[234:235], v12 offset:45312
    ds_read_b64_tr_b16 a[236:237], v12 offset:46080
    ds_read_b64_tr_b16 a[238:239], v12 offset:46336
    s_waitcnt vmcnt(8) lgkmcnt(6)
    v_mfma_f32_32x32x16_bf16 v[48:63], a[224:227], v[212:215], v[48:63]
    buffer_load_dwordx4 v[244:247], v1, s[32:35], s58 offen offset:1024 sc1
    v_add_f32 v92, v92, v100
    v_add_f32 v93, v93, v101
    v_add_f32 v94, v94, v102
    v_add_f32 v95, v95, v103
    s_waitcnt lgkmcnt(4)
    v_mfma_f32_32x32x16_bf16 v[64:79], a[228:231], v[212:215], v[64:79]
    ds_read_b64_tr_b16 a[240:241], v12 offset:47104
    ds_read_b64_tr_b16 a[242:243], v12 offset:47360
    ds_read_b64_tr_b16 a[244:245], v12 offset:48128
    ds_read_b64_tr_b16 a[246:247], v12 offset:48384
    s_waitcnt vmcnt(7) lgkmcnt(6)
    v_mfma_f32_32x32x16_bf16 v[48:63], a[232:235], v[216:219], v[48:63]
    buffer_load_dwordx4 v[248:251], v1, s[32:35], s58 offen offset:2048 sc1
    v_add_f32 v96, v96, v104
    v_add_f32 v97, v97, v105
    v_add_f32 v98, v98, v106
    v_add_f32 v99, v99, v107
    s_waitcnt lgkmcnt(4)
    v_mfma_f32_32x32x16_bf16 v[64:79], a[236:239], v[216:219], v[64:79]
    ds_read_b64_tr_b16 a[224:225], v12 offset:49152
    ds_read_b64_tr_b16 a[226:227], v12 offset:49408
    ds_read_b64_tr_b16 a[228:229], v12 offset:50176
    ds_read_b64_tr_b16 a[230:231], v12 offset:50432
    s_waitcnt vmcnt(7) lgkmcnt(6)
    v_mfma_f32_32x32x16_bf16 v[48:63], a[240:243], v[220:223], v[48:63]
    buffer_load_dwordx4 v[252:255], v1, s[32:35], s58 offen offset:3072 sc1
    v_add_f32 v92, v92, v96
    v_add_f32 v93, v93, v97
    v_add_f32 v94, v94, v98
    v_add_f32 v95, v95, v99
    s_waitcnt lgkmcnt(4)
    v_mfma_f32_32x32x16_bf16 v[64:79], a[244:247], v[220:223], v[64:79]
    ds_read_b64_tr_b16 a[232:233], v12 offset:51200
    ds_read_b64_tr_b16 a[234:235], v12 offset:51456
    ds_read_b64_tr_b16 a[236:237], v12 offset:52224
    ds_read_b64_tr_b16 a[238:239], v12 offset:52480
    s_waitcnt vmcnt(7) lgkmcnt(6)
    v_mfma_f32_32x32x16_bf16 v[48:63], a[224:227], v[224:227], v[48:63]
    v_add_f32 v92, v92, v94
    v_add_f32 v93, v93, v95
    v_mov_b32 v94, v92
    v_mov_b32 v95, v93
    s_waitcnt lgkmcnt(4)
    v_mfma_f32_32x32x16_bf16 v[64:79], a[228:231], v[224:227], v[64:79]
    ds_read_b64_tr_b16 a[240:241], v12 offset:53248
    ds_read_b64_tr_b16 a[242:243], v12 offset:53504
    ds_read_b64_tr_b16 a[244:245], v12 offset:54272
    ds_read_b64_tr_b16 a[246:247], v12 offset:54528
    s_waitcnt vmcnt(6) lgkmcnt(6)
    v_mfma_f32_32x32x16_bf16 v[48:63], a[232:235], v[228:231], v[48:63]
    v_permlane32_swap_b32 v92, v94
    v_permlane32_swap_b32 v93, v95
    v_add_f32 v92, v92, v94
    v_add_f32 v93, v93, v95
    s_waitcnt lgkmcnt(4)
    v_mfma_f32_32x32x16_bf16 v[64:79], a[236:239], v[228:231], v[64:79]
    ds_read_b64_tr_b16 a[224:225], v12 offset:55296
    ds_read_b64_tr_b16 a[226:227], v12 offset:55552
    ds_read_b64_tr_b16 a[228:229], v12 offset:56320
    ds_read_b64_tr_b16 a[230:231], v12 offset:56576
    s_waitcnt vmcnt(5) lgkmcnt(6)
    v_mfma_f32_32x32x16_bf16 v[48:63], a[240:243], v[232:235], v[48:63]
    v_mul_f32 v95, 0x3b000000, v92
    v_mul_f32 v93, 0x3b000000, v93
    v_mul_f32 v92, 0xba800000, v92
    v_fma_f32 v94, -v95, v95, v93
    s_waitcnt lgkmcnt(4)
    v_mfma_f32_32x32x16_bf16 v[64:79], a[244:247], v[232:235], v[64:79]
    ds_read_b64_tr_b16 a[232:233], v12 offset:57344
    ds_read_b64_tr_b16 a[234:235], v12 offset:57600
    ds_read_b64_tr_b16 a[236:237], v12 offset:58368
    ds_read_b64_tr_b16 a[238:239], v12 offset:58624
    s_waitcnt vmcnt(4) lgkmcnt(6)
    v_mfma_f32_32x32x16_bf16 v[48:63], a[224:227], v[236:239], v[48:63]
    v_cvt_pk_bf16_f32 v95, v92, v92
    v_max_f32 v94, 0, v94
    v_and_b32 v95, 0xffff0000, v95
    v_add_f32 v94, 0x3727c5ac, v94
    s_waitcnt lgkmcnt(4)
    v_mfma_f32_32x32x16_bf16 v[64:79], a[228:231], v[236:239], v[64:79]
    ds_read_b64_tr_b16 a[240:241], v12 offset:59392
    ds_read_b64_tr_b16 a[242:243], v12 offset:59648
    ds_read_b64_tr_b16 a[244:245], v12 offset:60416
    ds_read_b64_tr_b16 a[246:247], v12 offset:60672
    s_waitcnt vmcnt(3) lgkmcnt(6)
    v_mfma_f32_32x32x16_bf16 v[48:63], a[232:235], v[240:243], v[48:63]
    v_sub_f32 v95, v92, v95
    v_rsq_f32 v93, v94
    v_cvt_pk_bf16_f32 v120, v92, v95
    v_mov_b32 v121, v120
    s_waitcnt lgkmcnt(4)
    v_mfma_f32_32x32x16_bf16 v[64:79], a[236:239], v[240:243], v[64:79]
    ds_read_b64_tr_b16 a[224:225], v12 offset:61440
    ds_read_b64_tr_b16 a[226:227], v12 offset:61696
    ds_read_b64_tr_b16 a[228:229], v12 offset:62464
    ds_read_b64_tr_b16 a[230:231], v12 offset:62720
    s_waitcnt vmcnt(2) lgkmcnt(6)
    v_mfma_f32_32x32x16_bf16 v[48:63], a[240:243], v[244:247], v[48:63]
    v_mov_b32 v122, v120
    v_mov_b32 v123, v120
    v_mul_f32 v94, 0x3fb8aa3b, v93
    s_waitcnt lgkmcnt(4)
    v_mfma_f32_32x32x16_bf16 v[64:79], a[244:247], v[244:247], v[64:79]
    ds_read_b64_tr_b16 a[232:233], v12 offset:63488
    ds_read_b64_tr_b16 a[234:235], v12 offset:63744
    ds_read_b64_tr_b16 a[236:237], v12 offset:64512
    ds_read_b64_tr_b16 a[238:239], v12 offset:64768
    s_waitcnt vmcnt(1) lgkmcnt(6)
    v_mfma_f32_32x32x16_bf16 v[48:63], a[224:227], v[248:251], v[48:63]
    s_waitcnt lgkmcnt(4)
    v_mfma_f32_32x32x16_bf16 v[64:79], a[228:231], v[248:251], v[64:79]
    v_mfma_f32_32x32x16_bf16 v[48:63], v[112:115], v[120:123], v[48:63]
    v_mfma_f32_32x32x16_bf16 v[64:79], v[116:119], v[120:123], v[64:79]
    s_waitcnt vmcnt(0) lgkmcnt(2)
    v_mfma_f32_32x32x16_bf16 v[48:63], a[232:235], v[252:255], v[48:63]
    s_waitcnt lgkmcnt(0)
    v_mfma_f32_32x32x16_bf16 v[64:79], a[236:239], v[252:255], v[64:79]
    s_add_u32 s0, s65, 0
    s_and_b32 s0, s0, 0x7fff
    s_add_u32 m0, s69, 32768
    s_add_u32 s0, s0, s73
    buffer_load_dwordx4 v1, s[32:35], s0 offen sc1 lds
    v_cvt_pk_bf16_f32 v80, v48, v49
    v_cvt_pk_bf16_f32 v81, v50, v51
    v_cvt_pk_bf16_f32 v82, v52, v53
    v_cvt_pk_bf16_f32 v83, v54, v55
    v_cvt_pk_bf16_f32 v84, v56, v57
    v_cvt_pk_bf16_f32 v85, v58, v59
    v_cvt_pk_bf16_f32 v86, v60, v61
    v_cvt_pk_bf16_f32 v87, v62, v63
    v_mfma_f32_32x32x16_bf16 v[48:63], a[248:251], v[80:83], 0
    v_mul_f32 v64, v64, v93
    buffer_load_dwordx4 v1, s[32:35], s0 offen offset:1024 sc1 lds
    v_mul_f32 v65, v65, v93
    v_mul_f32 v66, v66, v93
    v_mul_f32 v67, v67, v93
    v_mul_f32 v68, v68, v93
    v_mul_f32 v69, v69, v93
    v_mfma_f32_32x32x16_bf16 v[96:111], a[252:255], v[84:87], 0
    v_mul_f32 v70, v70, v93
    v_mul_f32 v71, v71, v93
    v_mul_f32 v72, v72, v93
    v_mul_f32 v73, v73, v93
    s_add_u32 s0, s65, 8192
    s_and_b32 s0, s0, 0x7fff
    s_add_u32 m0, s69, 40960
    s_add_u32 s0, s0, s73
    buffer_load_dwordx4 v1, s[32:35], s0 offen sc1 lds
    v_mul_f32 v74, v74, v93
    v_mul_f32 v75, v75, v93
    v_mul_f32 v76, v76, v93
    v_mul_f32 v77, v77, v93
    v_mul_f32 v78, v78, v93
    v_mul_f32_e64 v79, v79, v93
    v_cvt_pk_bf16_f32 v112, v64, v65
    v_cvt_pk_bf16_f32 v113, v66, v67
    v_cvt_pk_bf16_f32 v114, v68, v69
    v_cvt_pk_bf16_f32 v115, v70, v71
    v_cvt_pk_bf16_f32 v116, v72, v73
    v_cvt_pk_bf16_f32 v117, v74, v75
    v_cvt_pk_bf16_f32 v118, v76, v77
    v_cvt_pk_bf16_f32 v119, v78, v79
    ds_write_b128 v14, v[112:115]
    ds_write_b128 v14, v[116:119] offset:32
    v_max3_f32 v80, v48, v49, v50
    buffer_load_dwordx4 v1, s[32:35], s0 offen offset:1024 sc1 lds
    v_max3_f32 v81, v51, v52, v53
    v_max3_f32 v80, v80, v54, v55
    v_max3_f32 v81, v81, v56, v57
    v_max3_f32 v80, v80, v58, v59
    v_max3_f32 v81, v81, v60, v61
    v_max3_f32 v80, v80, v62, v63
    v_max_f32 v80, v80, v81
    v_mul_f32 v95, v94, v80
    v_pk_fma_f32 v[48:49], v[48:49], v[94:95], v[94:95] op_sel:[0,0,1] op_sel_hi:[1,0,1] neg_lo:[0,0,1] neg_hi:[0,0,1]
    v_pk_fma_f32 v[50:51], v[50:51], v[94:95], v[94:95] op_sel:[0,0,1] op_sel_hi:[1,0,1] neg_lo:[0,0,1] neg_hi:[0,0,1]
    v_pk_fma_f32 v[52:53], v[52:53], v[94:95], v[94:95] op_sel:[0,0,1] op_sel_hi:[1,0,1] neg_lo:[0,0,1] neg_hi:[0,0,1]
    v_pk_fma_f32 v[54:55], v[54:55], v[94:95], v[94:95] op_sel:[0,0,1] op_sel_hi:[1,0,1] neg_lo:[0,0,1] neg_hi:[0,0,1]
    v_pk_fma_f32 v[56:57], v[56:57], v[94:95], v[94:95] op_sel:[0,0,1] op_sel_hi:[1,0,1] neg_lo:[0,0,1] neg_hi:[0,0,1]
    v_pk_fma_f32 v[58:59], v[58:59], v[94:95], v[94:95] op_sel:[0,0,1] op_sel_hi:[1,0,1] neg_lo:[0,0,1] neg_hi:[0,0,1]
    v_pk_fma_f32 v[60:61], v[60:61], v[94:95], v[94:95] op_sel:[0,0,1] op_sel_hi:[1,0,1] neg_lo:[0,0,1] neg_hi:[0,0,1]
    v_pk_fma_f32 v[62:63], v[62:63], v[94:95], v[94:95] op_sel:[0,0,1] op_sel_hi:[1,0,1] neg_lo:[0,0,1] neg_hi:[0,0,1]
    v_exp_f32 v48, v48
    s_add_u32 s0, s65, 16384
    s_and_b32 s0, s0, 0x7fff
    s_add_u32 m0, s69, 49152
    s_add_u32 s0, s0, s73
    buffer_load_dwordx4 v1, s[32:35], s0 offen sc1 lds
    v_exp_f32 v49, v49
    v_exp_f32 v50, v50
    v_exp_f32 v51, v51
    v_exp_f32 v52, v52
    v_exp_f32 v53, v53
    v_exp_f32 v54, v54
    v_exp_f32 v55, v55
    v_exp_f32 v56, v56
    buffer_load_dwordx4 v1, s[32:35], s0 offen offset:1024 sc1 lds
    v_exp_f32 v57, v57
    v_exp_f32 v58, v58
    v_exp_f32 v59, v59
    v_exp_f32 v60, v60
    v_exp_f32 v61, v61
    v_exp_f32 v62, v62
    v_exp_f32_e64 v63, v63
    v_pk_add_f32 v[80:81], v[48:49], v[56:57]
    v_pk_add_f32 v[82:83], v[50:51], v[58:59]
    v_pk_add_f32 v[84:85], v[52:53], v[60:61]
    s_add_u32 s0, s65, 24576
    s_and_b32 s0, s0, 0x7fff
    s_add_u32 m0, s69, 57344
    s_add_u32 s0, s0, s73
    buffer_load_dwordx4 v1, s[32:35], s0 offen sc1 lds
    v_pk_add_f32 v[86:87], v[54:55], v[62:63]
    v_pk_add_f32 v[80:81], v[80:81], v[84:85]
    v_pk_add_f32 v[82:83], v[82:83], v[86:87]
    v_pk_add_f32 v[80:81], v[80:81], v[82:83]
    v_add_f32 v80, v80, v81
    v_rcp_f32 v80, v80
    s_nop 0
    v_pk_mul_f32 v[48:49], v[48:49], v[80:81] op_sel_hi:[1,0]
    v_pk_mul_f32 v[50:51], v[50:51], v[80:81] op_sel_hi:[1,0]
    v_pk_mul_f32 v[52:53], v[52:53], v[80:81] op_sel_hi:[1,0]
    v_pk_mul_f32 v[54:55], v[54:55], v[80:81] op_sel_hi:[1,0]
    v_pk_mul_f32 v[56:57], v[56:57], v[80:81] op_sel_hi:[1,0]
    v_pk_mul_f32 v[58:59], v[58:59], v[80:81] op_sel_hi:[1,0]
    v_pk_mul_f32 v[60:61], v[60:61], v[80:81] op_sel_hi:[1,0]
    v_pk_mul_f32 v[62:63], v[62:63], v[80:81] op_sel_hi:[1,0]
    v_cvt_pk_bf16_f32 v64, v48, v49
    v_cvt_pk_bf16_f32 v65, v50, v51
    v_cvt_pk_bf16_f32 v66, v52, v53
    buffer_load_dwordx4 v1, s[32:35], s0 offen offset:1024 sc1 lds
    v_cvt_pk_bf16_f32 v67, v54, v55
    v_cvt_pk_bf16_f32 v68, v56, v57
    v_cvt_pk_bf16_f32 v69, v58, v59
    v_cvt_pk_bf16_f32 v70, v60, v61
    v_cvt_pk_bf16_f32 v71, v62, v63
    ds_write_b128 v15, v[64:67] offset:64
    ds_write_b128 v15, v[68:71] offset:80
    v_max3_f32 v80, v96, v97, v98
    v_max3_f32 v81, v99, v100, v101
    v_max3_f32 v80, v80, v102, v103
    v_max3_f32 v81, v81, v104, v105
    v_max3_f32 v80, v80, v106, v107
    v_max3_f32 v81, v81, v108, v109
    v_max3_f32 v80, v80, v110, v111
    v_max_f32 v80, v80, v81
    v_mul_f32 v95, v94, v80
    s_add_u32 m0, s70, 0
    s_add_u32 s0, s68, 0
    buffer_load_dwordx4 v6, s[12:15], s0 offen lds
    v_pk_fma_f32 v[96:97], v[96:97], v[94:95], v[94:95] op_sel:[0,0,1] op_sel_hi:[1,0,1] neg_lo:[0,0,1] neg_hi:[0,0,1]
    v_pk_fma_f32 v[98:99], v[98:99], v[94:95], v[94:95] op_sel:[0,0,1] op_sel_hi:[1,0,1] neg_lo:[0,0,1] neg_hi:[0,0,1]
    v_pk_fma_f32 v[100:101], v[100:101], v[94:95], v[94:95] op_sel:[0,0,1] op_sel_hi:[1,0,1] neg_lo:[0,0,1] neg_hi:[0,0,1]
    v_pk_fma_f32 v[102:103], v[102:103], v[94:95], v[94:95] op_sel:[0,0,1] op_sel_hi:[1,0,1] neg_lo:[0,0,1] neg_hi:[0,0,1]
    v_pk_fma_f32 v[104:105], v[104:105], v[94:95], v[94:95] op_sel:[0,0,1] op_sel_hi:[1,0,1] neg_lo:[0,0,1] neg_hi:[0,0,1]
    v_pk_fma_f32 v[106:107], v[106:107], v[94:95], v[94:95] op_sel:[0,0,1] op_sel_hi:[1,0,1] neg_lo:[0,0,1] neg_hi:[0,0,1]
    v_pk_fma_f32 v[108:109], v[108:109], v[94:95], v[94:95] op_sel:[0,0,1] op_sel_hi:[1,0,1] neg_lo:[0,0,1] neg_hi:[0,0,1]
    v_pk_fma_f32 v[110:111], v[110:111], v[94:95], v[94:95] op_sel:[0,0,1] op_sel_hi:[1,0,1] neg_lo:[0,0,1] neg_hi:[0,0,1]
    v_exp_f32 v96, v96
    v_exp_f32 v97, v97
    v_exp_f32 v98, v98
    v_exp_f32 v99, v99
    v_exp_f32 v100, v100
    buffer_load_dwordx4 v10, s[12:15], s0 offen offset:1024 lds
    v_exp_f32 v101, v101
    v_exp_f32 v102, v102
    v_exp_f32 v103, v103
    v_exp_f32 v104, v104
    v_exp_f32 v105, v105
    v_exp_f32 v106, v106
    v_exp_f32 v107, v107
    v_exp_f32 v108, v108
    s_add_u32 m0, s70, 2048
    s_add_u32 s0, s68, 16384
    buffer_load_dwordx4 v6, s[12:15], s0 offen lds
    v_exp_f32 v109, v109
    v_exp_f32 v110, v110
    v_exp_f32 v111, v111
    v_pk_add_f32 v[80:81], v[96:97], v[104:105]
    v_pk_add_f32 v[82:83], v[98:99], v[106:107]
    v_pk_add_f32 v[84:85], v[100:101], v[108:109]
    v_pk_add_f32 v[86:87], v[102:103], v[110:111]
    v_pk_add_f32 v[80:81], v[80:81], v[84:85]
    v_pk_add_f32 v[82:83], v[82:83], v[86:87]
    v_pk_add_f32 v[80:81], v[80:81], v[82:83]
    v_add_f32 v80, v80, v81
    v_rcp_f32_e64 v80, v80
    s_nop 0
    v_pk_mul_f32 v[96:97], v[96:97], v[80:81] op_sel_hi:[1,0]
    buffer_load_dwordx4 v10, s[12:15], s0 offen offset:1024 lds
    v_pk_mul_f32 v[98:99], v[98:99], v[80:81] op_sel_hi:[1,0]
    v_pk_mul_f32 v[100:101], v[100:101], v[80:81] op_sel_hi:[1,0]
    v_pk_mul_f32 v[102:103], v[102:103], v[80:81] op_sel_hi:[1,0]
    v_pk_mul_f32 v[104:105], v[104:105], v[80:81] op_sel_hi:[1,0]
    v_pk_mul_f32 v[106:107], v[106:107], v[80:81] op_sel_hi:[1,0]
    v_pk_mul_f32 v[108:109], v[108:109], v[80:81] op_sel_hi:[1,0]
    v_pk_mul_f32 v[110:111], v[110:111], v[80:81] op_sel_hi:[1,0]
    v_cvt_pk_bf16_f32 v72, v96, v97
    v_cvt_pk_bf16_f32 v73, v98, v99
    v_cvt_pk_bf16_f32 v74, v100, v101
    v_cvt_pk_bf16_f32 v75, v102, v103
    v_cvt_pk_bf16_f32 v76, v104, v105
    v_cvt_pk_bf16_f32 v77, v106, v107
    v_cvt_pk_bf16_f32 v78, v108, v109
    v_cvt_pk_bf16_f32 v79, v110, v111
    ds_write_b128 v15, v[72:75] offset:128
    ds_write_b128 v15, v[76:79] offset:144
    v_mov_b32 v88, 0x3f803f80
    v_mov_b32 v89, 0x3f803f80
    v_mov_b32 v90, 0x3f803f80
    v_mov_b32 v91, 0x3f803f80
    s_waitcnt lgkmcnt(0)
    s_barrier
    ds_read_b64_tr_b16 v[52:53], v17 offset:0
    ds_read_b64_tr_b16 v[54:55], v17 offset:832
    ds_read_b64_tr_b16 v[48:49], v16 offset:0
    ds_read_b64_tr_b16 v[50:51], v16 offset:832
    ds_read_b64_tr_b16 v[60:61], v17 offset:6656
    ds_read_b64_tr_b16 v[62:63], v17 offset:7488
    ds_read_b64_tr_b16 v[56:57], v16 offset:6656
    ds_read_b64_tr_b16 v[58:59], v16 offset:7488
    ds_read_b64_tr_b16 v[68:69], v17 offset:13312
    ds_read_b64_tr_b16 v[70:71], v17 offset:14144
    ds_read_b64_tr_b16 v[64:65], v16 offset:13312
    ds_read_b64_tr_b16 v[66:67], v16 offset:14144
    ds_read_b64_tr_b16 v[76:77], v17 offset:19968
    ds_read_b64_tr_b16 v[78:79], v17 offset:20800
    ds_read_b64_tr_b16 v[72:73], v16 offset:19968
    ds_read_b64_tr_b16 v[74:75], v16 offset:20800
    s_add_u32 m0, s70, 4096
    s_add_u32 s0, s68, 32768
    buffer_load_dwordx4 v6, s[12:15], s0 offen lds
    buffer_load_dwordx4 v10, s[12:15], s0 offen offset:1024 lds
    s_add_u32 m0, s70, 6144
    s_add_u32 s0, s68, 49152
    buffer_load_dwordx4 v6, s[12:15], s0 offen lds
    buffer_load_dwordx4 v10, s[12:15], s0 offen offset:1024 lds
    s_add_u32 s99, s95, 5120
    s_mov_b32 s100, 0x80008000
    s_mov_b32 s101, 0x80008000
    s_mov_b32 vcc_lo, 0x11111111
    s_mov_b32 vcc_hi, 0x11111111
    s_waitcnt lgkmcnt(14)
    v_mfma_f32_16x16x32_bf16 v[84:87], v[52:55], v[88:91], 0
    s_waitcnt lgkmcnt(12)
    v_mfma_f32_16x16x32_bf16 v[80:83], v[52:55], v[48:51], 0
    s_waitcnt lgkmcnt(10)
    v_mfma_f32_16x16x32_bf16 v[84:87], v[60:63], v[88:91], v[84:87]
    s_waitcnt lgkmcnt(8)
    v_mfma_f32_16x16x32_bf16 v[80:83], v[60:63], v[56:59], v[80:83]
    s_waitcnt lgkmcnt(6)
    v_mfma_f32_16x16x32_bf16 v[84:87], v[68:71], v[88:91], v[84:87]
    s_waitcnt lgkmcnt(4)
    v_mfma_f32_16x16x32_bf16 v[80:83], v[68:71], v[64:67], v[80:83]
    s_waitcnt lgkmcnt(2)
    v_mfma_f32_16x16x32_bf16 v[84:87], v[76:79], v[88:91], v[84:87]
    s_waitcnt lgkmcnt(0)
    v_mfma_f32_16x16x32_bf16 v[80:83], v[76:79], v[72:75], v[80:83]
    s_nop 3
    v_mov_b32_dpp v84, v85 quad_perm:[0,1,2,3] row_mask:0xf bank_mask:2
    v_mov_b32_dpp v84, v86 quad_perm:[0,1,2,3] row_mask:0xf bank_mask:4
    v_mov_b32_dpp v84, v87 quad_perm:[0,1,2,3] row_mask:0xf bank_mask:8
    s_nop 0
    v_mov_b32_dpp v85, v80 row_ror:1 row_mask:0xf bank_mask:1
    v_mov_b32_dpp v85, v81 row_ror:5 row_mask:0xf bank_mask:2
    v_mov_b32_dpp v85, v82 row_ror:9 row_mask:0xf bank_mask:4
    v_mov_b32_dpp v85, v83 row_ror:13 row_mask:0xf bank_mask:8
    v_cndmask_b32 v84, v84, v85, vcc
    s_mov_b64 exec, s[100:101]
    v_mov_b32 v80, 0x3e800000
    v_mov_b32 v81, 0x3e800000
    v_mov_b32 v82, 0x3e800000
    v_mov_b32 v83, 0x3e800000
    v_mov_b32 v84, 0x3e800000
    s_mov_b64 exec, -1
    buffer_atomic_add_f32 v80, v18, s[32:35], s99 offen offset:0
    buffer_atomic_add_f32 v81, v18, s[32:35], s99 offen offset:256
    buffer_atomic_add_f32 v82, v18, s[32:35], s99 offen offset:512
    buffer_atomic_add_f32 v83, v18, s[32:35], s99 offen offset:768
    buffer_atomic_add_f32 v84, v18, s[32:35], s99 offen offset:1024
    s_waitcnt vmcnt(13)
    s_barrier
    s_nop 0
    ds_read_b64_tr_b16 a[224:225], v20 offset:0
    ds_read_b64_tr_b16 a[226:227], v20 offset:256
    ds_read_b64_tr_b16 a[228:229], v20 offset:1024
    ds_read_b64_tr_b16 a[230:231], v20 offset:1280
    ds_read_b64_tr_b16 a[232:233], v20 offset:2048
    ds_read_b64_tr_b16 a[234:235], v20 offset:2304
    ds_read_b64_tr_b16 a[236:237], v20 offset:3072
    ds_read_b64_tr_b16 a[238:239], v20 offset:3328
    buffer_load_dword v117, v0, s[32:35], 0 offen sc1
    v_cvt_pk_bf16_f32 v84, v5, v5
    v_and_b32 v85, 0xffff0000, v84
    v_sub_f32 v85, v5, v85
    v_cvt_pk_bf16_f32 v85, v85, v85
    v_mov_b32 v86, 0
    v_mov_b32 v87, 0
    s_waitcnt lgkmcnt(6)
    v_mfma_f32_32x32x16_bf16 v[48:63], a[224:227], v[128:131], 0
    ds_read_b64_tr_b16 a[240:241], v20 offset:4096
    ds_read_b64_tr_b16 a[242:243], v20 offset:4352
    s_waitcnt lgkmcnt(6)
    v_mfma_f32_32x32x16_bf16 v[48:63], a[228:231], v[132:135], v[48:63]
    s_add_u32 m0, s70, 98304
    s_add_u32 s0, s68, 131072
    buffer_load_dwordx4 v6, s[12:15], s0 offen lds
    ds_read_b64_tr_b16 a[244:245], v20 offset:5120
    ds_read_b64_tr_b16 a[246:247], v20 offset:5376
    s_waitcnt lgkmcnt(6)
    v_mfma_f32_32x32x16_bf16 v[48:63], a[232:235], v[136:139], v[48:63]
    ds_read_b64_tr_b16 a[224:225], v20 offset:6144
    ds_read_b64_tr_b16 a[226:227], v20 offset:6400
    s_waitcnt lgkmcnt(6)
    v_mfma_f32_32x32x16_bf16 v[48:63], a[236:239], v[140:143], v[48:63]
    ds_read_b64_tr_b16 a[228:229], v20 offset:7168
    ds_read_b64_tr_b16 a[230:231], v20 offset:7424
    s_waitcnt lgkmcnt(6)
    v_mfma_f32_32x32x16_bf16 v[48:63], a[240:243], v[144:147], v[48:63]
    buffer_load_dwordx4 v10, s[12:15], s0 offen offset:1024 lds
    ds_read_b64_tr_b16 a[232:233], v20 offset:8192
    ds_read_b64_tr_b16 a[234:235], v20 offset:8448
    s_waitcnt lgkmcnt(6)
    v_mfma_f32_32x32x16_bf16 v[48:63], a[244:247], v[148:151], v[48:63]
    ds_read_b64_tr_b16 a[236:237], v20 offset:9216
    ds_read_b64_tr_b16 a[238:239], v20 offset:9472
    s_waitcnt lgkmcnt(6)
    v_mfma_f32_32x32x16_bf16 v[48:63], a[224:227], v[152:155], v[48:63]
    s_add_u32 m0, s70, 100352
    s_add_u32 s0, s68, 147456
    buffer_load_dwordx4 v6, s[12:15], s0 offen lds
    ds_read_b64_tr_b16 a[240:241], v20 offset:10240
    ds_read_b64_tr_b16 a[242:243], v20 offset:10496
    s_waitcnt lgkmcnt(6)
    v_mfma_f32_32x32x16_bf16 v[48:63], a[228:231], v[156:159], v[48:63]
    ds_read_b64_tr_b16 a[244:245], v20 offset:11264
    ds_read_b64_tr_b16 a[246:247], v20 offset:11520
    s_waitcnt lgkmcnt(6)
    v_mfma_f32_32x32x16_bf16 v[48:63], a[232:235], v[160:163], v[48:63]
    buffer_load_dwordx4 v10, s[12:15], s0 offen offset:1024 lds
    ds_read_b64_tr_b16 a[224:225], v20 offset:12288
    ds_read_b64_tr_b16 a[226:227], v20 offset:12544
    s_waitcnt lgkmcnt(6)
    v_mfma_f32_32x32x16_bf16 v[48:63], a[236:239], v[164:167], v[48:63]
    ds_read_b64_tr_b16 a[228:229], v20 offset:13312
    ds_read_b64_tr_b16 a[230:231], v20 offset:13568
    s_waitcnt lgkmcnt(6)
    v_mfma_f32_32x32x16_bf16 v[48:63], a[240:243], v[168:171], v[48:63]
    ds_read_b64_tr_b16 a[232:233], v20 offset:14336
    ds_read_b64_tr_b16 a[234:235], v20 offset:14592
    s_waitcnt lgkmcnt(6)
    v_mfma_f32_32x32x16_bf16 v[48:63], a[244:247], v[172:175], v[48:63]
    s_add_u32 m0, s70, 102400
    s_add_u32 s0, s68, 163840
    buffer_load_dwordx4 v6, s[12:15], s0 offen lds
    ds_read_b64_tr_b16 a[236:237], v20 offset:15360
    ds_read_b64_tr_b16 a[238:239], v20 offset:15616
    s_waitcnt lgkmcnt(6)
    v_mfma_f32_32x32x16_bf16 v[48:63], a[224:227], v[176:179], v[48:63]
    ds_read_b64_tr_b16 a[240:241], v20 offset:16384
    ds_read_b64_tr_b16 a[242:243], v20 offset:16640
    s_waitcnt lgkmcnt(6)
    v_mfma_f32_32x32x16_bf16 v[48:63], a[228:231], v[180:183], v[48:63]
    buffer_load_dwordx4 v10, s[12:15], s0 offen offset:1024 lds
    ds_read_b64_tr_b16 a[244:245], v20 offset:17408
    ds_read_b64_tr_b16 a[246:247], v20 offset:17664
    s_waitcnt lgkmcnt(6)
    v_mfma_f32_32x32x16_bf16 v[48:63], a[232:235], v[184:187], v[48:63]
    ds_read_b64_tr_b16 a[224:225], v20 offset:18432
    ds_read_b64_tr_b16 a[226:227], v20 offset:18688
    s_waitcnt lgkmcnt(6)
    v_mfma_f32_32x32x16_bf16 v[48:63], a[236:239], v[188:191], v[48:63]
    s_add_u32 m0, s70, 104448
    s_add_u32 s0, s68, 180224
    buffer_load_dwordx4 v6, s[12:15], s0 offen lds
    ds_read_b64_tr_b16 a[228:229], v20 offset:19456
    ds_read_b64_tr_b16 a[230:231], v20 offset:19712
    s_waitcnt lgkmcnt(6)
    v_mfma_f32_32x32x16_bf16 v[48:63], a[240:243], v[192:195], v[48:63]
    ds_read_b64_tr_b16 a[232:233], v20 offset:20480
    ds_read_b64_tr_b16 a[234:235], v20 offset:20736
    s_waitcnt lgkmcnt(6)
    v_mfma_f32_32x32x16_bf16 v[48:63], a[244:247], v[196:199], v[48:63]
    ds_read_b64_tr_b16 a[236:237], v20 offset:21504
    ds_read_b64_tr_b16 a[238:239], v20 offset:21760
    s_waitcnt lgkmcnt(6)
    v_mfma_f32_32x32x16_bf16 v[48:63], a[224:227], v[200:203], v[48:63]
    buffer_load_dwordx4 v10, s[12:15], s0 offen offset:1024 lds
    ds_read_b64_tr_b16 a[240:241], v20 offset:22528
    ds_read_b64_tr_b16 a[242:243], v20 offset:22784
    s_waitcnt lgkmcnt(6)
    v_mfma_f32_32x32x16_bf16 v[48:63], a[228:231], v[204:207], v[48:63]
    ds_read_b64_tr_b16 a[244:245], v20 offset:23552
    ds_read_b64_tr_b16 a[246:247], v20 offset:23808
    s_waitcnt lgkmcnt(6)
    v_mfma_f32_32x32x16_bf16 v[48:63], a[232:235], v[208:211], v[48:63]
    s_add_u32 m0, s69, 65536
    s_add_u32 s0, s66, 0
    buffer_load_dwordx4 v7, s[16:19], s0 offen lds
    ds_read_b64_tr_b16 a[224:225], v20 offset:24576
    ds_read_b64_tr_b16 a[226:227], v20 offset:24832
    s_waitcnt lgkmcnt(6)
    v_mfma_f32_32x32x16_bf16 v[48:63], a[236:239], v[212:215], v[48:63]
    ds_read_b64_tr_b16 a[228:229], v20 offset:25600
    ds_read_b64_tr_b16 a[230:231], v20 offset:25856
    s_waitcnt lgkmcnt(6)
    v_mfma_f32_32x32x16_bf16 v[48:63], a[240:243], v[216:219], v[48:63]
    buffer_load_dwordx4 v11, s[20:23], s0 offen offset:1024 lds
    ds_read_b64_tr_b16 a[232:233], v20 offset:26624
    ds_read_b64_tr_b16 a[234:235], v20 offset:26880
    s_waitcnt lgkmcnt(6)
    v_mfma_f32_32x32x16_bf16 v[48:63], a[244:247], v[220:223], v[48:63]
    ds_read_b64_tr_b16 a[236:237], v20 offset:27648
    ds_read_b64_tr_b16 a[238:239], v20 offset:27904
    s_waitcnt lgkmcnt(6)
    v_mfma_f32_32x32x16_bf16 v[48:63], a[224:227], v[224:227], v[48:63]
    ds_read_b64_tr_b16 a[240:241], v20 offset:28672
    ds_read_b64_tr_b16 a[242:243], v20 offset:28928
    s_waitcnt lgkmcnt(6)
    v_mfma_f32_32x32x16_bf16 v[48:63], a[228:231], v[228:231], v[48:63]
    s_add_u32 m0, s69, 73728
    s_add_u32 s0, s66, 114688
    buffer_load_dwordx4 v7, s[16:19], s0 offen lds
    ds_read_b64_tr_b16 a[244:245], v20 offset:29696
    ds_read_b64_tr_b16 a[246:247], v20 offset:29952
    s_waitcnt lgkmcnt(6)
    v_mfma_f32_32x32x16_bf16 v[48:63], a[232:235], v[232:235], v[48:63]
    ds_read_b64_tr_b16 a[224:225], v20 offset:30720
    ds_read_b64_tr_b16 a[226:227], v20 offset:30976
    s_waitcnt lgkmcnt(6)
    v_mfma_f32_32x32x16_bf16 v[48:63], a[236:239], v[236:239], v[48:63]
    buffer_load_dwordx4 v11, s[20:23], s0 offen offset:1024 lds
    ds_read_b64_tr_b16 a[228:229], v20 offset:31744
    ds_read_b64_tr_b16 a[230:231], v20 offset:32000
    s_waitcnt lgkmcnt(6)
    v_mfma_f32_32x32x16_bf16 v[48:63], a[240:243], v[240:243], v[48:63]
    s_waitcnt lgkmcnt(4)
    v_mfma_f32_32x32x16_bf16 v[48:63], a[244:247], v[244:247], v[48:63]
    s_waitcnt lgkmcnt(2)
    v_mfma_f32_32x32x16_bf16 v[48:63], a[224:227], v[248:251], v[48:63]
    s_add_u32 m0, s69, 81920
    s_add_u32 s0, s66, 229376
    buffer_load_dwordx4 v7, s[16:19], s0 offen lds
    v_mfma_f32_32x32x16_bf16 v[48:63], v[84:87], v[120:123], v[48:63]
    s_waitcnt lgkmcnt(0)
    v_mfma_f32_32x32x16_bf16 v[48:63], a[228:231], v[252:255], v[48:63]
    s_nop 11
    v_cvt_pk_bf16_f32 v80, v48, v49
    buffer_load_dwordx4 v11, s[20:23], s0 offen offset:1024 lds
    s_nop 0
    v_cvt_pk_bf16_f32 v81, v50, v51
    v_cvt_pk_bf16_f32 v82, v52, v53
    v_cvt_pk_bf16_f32 v83, v54, v55
    v_cvt_pk_bf16_f32 v84, v56, v57
    v_cvt_pk_bf16_f32 v85, v58, v59
    v_cvt_pk_bf16_f32 v86, v60, v61
    v_cvt_pk_bf16_f32 v87, v62, v63
    v_mfma_f32_32x32x16_bf16 v[48:63], a[248:251], v[80:83], 0
    s_nop 0
    v_mfma_f32_32x32x16_bf16 v[64:79], a[252:255], v[84:87], 0
    s_nop 3
    v_max3_f32 v80, v48, v49, v50
    v_max3_f32 v81, v51, v52, v53
    v_max3_f32 v80, v80, v54, v55
    v_max3_f32 v81, v81, v56, v57
    v_max3_f32 v80, v80, v58, v59
    v_max3_f32 v81, v81, v60, v61
    v_max3_f32 v80, v80, v62, v63
    v_max_f32 v80, v80, v81
    v_mul_f32 v95, v94, v80
    v_pk_fma_f32 v[48:49], v[48:49], v[94:95], v[94:95] op_sel:[0,0,1] op_sel_hi:[1,0,1] neg_lo:[0,0,1] neg_hi:[0,0,1]
    v_pk_fma_f32 v[50:51], v[50:51], v[94:95], v[94:95] op_sel:[0,0,1] op_sel_hi:[1,0,1] neg_lo:[0,0,1] neg_hi:[0,0,1]
    v_pk_fma_f32 v[52:53], v[52:53], v[94:95], v[94:95] op_sel:[0,0,1] op_sel_hi:[1,0,1] neg_lo:[0,0,1] neg_hi:[0,0,1]
    v_pk_fma_f32 v[54:55], v[54:55], v[94:95], v[94:95] op_sel:[0,0,1] op_sel_hi:[1,0,1] neg_lo:[0,0,1] neg_hi:[0,0,1]
    v_pk_fma_f32 v[56:57], v[56:57], v[94:95], v[94:95] op_sel:[0,0,1] op_sel_hi:[1,0,1] neg_lo:[0,0,1] neg_hi:[0,0,1]
    v_pk_fma_f32 v[58:59], v[58:59], v[94:95], v[94:95] op_sel:[0,0,1] op_sel_hi:[1,0,1] neg_lo:[0,0,1] neg_hi:[0,0,1]
    v_pk_fma_f32 v[60:61], v[60:61], v[94:95], v[94:95] op_sel:[0,0,1] op_sel_hi:[1,0,1] neg_lo:[0,0,1] neg_hi:[0,0,1]
    v_pk_fma_f32 v[62:63], v[62:63], v[94:95], v[94:95] op_sel:[0,0,1] op_sel_hi:[1,0,1] neg_lo:[0,0,1] neg_hi:[0,0,1]
    v_exp_f32 v48, v48
    v_exp_f32 v49, v49
    v_exp_f32 v50, v50
    v_exp_f32 v51, v51
    v_exp_f32 v52, v52
    v_exp_f32 v53, v53
    v_exp_f32 v54, v54
    v_exp_f32 v55, v55
    v_exp_f32 v56, v56
    v_exp_f32 v57, v57
    v_exp_f32 v58, v58
    v_exp_f32 v59, v59
    v_exp_f32 v60, v60
    v_exp_f32 v61, v61
    v_exp_f32 v62, v62
    v_exp_f32 v63, v63
    v_pk_add_f32 v[80:81], v[48:49], v[56:57]
    v_pk_add_f32 v[82:83], v[50:51], v[58:59]
    v_pk_add_f32 v[84:85], v[52:53], v[60:61]
    v_pk_add_f32 v[86:87], v[54:55], v[62:63]
    v_pk_add_f32 v[80:81], v[80:81], v[84:85]
    v_pk_add_f32 v[82:83], v[82:83], v[86:87]
    v_pk_add_f32 v[80:81], v[80:81], v[82:83]
    v_add_f32 v80, v80, v81
    v_rcp_f32_e64 v80, v80
    s_nop 0
    v_pk_mul_f32 v[48:49], v[48:49], v[80:81] op_sel_hi:[1,0]
    v_pk_mul_f32 v[50:51], v[50:51], v[80:81] op_sel_hi:[1,0]
    v_pk_mul_f32 v[52:53], v[52:53], v[80:81] op_sel_hi:[1,0]
    v_pk_mul_f32 v[54:55], v[54:55], v[80:81] op_sel_hi:[1,0]
    v_pk_mul_f32 v[56:57], v[56:57], v[80:81] op_sel_hi:[1,0]
    v_pk_mul_f32 v[58:59], v[58:59], v[80:81] op_sel_hi:[1,0]
    v_pk_mul_f32 v[60:61], v[60:61], v[80:81] op_sel_hi:[1,0]
    v_pk_mul_f32 v[62:63], v[62:63], v[80:81] op_sel_hi:[1,0]
    v_cvt_pk_bf16_f32 v96, v48, v49
    v_cvt_pk_bf16_f32 v97, v50, v51
    v_cvt_pk_bf16_f32 v98, v52, v53
    v_cvt_pk_bf16_f32 v99, v54, v55
    v_cvt_pk_bf16_f32 v100, v56, v57
    v_cvt_pk_bf16_f32 v101, v58, v59
    v_cvt_pk_bf16_f32 v102, v60, v61
    v_cvt_pk_bf16_f32 v103, v62, v63
    v_max3_f32 v80, v64, v65, v66
    v_max3_f32 v81, v67, v68, v69
    v_max3_f32 v80, v80, v70, v71
    v_max3_f32 v81, v81, v72, v73
    v_max3_f32 v80, v80, v74, v75
    v_max3_f32 v81, v81, v76, v77
    v_max3_f32 v80, v80, v78, v79
    v_max_f32 v80, v80, v81
    v_mul_f32 v95, v94, v80
    v_pk_fma_f32 v[64:65], v[64:65], v[94:95], v[94:95] op_sel:[0,0,1] op_sel_hi:[1,0,1] neg_lo:[0,0,1] neg_hi:[0,0,1]
    v_pk_fma_f32 v[66:67], v[66:67], v[94:95], v[94:95] op_sel:[0,0,1] op_sel_hi:[1,0,1] neg_lo:[0,0,1] neg_hi:[0,0,1]
    v_pk_fma_f32 v[68:69], v[68:69], v[94:95], v[94:95] op_sel:[0,0,1] op_sel_hi:[1,0,1] neg_lo:[0,0,1] neg_hi:[0,0,1]
    v_pk_fma_f32 v[70:71], v[70:71], v[94:95], v[94:95] op_sel:[0,0,1] op_sel_hi:[1,0,1] neg_lo:[0,0,1] neg_hi:[0,0,1]
    v_pk_fma_f32 v[72:73], v[72:73], v[94:95], v[94:95] op_sel:[0,0,1] op_sel_hi:[1,0,1] neg_lo:[0,0,1] neg_hi:[0,0,1]
    v_pk_fma_f32 v[74:75], v[74:75], v[94:95], v[94:95] op_sel:[0,0,1] op_sel_hi:[1,0,1] neg_lo:[0,0,1] neg_hi:[0,0,1]
    v_pk_fma_f32 v[76:77], v[76:77], v[94:95], v[94:95] op_sel:[0,0,1] op_sel_hi:[1,0,1] neg_lo:[0,0,1] neg_hi:[0,0,1]
    v_pk_fma_f32 v[78:79], v[78:79], v[94:95], v[94:95] op_sel:[0,0,1] op_sel_hi:[1,0,1] neg_lo:[0,0,1] neg_hi:[0,0,1]
    v_exp_f32 v64, v64
    v_exp_f32 v65, v65
    v_exp_f32 v66, v66
    v_exp_f32 v67, v67
    v_exp_f32 v68, v68
    v_exp_f32 v69, v69
    v_exp_f32 v70, v70
    v_exp_f32 v71, v71
    v_exp_f32 v72, v72
    v_exp_f32 v73, v73
    v_exp_f32 v74, v74
    v_exp_f32 v75, v75
    v_exp_f32 v76, v76
    v_exp_f32 v77, v77
    v_exp_f32 v78, v78
    v_exp_f32 v79, v79
    v_pk_add_f32 v[80:81], v[64:65], v[72:73]
    v_pk_add_f32 v[82:83], v[66:67], v[74:75]
    v_pk_add_f32 v[84:85], v[68:69], v[76:77]
    v_pk_add_f32 v[86:87], v[70:71], v[78:79]
    v_pk_add_f32 v[80:81], v[80:81], v[84:85]
    v_pk_add_f32 v[82:83], v[82:83], v[86:87]
    v_pk_add_f32 v[80:81], v[80:81], v[82:83]
    v_add_f32 v80, v80, v81
    v_rcp_f32_e64 v80, v80
    s_nop 0
    v_pk_mul_f32 v[64:65], v[64:65], v[80:81] op_sel_hi:[1,0]
    v_pk_mul_f32 v[66:67], v[66:67], v[80:81] op_sel_hi:[1,0]
    v_pk_mul_f32 v[68:69], v[68:69], v[80:81] op_sel_hi:[1,0]
    v_pk_mul_f32 v[70:71], v[70:71], v[80:81] op_sel_hi:[1,0]
    v_pk_mul_f32 v[72:73], v[72:73], v[80:81] op_sel_hi:[1,0]
    v_pk_mul_f32 v[74:75], v[74:75], v[80:81] op_sel_hi:[1,0]
    v_pk_mul_f32 v[76:77], v[76:77], v[80:81] op_sel_hi:[1,0]
    v_pk_mul_f32 v[78:79], v[78:79], v[80:81] op_sel_hi:[1,0]
    v_cvt_pk_bf16_f32 v104, v64, v65
    v_cvt_pk_bf16_f32 v105, v66, v67
    v_cvt_pk_bf16_f32 v106, v68, v69
    v_cvt_pk_bf16_f32 v107, v70, v71
    v_cvt_pk_bf16_f32 v108, v72, v73
    v_cvt_pk_bf16_f32 v109, v74, v75
    v_cvt_pk_bf16_f32 v110, v76, v77
    v_cvt_pk_bf16_f32 v111, v78, v79
L_kv49:

L_done50:
    buffer_load_dwordx4 v[48:51], v1, s[32:35], s99 offen sc1
    buffer_load_dword v52, v18, s[32:35], s99 offen offset:1024 sc1
    s_sub_u32 s56, s56, 1
    s_cselect_b32 s76, 0, 0x88888888
    s_mov_b32 s77, s76
    s_max_i32 s56, s56, 0
    s_waitcnt vmcnt(0)
    v_cmp_neq_f32 vcc, 4.0, v52
    v_cmp_neq_f32 s[44:45], 4.0, v51
    s_and_b64 vcc, vcc, s[100:101]
    s_or_b64 vcc, vcc, s[44:45]
    s_and_b64 vcc, vcc, s[76:77]
    s_cbranch_scc1 L_kv49
    v_cvt_pk_bf16_f32 v48, v48, v49
    v_cvt_pk_bf16_f32 v49, v50, v51
    v_cvt_pk_bf16_f32 v52, v52, v52
    ds_write_b64 v25, v[48:49]
    ds_write_b16 v26, v52 offset:30
    s_waitcnt lgkmcnt(0)
    s_barrier
    s_nop 0
    ds_read_b64_tr_b16 v[80:81], v27 offset:0
    ds_read_b64_tr_b16 v[82:83], v27 offset:160
    ds_read_b64_tr_b16 v[84:85], v27 offset:320
    ds_read_b64_tr_b16 v[86:87], v27 offset:480
    ds_read_b64_tr_b16 v[88:89], v27 offset:1280
    ds_read_b64_tr_b16 v[90:91], v27 offset:1440
    ds_read_b64_tr_b16 v[92:93], v27 offset:1600
    ds_read_b64_tr_b16 v[94:95], v27 offset:1760
    s_waitcnt lgkmcnt(6)
    v_mfma_f32_32x32x16_bf16 v[48:63], v[80:83], v[96:99], 0
    s_waitcnt lgkmcnt(4)
    v_mfma_f32_32x32x16_bf16 v[48:63], v[84:87], v[100:103], v[48:63]
    s_waitcnt lgkmcnt(2)
    v_mfma_f32_32x32x16_bf16 v[64:79], v[88:91], v[104:107], 0
    s_waitcnt lgkmcnt(0)
    v_mfma_f32_32x32x16_bf16 v[64:79], v[92:95], v[108:111], v[64:79]
    v_add_f32 v56, 0x358637bd, v56
    v_rcp_f32 v56, v56
    s_nop 0
    v_pk_mul_f32 v[48:49], v[48:49], v[56:57] op_sel_hi:[1,0]
    v_pk_mul_f32 v[50:51], v[50:51], v[56:57] op_sel_hi:[1,0]
    v_pk_mul_f32 v[52:53], v[52:53], v[56:57] op_sel_hi:[1,0]
    v_pk_mul_f32 v[54:55], v[54:55], v[56:57] op_sel_hi:[1,0]
    v_cvt_pk_bf16_f32 v60, v48, v49
    v_cvt_pk_bf16_f32 v61, v50, v51
    v_cvt_pk_bf16_f32 v62, v52, v53
    v_cvt_pk_bf16_f32 v63, v54, v55
    s_nop 0
    v_add_f32 v72, 0x358637bd, v72
    v_rcp_f32_e64 v72, v72
    s_nop 0
    v_pk_mul_f32 v[64:65], v[64:65], v[72:73] op_sel_hi:[1,0]
    v_pk_mul_f32 v[66:67], v[66:67], v[72:73] op_sel_hi:[1,0]
    v_pk_mul_f32 v[68:69], v[68:69], v[72:73] op_sel_hi:[1,0]
    v_pk_mul_f32 v[70:71], v[70:71], v[72:73] op_sel_hi:[1,0]
    v_cvt_pk_bf16_f32 v76, v64, v65
    v_cvt_pk_bf16_f32 v77, v66, v67
    v_cvt_pk_bf16_f32 v78, v68, v69
    v_cvt_pk_bf16_f32 v79, v70, v71
    s_cmp_lg_u32 s55, 0
    s_cbranch_scc1 L_slow_o51
    buffer_store_dwordx4 v[60:63], v1, s[32:35], s78 offen
    buffer_store_dwordx4 v[76:79], v1, s[32:35], s78 offen offset:1024
L_ret_o51:
    s_add_u32 m0, s69, 90112
    s_add_u32 s0, s66, 344064
    buffer_load_dwordx4 v7, s[16:19], s0 offen lds
    buffer_load_dwordx4 v11, s[20:23], s0 offen offset:1024 lds
    ds_read_b64_tr_b16 a[0:1], v21 offset:0
    ds_read_b64_tr_b16 a[2:3], v21 offset:512
    ds_read_b64_tr_b16 a[4:5], v22 offset:0
    ds_read_b64_tr_b16 a[6:7], v22 offset:512
    ds_read_b64_tr_b16 a[8:9], v21 offset:2048
    ds_read_b64_tr_b16 a[10:11], v21 offset:2560
    ds_read_b64_tr_b16 a[12:13], v22 offset:2048
    ds_read_b64_tr_b16 a[14:15], v22 offset:2560
    ds_read_b64_tr_b16 a[16:17], v21 offset:4096
    ds_read_b64_tr_b16 a[18:19], v21 offset:4608
    ds_read_b64_tr_b16 a[20:21], v22 offset:4096
    ds_read_b64_tr_b16 a[22:23], v22 offset:4608
    ds_read_b64_tr_b16 a[24:25], v21 offset:6144
    ds_read_b64_tr_b16 a[26:27], v21 offset:6656
    ds_read_b64_tr_b16 a[28:29], v22 offset:6144
    ds_read_b64_tr_b16 a[30:31], v22 offset:6656
    ds_read_b64_tr_b16 a[32:33], v21 offset:8192
    ds_read_b64_tr_b16 a[34:35], v21 offset:8704
    ds_read_b64_tr_b16 a[36:37], v22 offset:8192
    ds_read_b64_tr_b16 a[38:39], v22 offset:8704
    ds_read_b64_tr_b16 a[40:41], v21 offset:10240
    ds_read_b64_tr_b16 a[42:43], v21 offset:10752
    ds_read_b64_tr_b16 a[44:45], v22 offset:10240
    ds_read_b64_tr_b16 a[46:47], v22 offset:10752
    ds_read_b64_tr_b16 a[48:49], v21 offset:12288
    ds_read_b64_tr_b16 a[50:51], v21 offset:12800
    ds_read_b64_tr_b16 a[52:53], v22 offset:12288
    ds_read_b64_tr_b16 a[54:55], v22 offset:12800
    ds_read_b64_tr_b16 a[56:57], v21 offset:14336
    ds_read_b64_tr_b16 a[58:59], v21 offset:14848
    ds_read_b64_tr_b16 a[60:61], v22 offset:14336
    ds_read_b64_tr_b16 a[62:63], v22 offset:14848
    v_mov_b32 v30, 1
    s_waitcnt vmcnt(2)
    s_cmp_lg_u32 s55, 0
    s_cbranch_scc1 L_slow_f52
    buffer_store_dword v30, v28, s[32:35], s79 offen offset:512
L_ret_f52:
    ds_read_b64_tr_b16 a[64:65], v23 offset:0
    ds_read_b64_tr_b16 a[66:67], v23 offset:512
    ds_read_b64_tr_b16 a[68:69], v24 offset:0
    ds_read_b64_tr_b16 a[70:71], v24 offset:512
    ds_read_b64_tr_b16 a[72:73], v23 offset:2048
    ds_read_b64_tr_b16 a[74:75], v23 offset:2560
    ds_read_b64_tr_b16 a[76:77], v24 offset:2048
    ds_read_b64_tr_b16 a[78:79], v24 offset:2560
    ds_read_b64_tr_b16 a[80:81], v23 offset:4096
    ds_read_b64_tr_b16 a[82:83], v23 offset:4608
    ds_read_b64_tr_b16 a[84:85], v24 offset:4096
    ds_read_b64_tr_b16 a[86:87], v24 offset:4608
    ds_read_b64_tr_b16 a[88:89], v23 offset:6144
    ds_read_b64_tr_b16 a[90:91], v23 offset:6656
    ds_read_b64_tr_b16 a[92:93], v24 offset:6144
    ds_read_b64_tr_b16 a[94:95], v24 offset:6656
    ds_read_b64_tr_b16 a[96:97], v23 offset:8192
    ds_read_b64_tr_b16 a[98:99], v23 offset:8704
    ds_read_b64_tr_b16 a[100:101], v24 offset:8192
    ds_read_b64_tr_b16 a[102:103], v24 offset:8704
    ds_read_b64_tr_b16 a[104:105], v23 offset:10240
    ds_read_b64_tr_b16 a[106:107], v23 offset:10752
    ds_read_b64_tr_b16 a[108:109], v24 offset:10240
    ds_read_b64_tr_b16 a[110:111], v24 offset:10752
    ds_read_b64_tr_b16 a[112:113], v23 offset:12288
    ds_read_b64_tr_b16 a[114:115], v23 offset:12800
    ds_read_b64_tr_b16 a[116:117], v24 offset:12288
    ds_read_b64_tr_b16 a[118:119], v24 offset:12800
    ds_read_b64_tr_b16 a[120:121], v23 offset:14336
    ds_read_b64_tr_b16 a[122:123], v23 offset:14848
    ds_read_b64_tr_b16 a[124:125], v24 offset:14336
    ds_read_b64_tr_b16 a[126:127], v24 offset:14848
    v_and_b32 v14, 7, v9
    v_lshlrev_b32 v14, 2, v14
    s_lshl_b32 s57, s48, 12
    s_add_u32 s57, s57, 131072
    v_add_u32 v12, s57, v1
    v_xor_b32 v13, 0x2000, v12
    s_add_u32 s10, s4, L_k3_1-interleave_layers__linear_kernel_hedgehog__geglu_ffn__prompt_kernel
    s_addc_u32 s11, s5, 0
    s_load_dword s6, s[10:11], 0
    s_load_dword s7, s[10:11], 64
L_poll53:
    buffer_load_dword v30, v14, s[32:35], s80 offen offset:512 sc1
    s_sub_u32 s56, s56, 1
    s_cselect_b64 s[76:77], 0, -1
    s_max_i32 s56, s56, 0
    s_waitcnt vmcnt(0)
    v_cmp_eq_u32 vcc, 0, v30
    s_and_b64 vcc, vcc, s[76:77]
    s_cbranch_scc1 L_poll53
    buffer_load_dwordx4 v[128:131], v1, s[32:35], s81 offen offset:0 sc1
    buffer_load_dwordx4 v[132:135], v1, s[32:35], s81 offen offset:1024 sc1
    buffer_load_dwordx4 v[136:139], v1, s[32:35], s81 offen offset:2048 sc1
    buffer_load_dwordx4 v[140:143], v1, s[32:35], s81 offen offset:3072 sc1
    s_add_u32 s58, s81, 4096
    buffer_load_dwordx4 v[144:147], v1, s[32:35], s58 offen offset:0 sc1
    buffer_load_dwordx4 v[148:151], v1, s[32:35], s58 offen offset:1024 sc1
    buffer_load_dwordx4 v[152:155], v1, s[32:35], s58 offen offset:2048 sc1
    buffer_load_dwordx4 v[156:159], v1, s[32:35], s58 offen offset:3072 sc1
    s_waitcnt vmcnt(7) lgkmcnt(0)
    v_mfma_f32_32x32x16_bf16 v[64:79], a[4:7], v[128:131], 0
    s_add_u32 s58, s81, 8192
    buffer_load_dwordx4 v[160:163], v1, s[32:35], s58 offen offset:0 sc1
    v_mfma_f32_32x32x16_bf16 v[32:47], a[0:3], v[128:131], v[32:47]
    s_waitcnt vmcnt(7)
    v_mfma_f32_32x32x16_bf16 v[64:79], a[12:15], v[132:135], v[64:79]
    buffer_load_dwordx4 v[164:167], v1, s[32:35], s58 offen offset:1024 sc1
    v_mfma_f32_32x32x16_bf16 v[32:47], a[8:11], v[132:135], v[32:47]
    s_waitcnt vmcnt(7)
    v_mfma_f32_32x32x16_bf16 v[64:79], a[20:23], v[136:139], v[64:79]
    buffer_load_dwordx4 v[168:171], v1, s[32:35], s58 offen offset:2048 sc1
    v_mfma_f32_32x32x16_bf16 v[32:47], a[16:19], v[136:139], v[32:47]
    s_waitcnt vmcnt(7)
    v_mfma_f32_32x32x16_bf16 v[64:79], a[28:31], v[140:143], v[64:79]
    buffer_load_dwordx4 v[172:175], v1, s[32:35], s58 offen offset:3072 sc1
    s_barrier
    v_mfma_f32_32x32x16_bf16 v[32:47], a[24:27], v[140:143], v[32:47]
    s_waitcnt vmcnt(7)
    v_mfma_f32_32x32x16_bf16 v[64:79], a[36:39], v[144:147], v[64:79]
    s_add_u32 s58, s81, 12288
    buffer_load_dwordx4 v[176:179], v1, s[32:35], s58 offen offset:0 sc1
    v_mfma_f32_32x32x16_bf16 v[32:47], a[32:35], v[144:147], v[32:47]
    s_waitcnt vmcnt(7)
    v_mfma_f32_32x32x16_bf16 v[64:79], a[44:47], v[148:151], v[64:79]
    buffer_load_dwordx4 v[180:183], v1, s[32:35], s58 offen offset:1024 sc1
    v_mfma_f32_32x32x16_bf16 v[32:47], a[40:43], v[148:151], v[32:47]
    s_waitcnt vmcnt(7)
    v_mfma_f32_32x32x16_bf16 v[64:79], a[52:55], v[152:155], v[64:79]
    buffer_load_dwordx4 v[184:187], v1, s[32:35], s58 offen offset:2048 sc1
    v_mfma_f32_32x32x16_bf16 v[32:47], a[48:51], v[152:155], v[32:47]
    s_waitcnt vmcnt(7)
    v_mfma_f32_32x32x16_bf16 v[64:79], a[60:63], v[156:159], v[64:79]
    buffer_load_dwordx4 v[188:191], v1, s[32:35], s58 offen offset:3072 sc1
    v_mfma_f32_32x32x16_bf16 v[32:47], a[56:59], v[156:159], v[32:47]
    s_waitcnt vmcnt(7)
    v_mfma_f32_32x32x16_bf16 v[64:79], a[68:71], v[160:163], v[64:79]
    s_add_u32 m0, s69, 32768
    s_add_u32 s0, s66, 458752
    buffer_load_dwordx4 v7, s[16:19], s0 offen lds
    v_mfma_f32_32x32x16_bf16 v[32:47], a[64:67], v[160:163], v[32:47]
    s_waitcnt vmcnt(7)
    v_mfma_f32_32x32x16_bf16 v[64:79], a[76:79], v[164:167], v[64:79]
    buffer_load_dwordx4 v11, s[20:23], s0 offen offset:1024 lds
    v_mfma_f32_32x32x16_bf16 v[32:47], a[72:75], v[164:167], v[32:47]
    s_waitcnt vmcnt(7)
    v_mfma_f32_32x32x16_bf16 v[64:79], a[84:87], v[168:171], v[64:79]
    s_add_u32 m0, s69, 40960
    s_add_u32 s0, s66, 573440
    buffer_load_dwordx4 v7, s[16:19], s0 offen lds
    v_mfma_f32_32x32x16_bf16 v[32:47], a[80:83], v[168:171], v[32:47]
    s_waitcnt vmcnt(7)
    v_mfma_f32_32x32x16_bf16 v[64:79], a[92:95], v[172:175], v[64:79]
    buffer_load_dwordx4 v11, s[20:23], s0 offen offset:1024 lds
    s_waitcnt vmcnt(7)
    v_mfma_f32_32x32x16_bf16 v[64:79], a[100:103], v[176:179], v[64:79]
    s_add_u32 m0, s70, 0
    s_add_u32 s0, s67, 0
    buffer_load_dwordx4 v6, s[24:27], s0 offen lds
    s_waitcnt vmcnt(7)
    v_mfma_f32_32x32x16_bf16 v[64:79], a[108:111], v[180:183], v[64:79]
    buffer_load_dwordx4 v10, s[24:27], s0 offen offset:1024 lds
    s_waitcnt vmcnt(7)
    v_mfma_f32_32x32x16_bf16 v[64:79], a[116:119], v[184:187], v[64:79]
    s_add_u32 m0, s70, 2048
    s_add_u32 s0, s67, 16384
    buffer_load_dwordx4 v6, s[24:27], s0 offen lds
    s_waitcnt vmcnt(7)
    v_mfma_f32_32x32x16_bf16 v[64:79], a[124:127], v[188:191], v[64:79]
    buffer_load_dwordx4 v10, s[24:27], s0 offen offset:1024 lds
    v_mfma_f32_32x32x16_bf16 v[32:47], a[88:91], v[172:175], v[32:47]
    v_mfma_f32_32x32x16_bf16 v[32:47], a[96:99], v[176:179], v[32:47]
    ds_write_b128 v12, v[64:67] offset:0
    v_mfma_f32_32x32x16_bf16 v[32:47], a[104:107], v[180:183], v[32:47]
    ds_write_b128 v12, v[68:71] offset:1024
    v_mfma_f32_32x32x16_bf16 v[32:47], a[112:115], v[184:187], v[32:47]
    ds_write_b128 v12, v[72:75] offset:2048
    v_mfma_f32_32x32x16_bf16 v[32:47], a[120:123], v[188:191], v[32:47]
    ds_write_b128 v12, v[76:79] offset:3072
    s_waitcnt lgkmcnt(0)
    s_barrier
    ds_read_b128 v[64:67], v13 offset:0
    ds_read_b128 v[68:71], v13 offset:1024
    ds_read_b128 v[72:75], v13 offset:2048
    ds_read_b128 v[76:79], v13 offset:3072
    s_waitcnt lgkmcnt(3)
    s_nop 3
    v_pk_add_f32 v[32:33], v[32:33], v[64:65]
    v_pk_add_f32 v[34:35], v[34:35], v[66:67]
    s_waitcnt lgkmcnt(2)
    v_pk_add_f32 v[36:37], v[36:37], v[68:69]
    v_pk_add_f32 v[38:39], v[38:39], v[70:71]
    s_waitcnt lgkmcnt(1)
    v_pk_add_f32 v[40:41], v[40:41], v[72:73]
    v_pk_add_f32 v[42:43], v[42:43], v[74:75]
    s_waitcnt lgkmcnt(0)
    v_pk_add_f32 v[44:45], v[44:45], v[76:77]
    v_pk_add_f32 v[46:47], v[46:47], v[78:79]
    v_cvt_pk_bf16_f32 v48, v32, v33
    v_cvt_pk_bf16_f32 v49, v34, v35
    v_cvt_pk_bf16_f32 v50, v36, v37
    v_cvt_pk_bf16_f32 v51, v38, v39
    v_cvt_pk_bf16_f32 v52, v40, v41
    v_cvt_pk_bf16_f32 v53, v42, v43
    v_cvt_pk_bf16_f32 v54, v44, v45
    v_cvt_pk_bf16_f32 v55, v46, v47
    s_cmp_lg_u32 s55, 0
    s_cbranch_scc1 L_slow_x54
    buffer_store_dwordx4 v[48:51], v1, s[32:35], s82 offen
    buffer_store_dwordx4 v[52:55], v1, s[32:35], s82 offen offset:1024
L_ret_x54:
    v_pk_add_f32 v[56:57], v[32:33], v[34:35]
    v_pk_mul_f32 v[58:59], v[32:33], v[32:33]
    v_pk_fma_f32 v[58:59], v[34:35], v[34:35], v[58:59]
    v_pk_add_f32 v[56:57], v[56:57], v[36:37]
    v_pk_fma_f32 v[58:59], v[36:37], v[36:37], v[58:59]
    v_pk_add_f32 v[56:57], v[56:57], v[38:39]
    v_pk_fma_f32 v[58:59], v[38:39], v[38:39], v[58:59]
    v_pk_add_f32 v[56:57], v[56:57], v[40:41]
    v_pk_fma_f32 v[58:59], v[40:41], v[40:41], v[58:59]
    v_pk_add_f32 v[56:57], v[56:57], v[42:43]
    v_pk_fma_f32 v[58:59], v[42:43], v[42:43], v[58:59]
    v_pk_add_f32 v[56:57], v[56:57], v[44:45]
    v_pk_fma_f32 v[58:59], v[44:45], v[44:45], v[58:59]
    v_pk_add_f32 v[56:57], v[56:57], v[46:47]
    v_pk_fma_f32 v[58:59], v[46:47], v[46:47], v[58:59]
    v_add_f32 v56, v56, v57
    v_add_f32 v57, v58, v59
    v_mov_b32 v58, v56
    v_mov_b32 v59, v57
    v_lshrrev_b32 v60, 5, v9
    v_lshl_add_u32 v60, v60, 28, v1
    v_permlane32_swap_b32 v56, v58
    v_permlane32_swap_b32 v57, v59
    v_pk_add_f32 v[56:57], v[56:57], v[58:59]
    s_cmp_lg_u32 s55, 0
    s_cbranch_scc1 L_slow_s55
    buffer_store_dwordx2 v[56:57], v60, s[32:35], s83 offen
L_ret_s55:
    v_mov_b32 v30, 1
    s_waitcnt vmcnt(1)
    s_cmp_lg_u32 s55, 0
    s_cbranch_scc1 L_slow_f56
    buffer_store_dword v30, v28, s[32:35], s84 offen offset:512
L_ret_f56:
    v_mov_b32 v30, 1
    s_waitcnt vmcnt(1)
    s_cmp_lg_u32 s55, 0
    s_cbranch_scc1 L_slow_f57
    buffer_store_dword v30, v28, s[32:35], s84 offen offset:2048
L_ret_f57:
L_k3_1:
    v_and_b32 v12, 31, v9
    v_lshlrev_b32 v22, 3, v12
    v_lshlrev_b32 v12, 2, v12
    v_add_u32 v18, s70, v3
    v_xor_b32 v19, 64, v18
    v_add_u32 v20, 131072, v18
    v_add_u32 v21, 131072, v19
    v_and_b32 v23, 7, v9
    v_min_u32 v23, 6, v23
    v_lshlrev_b32 v23, 2, v23
    s_lshl2_add_u32 s1, s49, s48
    s_lshl_b32 s1, s1, 11
    s_add_u32 s1, s1, 28901376
    s_lshl2_add_u32 s2, s48, s62
    s_add_u32 s2, s2, 6144
    s_lshr_b32 s57, s53, 1
    s_mul_i32 s47, s57, 12288
    s_and_b32 s57, s53, 1
    s_lshl_b32 s57, s57, 9
    s_add_u32 s47, s47, s57
    s_add_u32 s47, s47, 11264
    s_cmp_ge_u32 s50, 28
    s_cbranch_scc1 L_idle1
    v_add_u32 v13, 65536, v4
    v_xor_b32 v14, 32, v13
    v_xor_b32 v15, 64, v13
    v_xor_b32 v16, 96, v13
    v_add_u32 v22, 162816, v22
    v_add_u32 v17, 0x8000, v1
    v_mov_b32 v246, 0
    v_mov_b32 v247, 0
    v_mov_b32 v254, 0
    v_mov_b32 v255, 0
L_poll58:
    buffer_load_dword v30, v12, s[32:35], s85 offen offset:512 sc1
    s_sub_u32 s56, s56, 1
    s_cselect_b64 s[76:77], 0, -1
    s_max_i32 s56, s56, 0
    s_waitcnt vmcnt(0)
    v_cmp_eq_u32 vcc, 0, v30
    s_and_b64 vcc, vcc, s[76:77]
    s_cbranch_scc1 L_poll58
    buffer_load_dwordx4 v[176:179], v1, s[32:35], s87 offen offset:0 sc1
    buffer_load_dwordx4 v[180:183], v17, s[32:35], s87 offen offset:0 sc1
    buffer_load_dwordx4 v[184:187], v1, s[32:35], s87 offen offset:1024 sc1
    buffer_load_dwordx4 v[188:191], v17, s[32:35], s87 offen offset:1024 sc1
    s_barrier
    ds_read_b64_tr_b16 a[224:225], v13 offset:0
    ds_read_b64_tr_b16 a[226:227], v13 offset:512
    ds_read_b64_tr_b16 a[228:229], v14 offset:0
    ds_read_b64_tr_b16 a[230:231], v14 offset:512
    ds_read_b64_tr_b16 a[232:233], v15 offset:0
    ds_read_b64_tr_b16 a[234:235], v15 offset:512
    ds_read_b64_tr_b16 a[236:237], v16 offset:0
    ds_read_b64_tr_b16 a[238:239], v16 offset:512
    s_waitcnt vmcnt(3) lgkmcnt(6)
    v_mfma_f32_32x32x16_bf16 v[48:63], a[224:227], v[176:179], 0
    buffer_load_dwordx4 v[192:195], v1, s[32:35], s87 offen offset:2048 sc1
    s_waitcnt vmcnt(3)
    v_mfma_f32_32x32x16_bf16 v[112:127], a[224:227], v[180:183], 0
    ds_read_b64_tr_b16 a[240:241], v13 offset:4096
    ds_read_b64_tr_b16 a[242:243], v13 offset:4608
    s_waitcnt lgkmcnt(6)
    v_mfma_f32_32x32x16_bf16 v[64:79], a[228:231], v[176:179], 0
    buffer_load_dwordx4 v[196:199], v17, s[32:35], s87 offen offset:2048 sc1
    v_mfma_f32_32x32x16_bf16 v[128:143], a[228:231], v[180:183], 0
    ds_read_b64_tr_b16 a[244:245], v14 offset:4096
    ds_read_b64_tr_b16 a[246:247], v14 offset:4608
    ds_read_b64_tr_b16 a[0:1], v18 offset:0
    ds_read_b64_tr_b16 a[2:3], v18 offset:512
    ds_read_b64_tr_b16 a[4:5], v19 offset:0
    ds_read_b64_tr_b16 a[6:7], v19 offset:512
    s_waitcnt lgkmcnt(10)
    v_mfma_f32_32x32x16_bf16 v[80:95], a[232:235], v[176:179], 0
    buffer_load_dwordx4 v[200:203], v1, s[32:35], s87 offen offset:3072 sc1
    v_mfma_f32_32x32x16_bf16 v[144:159], a[232:235], v[180:183], 0
    ds_read_b64_tr_b16 a[224:225], v15 offset:4096
    ds_read_b64_tr_b16 a[226:227], v15 offset:4608
    s_waitcnt lgkmcnt(10)
    v_mfma_f32_32x32x16_bf16 v[96:111], a[236:239], v[176:179], 0
    buffer_load_dwordx4 v[204:207], v17, s[32:35], s87 offen offset:3072 sc1
    v_mfma_f32_32x32x16_bf16 v[160:175], a[236:239], v[180:183], 0
    ds_read_b64_tr_b16 a[228:229], v16 offset:4096
    ds_read_b64_tr_b16 a[230:231], v16 offset:4608
    s_waitcnt vmcnt(5) lgkmcnt(10)
    v_mfma_f32_32x32x16_bf16 v[48:63], a[240:243], v[184:187], v[48:63]
    s_add_u32 s58, s87, 4096
    buffer_load_dwordx4 v[208:211], v1, s[32:35], s58 offen offset:0 sc1
    s_waitcnt vmcnt(5)
    v_mfma_f32_32x32x16_bf16 v[112:127], a[240:243], v[188:191], v[112:127]
    ds_read_b64_tr_b16 a[232:233], v13 offset:8192
    ds_read_b64_tr_b16 a[234:235], v13 offset:8704
    s_waitcnt lgkmcnt(10)
    v_mfma_f32_32x32x16_bf16 v[64:79], a[244:247], v[184:187], v[64:79]
    buffer_load_dwordx4 v[212:215], v17, s[32:35], s58 offen offset:0 sc1
    v_mfma_f32_32x32x16_bf16 v[128:143], a[244:247], v[188:191], v[128:143]
    ds_read_b64_tr_b16 a[236:237], v14 offset:8192
    ds_read_b64_tr_b16 a[238:239], v14 offset:8704
    ds_read_b64_tr_b16 a[8:9], v18 offset:2048
    ds_read_b64_tr_b16 a[10:11], v18 offset:2560
    ds_read_b64_tr_b16 a[12:13], v19 offset:2048
    ds_read_b64_tr_b16 a[14:15], v19 offset:2560
    s_waitcnt lgkmcnt(10)
    v_mfma_f32_32x32x16_bf16 v[80:95], a[224:227], v[184:187], v[80:95]
    buffer_load_dwordx4 v[216:219], v1, s[32:35], s58 offen offset:1024 sc1
    v_mfma_f32_32x32x16_bf16 v[144:159], a[224:227], v[188:191], v[144:159]
    ds_read_b64_tr_b16 a[240:241], v15 offset:8192
    ds_read_b64_tr_b16 a[242:243], v15 offset:8704
    s_waitcnt lgkmcnt(10)
    v_mfma_f32_32x32x16_bf16 v[96:111], a[228:231], v[184:187], v[96:111]
    buffer_load_dwordx4 v[220:223], v17, s[32:35], s58 offen offset:1024 sc1
    v_mfma_f32_32x32x16_bf16 v[160:175], a[228:231], v[188:191], v[160:175]
    ds_read_b64_tr_b16 a[244:245], v16 offset:8192
    ds_read_b64_tr_b16 a[246:247], v16 offset:8704
    s_waitcnt vmcnt(7) lgkmcnt(10)
    v_mfma_f32_32x32x16_bf16 v[48:63], a[232:235], v[192:195], v[48:63]
    buffer_load_dwordx4 v[224:227], v1, s[32:35], s58 offen offset:2048 sc1
    s_waitcnt vmcnt(7)
    v_mfma_f32_32x32x16_bf16 v[112:127], a[232:235], v[196:199], v[112:127]
    ds_read_b64_tr_b16 a[224:225], v13 offset:12288
    ds_read_b64_tr_b16 a[226:227], v13 offset:12800
    s_waitcnt lgkmcnt(10)
    v_mfma_f32_32x32x16_bf16 v[64:79], a[236:239], v[192:195], v[64:79]
    s_add_u32 m0, s69, 49152
    s_add_u32 s0, s66, 688128
    buffer_load_dwordx4 v7, s[16:19], s0 offen lds
    v_mfma_f32_32x32x16_bf16 v[128:143], a[236:239], v[196:199], v[128:143]
    ds_read_b64_tr_b16 a[228:229], v14 offset:12288
    ds_read_b64_tr_b16 a[230:231], v14 offset:12800
    s_waitcnt lgkmcnt(6)
    v_mfma_f32_32x32x16_bf16 v[80:95], a[240:243], v[192:195], v[80:95]
    buffer_load_dwordx4 v[228:231], v17, s[32:35], s58 offen offset:2048 sc1
    v_mfma_f32_32x32x16_bf16 v[144:159], a[240:243], v[196:199], v[144:159]
    ds_read_b64_tr_b16 a[232:233], v15 offset:12288
    ds_read_b64_tr_b16 a[234:235], v15 offset:12800
    s_waitcnt lgkmcnt(6)
    v_mfma_f32_32x32x16_bf16 v[96:111], a[244:247], v[192:195], v[96:111]
    buffer_load_dwordx4 v[232:235], v1, s[32:35], s58 offen offset:3072 sc1
    buffer_load_dwordx4 v[236:239], v17, s[32:35], s58 offen offset:3072 sc1
    v_mfma_f32_32x32x16_bf16 v[160:175], a[244:247], v[196:199], v[160:175]
    ds_read_b64_tr_b16 a[236:237], v16 offset:12288
    ds_read_b64_tr_b16 a[238:239], v16 offset:12800
    s_waitcnt vmcnt(10) lgkmcnt(6)
    v_mfma_f32_32x32x16_bf16 v[48:63], a[224:227], v[200:203], v[48:63]
    s_add_u32 s58, s87, 8192
    buffer_load_dwordx4 v[176:179], v1, s[32:35], s58 offen offset:0 sc1
    s_waitcnt vmcnt(10)
    v_mfma_f32_32x32x16_bf16 v[112:127], a[224:227], v[204:207], v[112:127]
    ds_read_b64_tr_b16 a[240:241], v13 offset:16384
    ds_read_b64_tr_b16 a[242:243], v13 offset:16896
    s_waitcnt lgkmcnt(6)
    v_mfma_f32_32x32x16_bf16 v[64:79], a[228:231], v[200:203], v[64:79]
    s_add_u32 m0, s69, 49152
    s_add_u32 s0, s66, 688128
    buffer_load_dwordx4 v11, s[20:23], s0 offen offset:1024 lds
    v_mfma_f32_32x32x16_bf16 v[128:143], a[228:231], v[204:207], v[128:143]
    ds_read_b64_tr_b16 a[244:245], v14 offset:16384
    ds_read_b64_tr_b16 a[246:247], v14 offset:16896
    s_waitcnt lgkmcnt(6)
    v_mfma_f32_32x32x16_bf16 v[80:95], a[232:235], v[200:203], v[80:95]
    buffer_load_dwordx4 v[180:183], v17, s[32:35], s58 offen offset:0 sc1
    v_mfma_f32_32x32x16_bf16 v[144:159], a[232:235], v[204:207], v[144:159]
    ds_read_b64_tr_b16 a[224:225], v15 offset:16384
    ds_read_b64_tr_b16 a[226:227], v15 offset:16896
    s_waitcnt lgkmcnt(6)
    v_mfma_f32_32x32x16_bf16 v[96:111], a[236:239], v[200:203], v[96:111]
    buffer_load_dwordx4 v[184:187], v1, s[32:35], s58 offen offset:1024 sc1
    buffer_load_dwordx4 v[188:191], v17, s[32:35], s58 offen offset:1024 sc1
    v_mfma_f32_32x32x16_bf16 v[160:175], a[236:239], v[204:207], v[160:175]
    ds_read_b64_tr_b16 a[228:229], v16 offset:16384
    ds_read_b64_tr_b16 a[230:231], v16 offset:16896
    s_waitcnt vmcnt(13) lgkmcnt(6)
    v_mfma_f32_32x32x16_bf16 v[48:63], a[240:243], v[208:211], v[48:63]
    buffer_load_dwordx4 v[192:195], v1, s[32:35], s58 offen offset:2048 sc1
    s_waitcnt vmcnt(13)
    v_mfma_f32_32x32x16_bf16 v[112:127], a[240:243], v[212:215], v[112:127]
    ds_read_b64_tr_b16 a[232:233], v13 offset:20480
    ds_read_b64_tr_b16 a[234:235], v13 offset:20992
    s_waitcnt lgkmcnt(6)
    v_mfma_f32_32x32x16_bf16 v[64:79], a[244:247], v[208:211], v[64:79]
    s_add_u32 m0, s69, 57344
    s_add_u32 s0, s66, 802816
    buffer_load_dwordx4 v7, s[16:19], s0 offen lds
    v_mfma_f32_32x32x16_bf16 v[128:143], a[244:247], v[212:215], v[128:143]
    ds_read_b64_tr_b16 a[236:237], v14 offset:20480
    ds_read_b64_tr_b16 a[238:239], v14 offset:20992
    s_waitcnt lgkmcnt(6)
    v_mfma_f32_32x32x16_bf16 v[80:95], a[224:227], v[208:211], v[80:95]
    buffer_load_dwordx4 v[196:199], v17, s[32:35], s58 offen offset:2048 sc1
    v_mfma_f32_32x32x16_bf16 v[144:159], a[224:227], v[212:215], v[144:159]
    ds_read_b64_tr_b16 a[240:241], v15 offset:20480
    ds_read_b64_tr_b16 a[242:243], v15 offset:20992
    s_waitcnt lgkmcnt(6)
    v_mfma_f32_32x32x16_bf16 v[96:111], a[228:231], v[208:211], v[96:111]
    v_mfma_f32_32x32x16_bf16 v[160:175], a[228:231], v[212:215], v[160:175]
    ds_read_b64_tr_b16 a[244:245], v16 offset:20480
    ds_read_b64_tr_b16 a[246:247], v16 offset:20992
    s_waitcnt vmcnt(14) lgkmcnt(6)
    v_mfma_f32_32x32x16_bf16 v[48:63], a[232:235], v[216:219], v[48:63]
    buffer_load_dwordx4 v[200:203], v1, s[32:35], s58 offen offset:3072 sc1
    s_waitcnt vmcnt(14)
    v_mfma_f32_32x32x16_bf16 v[112:127], a[232:235], v[220:223], v[112:127]
    ds_read_b64_tr_b16 a[224:225], v13 offset:24576
    ds_read_b64_tr_b16 a[226:227], v13 offset:25088
    s_waitcnt lgkmcnt(6)
    v_mfma_f32_32x32x16_bf16 v[64:79], a[236:239], v[216:219], v[64:79]
    s_add_u32 m0, s69, 57344
    s_add_u32 s0, s66, 802816
    buffer_load_dwordx4 v11, s[20:23], s0 offen offset:1024 lds
    v_mfma_f32_32x32x16_bf16 v[128:143], a[236:239], v[220:223], v[128:143]
    ds_read_b64_tr_b16 a[228:229], v14 offset:24576
    ds_read_b64_tr_b16 a[230:231], v14 offset:25088
    s_waitcnt lgkmcnt(6)
    v_mfma_f32_32x32x16_bf16 v[80:95], a[240:243], v[216:219], v[80:95]
    buffer_load_dwordx4 v[204:207], v17, s[32:35], s58 offen offset:3072 sc1
    v_mfma_f32_32x32x16_bf16 v[144:159], a[240:243], v[220:223], v[144:159]
    ds_read_b64_tr_b16 a[232:233], v15 offset:24576
    ds_read_b64_tr_b16 a[234:235], v15 offset:25088
    s_waitcnt lgkmcnt(6)
    v_mfma_f32_32x32x16_bf16 v[96:111], a[244:247], v[216:219], v[96:111]
    s_add_u32 m0, s70, 4096
    s_add_u32 s0, s67, 32768
    buffer_load_dwordx4 v6, s[24:27], s0 offen lds
    v_mfma_f32_32x32x16_bf16 v[160:175], a[244:247], v[220:223], v[160:175]
    ds_read_b64_tr_b16 a[236:237], v16 offset:24576
    ds_read_b64_tr_b16 a[238:239], v16 offset:25088
    s_waitcnt vmcnt(16) lgkmcnt(6)
    v_mfma_f32_32x32x16_bf16 v[48:63], a[224:227], v[224:227], v[48:63]
    s_add_u32 s58, s87, 12288
    buffer_load_dwordx4 v[208:211], v1, s[32:35], s58 offen offset:0 sc1
    s_waitcnt vmcnt(15)
    v_mfma_f32_32x32x16_bf16 v[112:127], a[224:227], v[228:231], v[112:127]
    ds_read_b64_tr_b16 a[240:241], v13 offset:28672
    ds_read_b64_tr_b16 a[242:243], v13 offset:29184
    s_waitcnt lgkmcnt(6)
    v_mfma_f32_32x32x16_bf16 v[64:79], a[228:231], v[224:227], v[64:79]
    s_add_u32 m0, s70, 4096
    s_add_u32 s0, s67, 32768
    buffer_load_dwordx4 v10, s[24:27], s0 offen offset:1024 lds
    v_mfma_f32_32x32x16_bf16 v[128:143], a[228:231], v[228:231], v[128:143]
    ds_read_b64_tr_b16 a[244:245], v14 offset:28672
    ds_read_b64_tr_b16 a[246:247], v14 offset:29184
    s_waitcnt lgkmcnt(6)
    v_mfma_f32_32x32x16_bf16 v[80:95], a[232:235], v[224:227], v[80:95]
    buffer_load_dwordx4 v[212:215], v17, s[32:35], s58 offen offset:0 sc1
    v_mfma_f32_32x32x16_bf16 v[144:159], a[232:235], v[228:231], v[144:159]
    ds_read_b64_tr_b16 a[224:225], v15 offset:28672
    ds_read_b64_tr_b16 a[226:227], v15 offset:29184
    s_waitcnt lgkmcnt(6)
    v_mfma_f32_32x32x16_bf16 v[96:111], a[236:239], v[224:227], v[96:111]
    s_add_u32 m0, s69, 98304
    s_add_u32 s0, s66, 917504
    buffer_load_dwordx4 v7, s[16:19], s0 offen lds
    v_mfma_f32_32x32x16_bf16 v[160:175], a[236:239], v[228:231], v[160:175]
    ds_read_b64_tr_b16 a[228:229], v16 offset:28672
    ds_read_b64_tr_b16 a[230:231], v16 offset:29184
    s_waitcnt vmcnt(17) lgkmcnt(6)
    v_mfma_f32_32x32x16_bf16 v[48:63], a[240:243], v[232:235], v[48:63]
    buffer_load_dwordx4 v[216:219], v1, s[32:35], s58 offen offset:1024 sc1
    s_waitcnt vmcnt(17)
    v_mfma_f32_32x32x16_bf16 v[112:127], a[240:243], v[236:239], v[112:127]
    v_subrev_u32 v13, 32768, v13
    v_subrev_u32 v14, 32768, v14
    v_subrev_u32 v15, 32768, v15
    v_subrev_u32 v16, 32768, v16
    ds_read_b64_tr_b16 a[232:233], v13 offset:0
    ds_read_b64_tr_b16 a[234:235], v13 offset:512
    s_waitcnt lgkmcnt(6)
    v_mfma_f32_32x32x16_bf16 v[64:79], a[244:247], v[232:235], v[64:79]
    s_add_u32 m0, s69, 98304
    s_add_u32 s0, s66, 917504
    buffer_load_dwordx4 v11, s[20:23], s0 offen offset:1024 lds
    v_mfma_f32_32x32x16_bf16 v[128:143], a[244:247], v[236:239], v[128:143]
    ds_read_b64_tr_b16 a[236:237], v14 offset:0
    ds_read_b64_tr_b16 a[238:239], v14 offset:512
    s_waitcnt lgkmcnt(6)
    v_mfma_f32_32x32x16_bf16 v[80:95], a[224:227], v[232:235], v[80:95]
    buffer_load_dwordx4 v[220:223], v17, s[32:35], s58 offen offset:1024 sc1
    v_mfma_f32_32x32x16_bf16 v[144:159], a[224:227], v[236:239], v[144:159]
    ds_read_b64_tr_b16 a[240:241], v15 offset:0
    ds_read_b64_tr_b16 a[242:243], v15 offset:512
    s_waitcnt lgkmcnt(6)
    v_mfma_f32_32x32x16_bf16 v[96:111], a[228:231], v[232:235], v[96:111]
    s_add_u32 m0, s70, 6144
    s_add_u32 s0, s67, 49152
    buffer_load_dwordx4 v6, s[24:27], s0 offen lds
    v_mfma_f32_32x32x16_bf16 v[160:175], a[228:231], v[236:239], v[160:175]
    ds_read_b64_tr_b16 a[244:245], v16 offset:0
    ds_read_b64_tr_b16 a[246:247], v16 offset:512
    s_waitcnt vmcnt(19) lgkmcnt(6)
    v_mfma_f32_32x32x16_bf16 v[48:63], a[232:235], v[176:179], v[48:63]
    buffer_load_dwordx4 v[224:227], v1, s[32:35], s58 offen offset:2048 sc1
    s_waitcnt vmcnt(18)
    v_mfma_f32_32x32x16_bf16 v[112:127], a[232:235], v[180:183], v[112:127]
    ds_read_b64_tr_b16 a[224:225], v13 offset:4096
    ds_read_b64_tr_b16 a[226:227], v13 offset:4608
    s_waitcnt lgkmcnt(6)
    v_mfma_f32_32x32x16_bf16 v[64:79], a[236:239], v[176:179], v[64:79]
    s_add_u32 m0, s70, 6144
    s_add_u32 s0, s67, 49152
    buffer_load_dwordx4 v10, s[24:27], s0 offen offset:1024 lds
    v_mfma_f32_32x32x16_bf16 v[128:143], a[236:239], v[180:183], v[128:143]
    ds_read_b64_tr_b16 a[228:229], v14 offset:4096
    ds_read_b64_tr_b16 a[230:231], v14 offset:4608
    s_waitcnt lgkmcnt(6)
    v_mfma_f32_32x32x16_bf16 v[80:95], a[240:243], v[176:179], v[80:95]
    buffer_load_dwordx4 v[228:231], v17, s[32:35], s58 offen offset:2048 sc1
    v_mfma_f32_32x32x16_bf16 v[144:159], a[240:243], v[180:183], v[144:159]
    ds_read_b64_tr_b16 a[232:233], v15 offset:4096
    ds_read_b64_tr_b16 a[234:235], v15 offset:4608
    s_waitcnt lgkmcnt(6)
    v_mfma_f32_32x32x16_bf16 v[96:111], a[244:247], v[176:179], v[96:111]
    s_add_u32 m0, s69, 106496
    s_add_u32 s0, s66, 1032192
    buffer_load_dwordx4 v7, s[16:19], s0 offen lds
    v_mfma_f32_32x32x16_bf16 v[160:175], a[244:247], v[180:183], v[160:175]
    ds_read_b64_tr_b16 a[236:237], v16 offset:4096
    ds_read_b64_tr_b16 a[238:239], v16 offset:4608
    s_waitcnt vmcnt(20) lgkmcnt(6)
    v_mfma_f32_32x32x16_bf16 v[48:63], a[224:227], v[184:187], v[48:63]
    buffer_load_dwordx4 v[232:235], v1, s[32:35], s58 offen offset:3072 sc1
    s_waitcnt vmcnt(20)
    v_mfma_f32_32x32x16_bf16 v[112:127], a[224:227], v[188:191], v[112:127]
    s_waitcnt vmcnt(15)
    s_barrier
    ds_read_b64_tr_b16 a[240:241], v13 offset:8192
    ds_read_b64_tr_b16 a[242:243], v13 offset:8704
    s_waitcnt lgkmcnt(6)
    v_mfma_f32_32x32x16_bf16 v[64:79], a[228:231], v[184:187], v[64:79]
    s_add_u32 m0, s69, 106496
    s_add_u32 s0, s66, 1032192
    buffer_load_dwordx4 v11, s[20:23], s0 offen offset:1024 lds
    v_mfma_f32_32x32x16_bf16 v[128:143], a[228:231], v[188:191], v[128:143]
    ds_read_b64_tr_b16 a[244:245], v14 offset:8192
    ds_read_b64_tr_b16 a[246:247], v14 offset:8704
    s_waitcnt vmcnt(12)
    ds_read_b64_tr_b16 a[16:17], v18 offset:4096
    ds_read_b64_tr_b16 a[18:19], v18 offset:4608
    ds_read_b64_tr_b16 a[20:21], v19 offset:4096
    ds_read_b64_tr_b16 a[22:23], v19 offset:4608
    s_waitcnt lgkmcnt(10)
    v_mfma_f32_32x32x16_bf16 v[80:95], a[232:235], v[184:187], v[80:95]
    buffer_load_dwordx4 v[236:239], v17, s[32:35], s58 offen offset:3072 sc1
    v_mfma_f32_32x32x16_bf16 v[144:159], a[232:235], v[188:191], v[144:159]
    ds_read_b64_tr_b16 a[224:225], v15 offset:8192
    ds_read_b64_tr_b16 a[226:227], v15 offset:8704
    s_waitcnt lgkmcnt(10)
    v_mfma_f32_32x32x16_bf16 v[96:111], a[236:239], v[184:187], v[96:111]
    s_add_u32 m0, s70, 131072
    s_add_u32 s0, s67, 65536
    buffer_load_dwordx4 v6, s[24:27], s0 offen lds
    v_mfma_f32_32x32x16_bf16 v[160:175], a[236:239], v[188:191], v[160:175]
    ds_read_b64_tr_b16 a[228:229], v16 offset:8192
    ds_read_b64_tr_b16 a[230:231], v16 offset:8704
    s_waitcnt lgkmcnt(10)
    v_mfma_f32_32x32x16_bf16 v[48:63], a[240:243], v[192:195], v[48:63]
    s_add_u32 s58, s87, 16384
    buffer_load_dwordx4 v[176:179], v1, s[32:35], s58 offen offset:0 sc1
    v_mfma_f32_32x32x16_bf16 v[112:127], a[240:243], v[196:199], v[112:127]
    ds_read_b64_tr_b16 a[232:233], v13 offset:12288
    ds_read_b64_tr_b16 a[234:235], v13 offset:12800
    s_waitcnt lgkmcnt(10)
    v_mfma_f32_32x32x16_bf16 v[64:79], a[244:247], v[192:195], v[64:79]
    s_add_u32 m0, s70, 131072
    s_add_u32 s0, s67, 65536
    buffer_load_dwordx4 v10, s[24:27], s0 offen offset:1024 lds
    v_mfma_f32_32x32x16_bf16 v[128:143], a[244:247], v[196:199], v[128:143]
    ds_read_b64_tr_b16 a[236:237], v14 offset:12288
    ds_read_b64_tr_b16 a[238:239], v14 offset:12800
    s_waitcnt lgkmcnt(6)
    v_mfma_f32_32x32x16_bf16 v[80:95], a[224:227], v[192:195], v[80:95]
    buffer_load_dwordx4 v[180:183], v17, s[32:35], s58 offen offset:0 sc1
    v_mfma_f32_32x32x16_bf16 v[144:159], a[224:227], v[196:199], v[144:159]
    ds_read_b64_tr_b16 a[240:241], v15 offset:12288
    ds_read_b64_tr_b16 a[242:243], v15 offset:12800
    s_waitcnt lgkmcnt(6)
    v_mfma_f32_32x32x16_bf16 v[96:111], a[228:231], v[192:195], v[96:111]
    s_add_u32 m0, s69, 114688
    s_add_u32 s0, s66, 1146880
    buffer_load_dwordx4 v7, s[16:19], s0 offen lds
    v_mfma_f32_32x32x16_bf16 v[160:175], a[228:231], v[196:199], v[160:175]
    ds_read_b64_tr_b16 a[244:245], v16 offset:12288
    ds_read_b64_tr_b16 a[246:247], v16 offset:12800
    s_waitcnt lgkmcnt(6)
    v_mfma_f32_32x32x16_bf16 v[48:63], a[232:235], v[200:203], v[48:63]
    buffer_load_dwordx4 v[184:187], v1, s[32:35], s58 offen offset:1024 sc1
    v_mfma_f32_32x32x16_bf16 v[112:127], a[232:235], v[204:207], v[112:127]
    ds_read_b64_tr_b16 a[224:225], v13 offset:16384
    ds_read_b64_tr_b16 a[226:227], v13 offset:16896
    s_waitcnt lgkmcnt(6)
    v_mfma_f32_32x32x16_bf16 v[64:79], a[236:239], v[200:203], v[64:79]
    s_add_u32 m0, s69, 114688
    s_add_u32 s0, s66, 1146880
    buffer_load_dwordx4 v11, s[20:23], s0 offen offset:1024 lds
    v_mfma_f32_32x32x16_bf16 v[128:143], a[236:239], v[204:207], v[128:143]
    ds_read_b64_tr_b16 a[228:229], v14 offset:16384
    ds_read_b64_tr_b16 a[230:231], v14 offset:16896
    s_waitcnt vmcnt(12)
    ds_read_b64_tr_b16 a[24:25], v18 offset:6144
    ds_read_b64_tr_b16 a[26:27], v18 offset:6656
    ds_read_b64_tr_b16 a[28:29], v19 offset:6144
    ds_read_b64_tr_b16 a[30:31], v19 offset:6656
    s_waitcnt lgkmcnt(10)
    v_mfma_f32_32x32x16_bf16 v[80:95], a[240:243], v[200:203], v[80:95]
    buffer_load_dwordx4 v[188:191], v17, s[32:35], s58 offen offset:1024 sc1
    v_mfma_f32_32x32x16_bf16 v[144:159], a[240:243], v[204:207], v[144:159]
    ds_read_b64_tr_b16 a[232:233], v15 offset:16384
    ds_read_b64_tr_b16 a[234:235], v15 offset:16896
    s_waitcnt lgkmcnt(10)
    v_mfma_f32_32x32x16_bf16 v[96:111], a[244:247], v[200:203], v[96:111]
    s_add_u32 m0, s70, 133120
    s_add_u32 s0, s67, 81920
    buffer_load_dwordx4 v6, s[24:27], s0 offen lds
    v_mfma_f32_32x32x16_bf16 v[160:175], a[244:247], v[204:207], v[160:175]
    ds_read_b64_tr_b16 a[236:237], v16 offset:16384
    ds_read_b64_tr_b16 a[238:239], v16 offset:16896
    s_waitcnt lgkmcnt(10)
    v_mfma_f32_32x32x16_bf16 v[48:63], a[224:227], v[208:211], v[48:63]
    buffer_load_dwordx4 v[192:195], v1, s[32:35], s58 offen offset:2048 sc1
    v_mfma_f32_32x32x16_bf16 v[112:127], a[224:227], v[212:215], v[112:127]
    ds_read_b64_tr_b16 a[240:241], v13 offset:20480
    ds_read_b64_tr_b16 a[242:243], v13 offset:20992
    s_waitcnt lgkmcnt(10)
    v_mfma_f32_32x32x16_bf16 v[64:79], a[228:231], v[208:211], v[64:79]
    s_add_u32 m0, s70, 133120
    s_add_u32 s0, s67, 81920
    buffer_load_dwordx4 v10, s[24:27], s0 offen offset:1024 lds
    v_mfma_f32_32x32x16_bf16 v[128:143], a[228:231], v[212:215], v[128:143]
    ds_read_b64_tr_b16 a[244:245], v14 offset:20480
    ds_read_b64_tr_b16 a[246:247], v14 offset:20992
    s_waitcnt lgkmcnt(6)
    v_mfma_f32_32x32x16_bf16 v[80:95], a[232:235], v[208:211], v[80:95]
    buffer_load_dwordx4 v[196:199], v17, s[32:35], s58 offen offset:2048 sc1
    v_mfma_f32_32x32x16_bf16 v[144:159], a[232:235], v[212:215], v[144:159]
    ds_read_b64_tr_b16 a[224:225], v15 offset:20480
    ds_read_b64_tr_b16 a[226:227], v15 offset:20992
    s_waitcnt lgkmcnt(6)
    v_mfma_f32_32x32x16_bf16 v[96:111], a[236:239], v[208:211], v[96:111]
    s_add_u32 m0, s69, 122880
    s_add_u32 s0, s66, 1261568
    buffer_load_dwordx4 v7, s[16:19], s0 offen lds
    v_mfma_f32_32x32x16_bf16 v[160:175], a[236:239], v[212:215], v[160:175]
    ds_read_b64_tr_b16 a[228:229], v16 offset:20480
    ds_read_b64_tr_b16 a[230:231], v16 offset:20992
    s_waitcnt lgkmcnt(6)
    v_mfma_f32_32x32x16_bf16 v[48:63], a[240:243], v[216:219], v[48:63]
    buffer_load_dwordx4 v[200:203], v1, s[32:35], s58 offen offset:3072 sc1
    v_mfma_f32_32x32x16_bf16 v[112:127], a[240:243], v[220:223], v[112:127]
    ds_read_b64_tr_b16 a[232:233], v13 offset:24576
    ds_read_b64_tr_b16 a[234:235], v13 offset:25088
    s_waitcnt lgkmcnt(6)
    v_mfma_f32_32x32x16_bf16 v[64:79], a[244:247], v[216:219], v[64:79]
    s_add_u32 m0, s69, 122880
    s_add_u32 s0, s66, 1261568
    buffer_load_dwordx4 v11, s[20:23], s0 offen offset:1024 lds
    v_mfma_f32_32x32x16_bf16 v[128:143], a[244:247], v[220:223], v[128:143]
    ds_read_b64_tr_b16 a[236:237], v14 offset:24576
    ds_read_b64_tr_b16 a[238:239], v14 offset:25088
    s_waitcnt vmcnt(12)
    ds_read_b64_tr_b16 a[32:33], v20 offset:0
    ds_read_b64_tr_b16 a[34:35], v20 offset:512
    ds_read_b64_tr_b16 a[36:37], v21 offset:0
    ds_read_b64_tr_b16 a[38:39], v21 offset:512
    s_waitcnt lgkmcnt(10)
    v_mfma_f32_32x32x16_bf16 v[80:95], a[224:227], v[216:219], v[80:95]
    buffer_load_dwordx4 v[204:207], v17, s[32:35], s58 offen offset:3072 sc1
    v_mfma_f32_32x32x16_bf16 v[144:159], a[224:227], v[220:223], v[144:159]
    ds_read_b64_tr_b16 a[240:241], v15 offset:24576
    ds_read_b64_tr_b16 a[242:243], v15 offset:25088
    s_waitcnt lgkmcnt(10)
    v_mfma_f32_32x32x16_bf16 v[96:111], a[228:231], v[216:219], v[96:111]
    s_add_u32 m0, s70, 135168
    s_add_u32 s0, s67, 98304
    buffer_load_dwordx4 v6, s[24:27], s0 offen lds
    v_mfma_f32_32x32x16_bf16 v[160:175], a[228:231], v[220:223], v[160:175]
    ds_read_b64_tr_b16 a[244:245], v16 offset:24576
    ds_read_b64_tr_b16 a[246:247], v16 offset:25088
    s_waitcnt lgkmcnt(10)
    v_mfma_f32_32x32x16_bf16 v[48:63], a[232:235], v[224:227], v[48:63]
    s_add_u32 s58, s87, 20480
    buffer_load_dwordx4 v[208:211], v1, s[32:35], s58 offen offset:0 sc1
    v_mfma_f32_32x32x16_bf16 v[112:127], a[232:235], v[228:231], v[112:127]
    ds_read_b64_tr_b16 a[224:225], v13 offset:28672
    ds_read_b64_tr_b16 a[226:227], v13 offset:29184
    s_waitcnt lgkmcnt(10)
    v_mfma_f32_32x32x16_bf16 v[64:79], a[236:239], v[224:227], v[64:79]
    s_add_u32 m0, s70, 135168
    s_add_u32 s0, s67, 98304
    buffer_load_dwordx4 v10, s[24:27], s0 offen offset:1024 lds
    v_mfma_f32_32x32x16_bf16 v[128:143], a[236:239], v[228:231], v[128:143]
    ds_read_b64_tr_b16 a[228:229], v14 offset:28672
    ds_read_b64_tr_b16 a[230:231], v14 offset:29184
    s_waitcnt lgkmcnt(6)
    v_mfma_f32_32x32x16_bf16 v[80:95], a[240:243], v[224:227], v[80:95]
    buffer_load_dwordx4 v[212:215], v17, s[32:35], s58 offen offset:0 sc1
    v_mfma_f32_32x32x16_bf16 v[144:159], a[240:243], v[228:231], v[144:159]
    ds_read_b64_tr_b16 a[232:233], v15 offset:28672
    ds_read_b64_tr_b16 a[234:235], v15 offset:29184
    s_waitcnt lgkmcnt(6)
    v_mfma_f32_32x32x16_bf16 v[96:111], a[244:247], v[224:227], v[96:111]
    s_add_u32 m0, s69, 65536
    s_add_u32 s0, s66, 1376256
    buffer_load_dwordx4 v7, s[16:19], s0 offen lds
    v_mfma_f32_32x32x16_bf16 v[160:175], a[244:247], v[228:231], v[160:175]
    ds_read_b64_tr_b16 a[236:237], v16 offset:28672
    ds_read_b64_tr_b16 a[238:239], v16 offset:29184
    s_waitcnt lgkmcnt(6)
    v_mfma_f32_32x32x16_bf16 v[48:63], a[224:227], v[232:235], v[48:63]
    buffer_load_dwordx4 v[216:219], v1, s[32:35], s58 offen offset:1024 sc1
    v_mfma_f32_32x32x16_bf16 v[112:127], a[224:227], v[236:239], v[112:127]
    s_waitcnt vmcnt(15)
    s_barrier
    v_add_u32 v13, 32768, v13
    v_add_u32 v14, 32768, v14
    v_add_u32 v15, 32768, v15
    v_add_u32 v16, 32768, v16
    ds_read_b64_tr_b16 a[240:241], v13 offset:32768
    ds_read_b64_tr_b16 a[242:243], v13 offset:33280
    s_waitcnt lgkmcnt(6)
    v_mfma_f32_32x32x16_bf16 v[64:79], a[228:231], v[232:235], v[64:79]
    s_add_u32 m0, s69, 65536
    s_add_u32 s0, s66, 1376256
    buffer_load_dwordx4 v11, s[20:23], s0 offen offset:1024 lds
    v_mfma_f32_32x32x16_bf16 v[128:143], a[228:231], v[236:239], v[128:143]
    ds_read_b64_tr_b16 a[244:245], v14 offset:32768
    ds_read_b64_tr_b16 a[246:247], v14 offset:33280
    s_waitcnt vmcnt(12)
    ds_read_b64_tr_b16 a[40:41], v20 offset:2048
    ds_read_b64_tr_b16 a[42:43], v20 offset:2560
    ds_read_b64_tr_b16 a[44:45], v21 offset:2048
    ds_read_b64_tr_b16 a[46:47], v21 offset:2560
    s_waitcnt lgkmcnt(10)
    v_mfma_f32_32x32x16_bf16 v[80:95], a[232:235], v[232:235], v[80:95]
    buffer_load_dwordx4 v[220:223], v17, s[32:35], s58 offen offset:1024 sc1
    v_mfma_f32_32x32x16_bf16 v[144:159], a[232:235], v[236:239], v[144:159]
    ds_read_b64_tr_b16 a[224:225], v15 offset:32768
    ds_read_b64_tr_b16 a[226:227], v15 offset:33280
    s_waitcnt lgkmcnt(10)
    v_mfma_f32_32x32x16_bf16 v[96:111], a[236:239], v[232:235], v[96:111]
    s_add_u32 m0, s70, 0
    s_add_u32 s0, s67, 114688
    buffer_load_dwordx4 v6, s[24:27], s0 offen lds
    v_mfma_f32_32x32x16_bf16 v[160:175], a[236:239], v[236:239], v[160:175]
    ds_read_b64_tr_b16 a[228:229], v16 offset:32768
    ds_read_b64_tr_b16 a[230:231], v16 offset:33280
    s_waitcnt lgkmcnt(10)
    v_mfma_f32_32x32x16_bf16 v[48:63], a[240:243], v[176:179], v[48:63]
    buffer_load_dwordx4 v[224:227], v1, s[32:35], s58 offen offset:2048 sc1
    v_mfma_f32_32x32x16_bf16 v[112:127], a[240:243], v[180:183], v[112:127]
    ds_read_b64_tr_b16 a[232:233], v13 offset:36864
    ds_read_b64_tr_b16 a[234:235], v13 offset:37376
    s_waitcnt lgkmcnt(10)
    v_mfma_f32_32x32x16_bf16 v[64:79], a[244:247], v[176:179], v[64:79]
    s_add_u32 m0, s70, 0
    s_add_u32 s0, s67, 114688
    buffer_load_dwordx4 v10, s[24:27], s0 offen offset:1024 lds
    v_mfma_f32_32x32x16_bf16 v[128:143], a[244:247], v[180:183], v[128:143]
    ds_read_b64_tr_b16 a[236:237], v14 offset:36864
    ds_read_b64_tr_b16 a[238:239], v14 offset:37376
    s_waitcnt lgkmcnt(6)
    v_mfma_f32_32x32x16_bf16 v[80:95], a[224:227], v[176:179], v[80:95]
    buffer_load_dwordx4 v[228:231], v17, s[32:35], s58 offen offset:2048 sc1
    v_mfma_f32_32x32x16_bf16 v[144:159], a[224:227], v[180:183], v[144:159]
    ds_read_b64_tr_b16 a[240:241], v15 offset:36864
    ds_read_b64_tr_b16 a[242:243], v15 offset:37376
    s_waitcnt lgkmcnt(6)
    v_mfma_f32_32x32x16_bf16 v[96:111], a[228:231], v[176:179], v[96:111]
    s_add_u32 m0, s69, 73728
    s_add_u32 s0, s66, 1490944
    buffer_load_dwordx4 v7, s[16:19], s0 offen lds
    buffer_load_dword v29, v246, s[32:35], s2 offen offset:16 sc1
    v_mfma_f32_32x32x16_bf16 v[160:175], a[228:231], v[180:183], v[160:175]
    ds_read_b64_tr_b16 a[244:245], v16 offset:36864
    ds_read_b64_tr_b16 a[246:247], v16 offset:37376
    s_waitcnt lgkmcnt(6)
    v_mfma_f32_32x32x16_bf16 v[48:63], a[232:235], v[184:187], v[48:63]
    buffer_load_dwordx4 v[232:235], v1, s[32:35], s58 offen offset:3072 sc1
    v_mfma_f32_32x32x16_bf16 v[112:127], a[232:235], v[188:191], v[112:127]
    ds_read_b64_tr_b16 a[224:225], v13 offset:40960
    ds_read_b64_tr_b16 a[226:227], v13 offset:41472
    s_waitcnt lgkmcnt(6)
    v_mfma_f32_32x32x16_bf16 v[64:79], a[236:239], v[184:187], v[64:79]
    s_add_u32 m0, s69, 73728
    s_add_u32 s0, s66, 1490944
    buffer_load_dwordx4 v11, s[20:23], s0 offen offset:1024 lds
    v_mfma_f32_32x32x16_bf16 v[128:143], a[236:239], v[188:191], v[128:143]
    ds_read_b64_tr_b16 a[228:229], v14 offset:40960
    ds_read_b64_tr_b16 a[230:231], v14 offset:41472
    s_waitcnt vmcnt(13)
    ds_read_b64_tr_b16 a[48:49], v20 offset:4096
    ds_read_b64_tr_b16 a[50:51], v20 offset:4608
    ds_read_b64_tr_b16 a[52:53], v21 offset:4096
    ds_read_b64_tr_b16 a[54:55], v21 offset:4608
    s_waitcnt lgkmcnt(10)
    v_mfma_f32_32x32x16_bf16 v[80:95], a[240:243], v[184:187], v[80:95]
    buffer_load_dwordx4 v[236:239], v17, s[32:35], s58 offen offset:3072 sc1
    v_mfma_f32_32x32x16_bf16 v[144:159], a[240:243], v[188:191], v[144:159]
    ds_read_b64_tr_b16 a[232:233], v15 offset:40960
    ds_read_b64_tr_b16 a[234:235], v15 offset:41472
    s_waitcnt lgkmcnt(10)
    v_mfma_f32_32x32x16_bf16 v[96:111], a[244:247], v[184:187], v[96:111]
    v_mfma_f32_32x32x16_bf16 v[160:175], a[244:247], v[188:191], v[160:175]
    ds_read_b64_tr_b16 a[236:237], v16 offset:40960
    ds_read_b64_tr_b16 a[238:239], v16 offset:41472
    s_waitcnt lgkmcnt(10)
    v_mfma_f32_32x32x16_bf16 v[48:63], a[224:227], v[192:195], v[48:63]
    s_add_u32 s58, s87, 24576
    buffer_load_dwordx4 v[176:179], v1, s[32:35], s58 offen offset:0 sc1
    v_mfma_f32_32x32x16_bf16 v[112:127], a[224:227], v[196:199], v[112:127]
    ds_read_b64_tr_b16 a[240:241], v13 offset:45056
    ds_read_b64_tr_b16 a[242:243], v13 offset:45568
    s_waitcnt lgkmcnt(10)
    v_mfma_f32_32x32x16_bf16 v[64:79], a[228:231], v[192:195], v[64:79]
    s_add_u32 m0, s69, 81920
    s_add_u32 s0, s66, 1605632
    buffer_load_dwordx4 v7, s[16:19], s0 offen lds
    v_mfma_f32_32x32x16_bf16 v[128:143], a[228:231], v[196:199], v[128:143]
    ds_read_b64_tr_b16 a[244:245], v14 offset:45056
    ds_read_b64_tr_b16 a[246:247], v14 offset:45568
    s_waitcnt lgkmcnt(6)
    v_mfma_f32_32x32x16_bf16 v[80:95], a[232:235], v[192:195], v[80:95]
    buffer_load_dwordx4 v[180:183], v17, s[32:35], s58 offen offset:0 sc1
    v_mfma_f32_32x32x16_bf16 v[144:159], a[232:235], v[196:199], v[144:159]
    ds_read_b64_tr_b16 a[224:225], v15 offset:45056
    ds_read_b64_tr_b16 a[226:227], v15 offset:45568
    s_waitcnt lgkmcnt(6)
    v_mfma_f32_32x32x16_bf16 v[96:111], a[236:239], v[192:195], v[96:111]
    v_mfma_f32_32x32x16_bf16 v[160:175], a[236:239], v[196:199], v[160:175]
    ds_read_b64_tr_b16 a[228:229], v16 offset:45056
    ds_read_b64_tr_b16 a[230:231], v16 offset:45568
    s_waitcnt lgkmcnt(6)
    v_mfma_f32_32x32x16_bf16 v[48:63], a[240:243], v[200:203], v[48:63]
    buffer_load_dwordx4 v[184:187], v1, s[32:35], s58 offen offset:1024 sc1
    v_mfma_f32_32x32x16_bf16 v[112:127], a[240:243], v[204:207], v[112:127]
    ds_read_b64_tr_b16 a[232:233], v13 offset:49152
    ds_read_b64_tr_b16 a[234:235], v13 offset:49664
    s_waitcnt lgkmcnt(6)
    v_mfma_f32_32x32x16_bf16 v[64:79], a[244:247], v[200:203], v[64:79]
    s_add_u32 m0, s69, 81920
    s_add_u32 s0, s66, 1605632
    buffer_load_dwordx4 v11, s[20:23], s0 offen offset:1024 lds
    v_mfma_f32_32x32x16_bf16 v[128:143], a[244:247], v[204:207], v[128:143]
    ds_read_b64_tr_b16 a[236:237], v14 offset:49152
    ds_read_b64_tr_b16 a[238:239], v14 offset:49664
    s_waitcnt vmcnt(11)
    ds_read_b64_tr_b16 a[56:57], v18 offset:0
    ds_read_b64_tr_b16 a[58:59], v18 offset:512
    ds_read_b64_tr_b16 a[60:61], v19 offset:0
    ds_read_b64_tr_b16 a[62:63], v19 offset:512
    s_waitcnt lgkmcnt(10)
    v_mfma_f32_32x32x16_bf16 v[80:95], a[224:227], v[200:203], v[80:95]
    buffer_load_dwordx4 v[188:191], v17, s[32:35], s58 offen offset:1024 sc1
    v_mfma_f32_32x32x16_bf16 v[144:159], a[224:227], v[204:207], v[144:159]
    ds_read_b64_tr_b16 a[240:241], v15 offset:49152
    ds_read_b64_tr_b16 a[242:243], v15 offset:49664
    s_waitcnt lgkmcnt(10)
    v_mfma_f32_32x32x16_bf16 v[96:111], a[228:231], v[200:203], v[96:111]
    s_add_u32 m0, s70, 2048
    s_add_u32 s0, s67, 131072
    buffer_load_dwordx4 v6, s[24:27], s0 offen lds
    v_mfma_f32_32x32x16_bf16 v[160:175], a[228:231], v[204:207], v[160:175]
    ds_read_b64_tr_b16 a[244:245], v16 offset:49152
    ds_read_b64_tr_b16 a[246:247], v16 offset:49664
    s_waitcnt lgkmcnt(10)
    v_mfma_f32_32x32x16_bf16 v[48:63], a[232:235], v[208:211], v[48:63]
    buffer_load_dwordx4 v[192:195], v1, s[32:35], s58 offen offset:2048 sc1
    v_mfma_f32_32x32x16_bf16 v[112:127], a[232:235], v[212:215], v[112:127]
    ds_read_b64_tr_b16 a[224:225], v13 offset:53248
    ds_read_b64_tr_b16 a[226:227], v13 offset:53760
    s_waitcnt lgkmcnt(10)
    v_mfma_f32_32x32x16_bf16 v[64:79], a[236:239], v[208:211], v[64:79]
    s_add_u32 m0, s70, 2048
    s_add_u32 s0, s67, 131072
    buffer_load_dwordx4 v10, s[24:27], s0 offen offset:1024 lds
    v_mfma_f32_32x32x16_bf16 v[128:143], a[236:239], v[212:215], v[128:143]
    ds_read_b64_tr_b16 a[228:229], v14 offset:53248
    ds_read_b64_tr_b16 a[230:231], v14 offset:53760
    s_waitcnt lgkmcnt(6)
    v_mfma_f32_32x32x16_bf16 v[80:95], a[240:243], v[208:211], v[80:95]
    buffer_load_dwordx4 v[196:199], v17, s[32:35], s58 offen offset:2048 sc1
    v_mfma_f32_32x32x16_bf16 v[144:159], a[240:243], v[212:215], v[144:159]
    ds_read_b64_tr_b16 a[232:233], v15 offset:53248
    ds_read_b64_tr_b16 a[234:235], v15 offset:53760
    s_waitcnt lgkmcnt(6)
    v_mfma_f32_32x32x16_bf16 v[96:111], a[244:247], v[208:211], v[96:111]
    s_add_u32 m0, s69, 90112
    s_add_u32 s0, s66, 1720320
    buffer_load_dwordx4 v7, s[16:19], s0 offen lds
    v_mfma_f32_32x32x16_bf16 v[160:175], a[244:247], v[212:215], v[160:175]
    ds_read_b64_tr_b16 a[236:237], v16 offset:53248
    ds_read_b64_tr_b16 a[238:239], v16 offset:53760
    s_waitcnt lgkmcnt(6)
    v_mfma_f32_32x32x16_bf16 v[48:63], a[224:227], v[216:219], v[48:63]
    buffer_load_dwordx4 v[200:203], v1, s[32:35], s58 offen offset:3072 sc1
    v_mfma_f32_32x32x16_bf16 v[112:127], a[224:227], v[220:223], v[112:127]
    s_waitcnt vmcnt(13)
    s_barrier
    ds_read_b64_tr_b16 a[240:241], v13 offset:57344
    ds_read_b64_tr_b16 a[242:243], v13 offset:57856
    s_waitcnt lgkmcnt(6)
    v_mfma_f32_32x32x16_bf16 v[64:79], a[228:231], v[216:219], v[64:79]
    s_add_u32 m0, s69, 90112
    s_add_u32 s0, s66, 1720320
    buffer_load_dwordx4 v11, s[20:23], s0 offen offset:1024 lds
    v_mfma_f32_32x32x16_bf16 v[128:143], a[228:231], v[220:223], v[128:143]
    ds_read_b64_tr_b16 a[244:245], v14 offset:57344
    ds_read_b64_tr_b16 a[246:247], v14 offset:57856
    s_waitcnt lgkmcnt(6)
    v_mfma_f32_32x32x16_bf16 v[80:95], a[232:235], v[216:219], v[80:95]
    buffer_load_dwordx4 v[204:207], v17, s[32:35], s58 offen offset:3072 sc1
    v_mfma_f32_32x32x16_bf16 v[144:159], a[232:235], v[220:223], v[144:159]
    ds_read_b64_tr_b16 a[224:225], v15 offset:57344
    ds_read_b64_tr_b16 a[226:227], v15 offset:57856
    s_waitcnt lgkmcnt(6)
    v_mfma_f32_32x32x16_bf16 v[96:111], a[236:239], v[216:219], v[96:111]
    s_add_u32 m0, s70, 4096
    s_add_u32 s0, s67, 147456
    buffer_load_dwordx4 v6, s[24:27], s0 offen lds
    v_cmp_eq_u32 vcc, 0, v29
    s_nop 0
    s_cbranch_vccnz L_redo60
L_done59:
    buffer_load_dwordx4 v[240:243], v1, s[32:35], s1 offen offset:0 sc1
    buffer_load_dwordx4 v[248:251], v1, s[32:35], s1 offen offset:1024 sc1
    v_mfma_f32_32x32x16_bf16 v[160:175], a[236:239], v[220:223], v[160:175]
    ds_read_b64_tr_b16 a[228:229], v16 offset:57344
    ds_read_b64_tr_b16 a[230:231], v16 offset:57856
    s_waitcnt lgkmcnt(6)
    v_mfma_f32_32x32x16_bf16 v[48:63], a[240:243], v[224:227], v[48:63]
    s_add_u32 s58, s87, 28672
    buffer_load_dwordx4 v[208:211], v1, s[32:35], s58 offen offset:0 sc1
    v_mfma_f32_32x32x16_bf16 v[112:127], a[240:243], v[228:231], v[112:127]
    ds_read_b64_tr_b16 a[232:233], v13 offset:61440
    ds_read_b64_tr_b16 a[234:235], v13 offset:61952
    s_waitcnt lgkmcnt(6)
    v_mfma_f32_32x32x16_bf16 v[64:79], a[244:247], v[224:227], v[64:79]
    s_add_u32 m0, s70, 4096
    s_add_u32 s0, s67, 147456
    buffer_load_dwordx4 v10, s[24:27], s0 offen offset:1024 lds
    v_mfma_f32_32x32x16_bf16 v[128:143], a[244:247], v[228:231], v[128:143]
    ds_read_b64_tr_b16 a[236:237], v14 offset:61440
    ds_read_b64_tr_b16 a[238:239], v14 offset:61952
    s_waitcnt lgkmcnt(6)
    v_mfma_f32_32x32x16_bf16 v[80:95], a[224:227], v[224:227], v[80:95]
    buffer_load_dwordx4 v[212:215], v17, s[32:35], s58 offen offset:0 sc1
    v_mfma_f32_32x32x16_bf16 v[144:159], a[224:227], v[228:231], v[144:159]
    ds_read_b64_tr_b16 a[240:241], v15 offset:61440
    ds_read_b64_tr_b16 a[242:243], v15 offset:61952
    s_waitcnt lgkmcnt(6)
    v_mfma_f32_32x32x16_bf16 v[96:111], a[228:231], v[224:227], v[96:111]
    s_add_u32 m0, s70, 6144
    s_add_u32 s0, s67, 163840
    buffer_load_dwordx4 v6, s[24:27], s0 offen lds
    v_mfma_f32_32x32x16_bf16 v[160:175], a[228:231], v[228:231], v[160:175]
    ds_read_b64_tr_b16 a[244:245], v16 offset:61440
    ds_read_b64_tr_b16 a[246:247], v16 offset:61952
    s_waitcnt lgkmcnt(6)
    v_mfma_f32_32x32x16_bf16 v[48:63], a[232:235], v[232:235], v[48:63]
    buffer_load_dwordx4 v[216:219], v1, s[32:35], s58 offen offset:1024 sc1
    s_waitcnt vmcnt(22)
    v_mfma_f32_32x32x16_bf16 v[112:127], a[232:235], v[236:239], v[112:127]
    ds_read_b64_tr_b16 a[224:225], v13 offset:0
    ds_read_b64_tr_b16 a[226:227], v13 offset:512
    s_waitcnt lgkmcnt(6)
    v_mfma_f32_32x32x16_bf16 v[64:79], a[236:239], v[232:235], v[64:79]
    s_add_u32 m0, s70, 6144
    s_add_u32 s0, s67, 163840
    buffer_load_dwordx4 v10, s[24:27], s0 offen offset:1024 lds
    v_mfma_f32_32x32x16_bf16 v[128:143], a[236:239], v[236:239], v[128:143]
    ds_read_b64_tr_b16 a[228:229], v14 offset:0
    ds_read_b64_tr_b16 a[230:231], v14 offset:512
    s_waitcnt vmcnt(14)
    ds_read_b64_tr_b16 a[64:65], v18 offset:2048
    ds_read_b64_tr_b16 a[66:67], v18 offset:2560
    ds_read_b64_tr_b16 a[68:69], v19 offset:2048
    ds_read_b64_tr_b16 a[70:71], v19 offset:2560
    s_waitcnt lgkmcnt(10)
    v_mfma_f32_32x32x16_bf16 v[80:95], a[240:243], v[232:235], v[80:95]
    buffer_load_dwordx4 v[220:223], v17, s[32:35], s58 offen offset:1024 sc1
    v_mfma_f32_32x32x16_bf16 v[144:159], a[240:243], v[236:239], v[144:159]
    ds_read_b64_tr_b16 a[232:233], v15 offset:0
    ds_read_b64_tr_b16 a[234:235], v15 offset:512
    s_waitcnt lgkmcnt(10)
    v_mfma_f32_32x32x16_bf16 v[96:111], a[244:247], v[232:235], v[96:111]
    s_add_u32 m0, s70, 131072
    s_add_u32 s0, s67, 180224
    buffer_load_dwordx4 v6, s[24:27], s0 offen lds
    v_mfma_f32_32x32x16_bf16 v[160:175], a[244:247], v[236:239], v[160:175]
    ds_read_b64_tr_b16 a[236:237], v16 offset:0
    ds_read_b64_tr_b16 a[238:239], v16 offset:512
    s_waitcnt lgkmcnt(10)
    v_mfma_f32_32x32x16_bf16 v[48:63], a[224:227], v[176:179], v[48:63]
    buffer_load_dwordx4 v[224:227], v1, s[32:35], s58 offen offset:2048 sc1
    v_mfma_f32_32x32x16_bf16 v[112:127], a[224:227], v[180:183], v[112:127]
    ds_read_b64_tr_b16 a[240:241], v13 offset:4096
    ds_read_b64_tr_b16 a[242:243], v13 offset:4608
    s_waitcnt lgkmcnt(10)
    v_mfma_f32_32x32x16_bf16 v[64:79], a[228:231], v[176:179], v[64:79]
    s_add_u32 m0, s70, 131072
    s_add_u32 s0, s67, 180224
    buffer_load_dwordx4 v10, s[24:27], s0 offen offset:1024 lds
    v_mfma_f32_32x32x16_bf16 v[128:143], a[228:231], v[180:183], v[128:143]
    ds_read_b64_tr_b16 a[244:245], v14 offset:4096
    ds_read_b64_tr_b16 a[246:247], v14 offset:4608
    s_waitcnt lgkmcnt(6)
    v_mfma_f32_32x32x16_bf16 v[80:95], a[232:235], v[176:179], v[80:95]
    buffer_load_dwordx4 v[228:231], v17, s[32:35], s58 offen offset:2048 sc1
    v_mfma_f32_32x32x16_bf16 v[144:159], a[232:235], v[180:183], v[144:159]
    ds_read_b64_tr_b16 a[224:225], v15 offset:4096
    ds_read_b64_tr_b16 a[226:227], v15 offset:4608
    s_waitcnt lgkmcnt(6)
    v_mfma_f32_32x32x16_bf16 v[96:111], a[236:239], v[176:179], v[96:111]
    s_add_u32 m0, s70, 133120
    s_add_u32 s0, s67, 196608
    buffer_load_dwordx4 v6, s[24:27], s0 offen lds
    v_mfma_f32_32x32x16_bf16 v[160:175], a[236:239], v[180:183], v[160:175]
    ds_read_b64_tr_b16 a[228:229], v16 offset:4096
    ds_read_b64_tr_b16 a[230:231], v16 offset:4608
    s_waitcnt lgkmcnt(6)
    v_mfma_f32_32x32x16_bf16 v[48:63], a[240:243], v[184:187], v[48:63]
    buffer_load_dwordx4 v[232:235], v1, s[32:35], s58 offen offset:3072 sc1
    v_mfma_f32_32x32x16_bf16 v[112:127], a[240:243], v[188:191], v[112:127]
    s_waitcnt vmcnt(17)
    s_barrier
    ds_read_b64_tr_b16 a[128:129], v13 offset:8192
    ds_read_b64_tr_b16 a[130:131], v13 offset:8704
    s_waitcnt lgkmcnt(6)
    v_mfma_f32_32x32x16_bf16 v[64:79], a[244:247], v[184:187], v[64:79]
    s_add_u32 m0, s70, 133120
    s_add_u32 s0, s67, 196608
    buffer_load_dwordx4 v10, s[24:27], s0 offen offset:1024 lds
    v_mfma_f32_32x32x16_bf16 v[128:143], a[244:247], v[188:191], v[128:143]
    ds_read_b64_tr_b16 a[144:145], v13 offset:12288
    ds_read_b64_tr_b16 a[146:147], v13 offset:12800
    s_waitcnt vmcnt(12)
    ds_read_b64_tr_b16 a[72:73], v18 offset:4096
    ds_read_b64_tr_b16 a[74:75], v18 offset:4608
    ds_read_b64_tr_b16 a[76:77], v19 offset:4096
    ds_read_b64_tr_b16 a[78:79], v19 offset:4608
    ds_read_b64 a[96:97], v22 offset:0
    ds_read_b64 a[98:99], v22 offset:256
    s_waitcnt lgkmcnt(12)
    v_mfma_f32_32x32x16_bf16 v[80:95], a[224:227], v[184:187], v[80:95]
    buffer_load_dwordx4 v[236:239], v17, s[32:35], s58 offen offset:3072 sc1
    v_mfma_f32_32x32x16_bf16 v[144:159], a[224:227], v[188:191], v[144:159]
    ds_read_b64_tr_b16 a[160:161], v13 offset:16384
    ds_read_b64_tr_b16 a[162:163], v13 offset:16896
    ds_read_b64 a[100:101], v22 offset:512
    ds_read_b64 a[102:103], v22 offset:768
    s_waitcnt lgkmcnt(14)
    v_mfma_f32_32x32x16_bf16 v[96:111], a[228:231], v[184:187], v[96:111]
    v_mfma_f32_32x32x16_bf16 v[160:175], a[228:231], v[188:191], v[160:175]
    ds_read_b64_tr_b16 a[176:177], v13 offset:20480
    ds_read_b64_tr_b16 a[178:179], v13 offset:20992
    ds_read_b64 a[104:105], v22 offset:0
L_tail_1:
    s_add_u32 m0, s70, 135168
    s_add_u32 s0, s67, 212992
    buffer_load_dwordx4 v6, s[24:27], s0 offen lds
    s_waitcnt lgkmcnt(14)
    v_mfma_f32_32x32x16_bf16 v[48:63], a[128:131], v[192:195], v[48:63]
    ds_read_b64_tr_b16 a[192:193], v13 offset:24576
    ds_read_b64_tr_b16 a[194:195], v13 offset:25088
    ds_read_b64_tr_b16 a[208:209], v13 offset:28672
    ds_read_b64_tr_b16 a[210:211], v13 offset:29184
    s_waitcnt lgkmcnt(14)
    v_mfma_f32_32x32x16_bf16 v[48:63], a[144:147], v[200:203], v[48:63]
    buffer_load_dwordx4 v10, s[24:27], s0 offen offset:1024 lds
    ds_read_b64_tr_b16 a[132:133], v14 offset:8192
    ds_read_b64_tr_b16 a[134:135], v14 offset:8704
    ds_read_b64_tr_b16 a[148:149], v14 offset:12288
    ds_read_b64_tr_b16 a[150:151], v14 offset:12800
    s_waitcnt lgkmcnt(13)
    v_mfma_f32_32x32x16_bf16 v[48:63], a[160:163], v[208:211], v[48:63]
    s_add_u32 m0, s70, 32768
    s_add_u32 s0, s67, 229376
    buffer_load_dwordx4 v6, s[24:27], s0 offen lds
    ds_read_b64_tr_b16 a[164:165], v14 offset:16384
    ds_read_b64_tr_b16 a[166:167], v14 offset:16896
    ds_read_b64_tr_b16 a[180:181], v14 offset:20480
    ds_read_b64_tr_b16 a[182:183], v14 offset:20992
    s_waitcnt vmcnt(13) lgkmcnt(13)
    v_mfma_f32_32x32x16_bf16 v[48:63], a[176:179], v[216:219], v[48:63]
    buffer_load_dwordx4 v10, s[24:27], s0 offen offset:1024 lds
    ds_read_b64_tr_b16 a[196:197], v14 offset:24576
    ds_read_b64_tr_b16 a[198:199], v14 offset:25088
    ds_read_b64_tr_b16 a[212:213], v14 offset:28672
    ds_read_b64_tr_b16 a[214:215], v14 offset:29184
    v_mov_b32 v244, v243
    v_mov_b32 v245, v243
    v_mov_b32 v252, v251
    v_mov_b32 v253, v251
    s_waitcnt vmcnt(10) lgkmcnt(14)
    v_mfma_f32_32x32x16_bf16 v[48:63], a[192:195], v[224:227], v[48:63]
    s_add_u32 m0, s70, 34816
    s_add_u32 s0, s67, 245760
    buffer_load_dwordx4 v6, s[24:27], s0 offen lds
    ds_read_b64_tr_b16 a[136:137], v15 offset:8192
    ds_read_b64_tr_b16 a[138:139], v15 offset:8704
    ds_read_b64_tr_b16 a[152:153], v15 offset:12288
    ds_read_b64_tr_b16 a[154:155], v15 offset:12800
    s_waitcnt vmcnt(7) lgkmcnt(14)
    v_mfma_f32_32x32x16_bf16 v[48:63], a[208:211], v[232:235], v[48:63]
    buffer_load_dwordx4 v10, s[24:27], s0 offen offset:1024 lds
    ds_read_b64_tr_b16 a[168:169], v15 offset:16384
    ds_read_b64_tr_b16 a[170:171], v15 offset:16896
    ds_read_b64_tr_b16 a[184:185], v15 offset:20480
    ds_read_b64_tr_b16 a[186:187], v15 offset:20992
    v_mfma_f32_32x32x16_bf16 v[48:63], a[96:99], v[244:247], v[48:63]
    s_nop 11
    s_nop 0
    v_pk_mul_f32 v[176:177], v[48:49], v[48:49]
    v_pk_mul_f32 v[178:179], v[50:51], v[50:51]
    v_pk_mul_f32 v[180:181], v[52:53], v[52:53]
    v_pk_mul_f32 v[182:183], v[54:55], v[54:55]
    v_pk_fma_f32 v[176:177], v[176:177], v[240:241], v[240:241] op_sel:[0,1,0] op_sel_hi:[1,1,0]
    v_pk_fma_f32 v[178:179], v[178:179], v[240:241], v[240:241] op_sel:[0,1,0] op_sel_hi:[1,1,0]
    v_pk_fma_f32 v[180:181], v[180:181], v[240:241], v[240:241] op_sel:[0,1,0] op_sel_hi:[1,1,0]
    s_add_u32 m0, s70, 36864
    s_add_u32 s0, s67, 262144
    buffer_load_dwordx4 v6, s[24:27], s0 offen lds
    v_pk_fma_f32 v[182:183], v[182:183], v[240:241], v[240:241] op_sel:[0,1,0] op_sel_hi:[1,1,0]
    v_pk_mul_f32 v[176:177], v[176:177], v[48:49]
    v_pk_mul_f32 v[178:179], v[178:179], v[50:51]
    v_pk_mul_f32 v[180:181], v[180:181], v[52:53]
    v_pk_mul_f32 v[182:183], v[182:183], v[54:55]
    v_pk_mul_f32 v[48:49], v[48:49], v[56:57]
    v_pk_mul_f32 v[50:51], v[50:51], v[58:59]
    v_pk_mul_f32 v[52:53], v[52:53], v[60:61]
    v_pk_mul_f32 v[54:55], v[54:55], v[62:63]
    v_mfma_f32_32x32x16_bf16 v[64:79], a[132:135], v[192:195], v[64:79]
    ds_read_b64_tr_b16 a[200:201], v15 offset:24576
    ds_read_b64_tr_b16 a[202:203], v15 offset:25088
    ds_read_b64_tr_b16 a[216:217], v15 offset:28672
    ds_read_b64_tr_b16 a[218:219], v15 offset:29184
    buffer_load_dwordx4 v10, s[24:27], s0 offen offset:1024 lds
    v_exp_f32 v176, v176
    v_exp_f32 v177, v177
    v_exp_f32 v178, v178
    v_exp_f32_e64 v179, v179
    s_waitcnt lgkmcnt(14)
    v_mfma_f32_32x32x16_bf16 v[64:79], a[148:151], v[200:203], v[64:79]
    ds_read_b64_tr_b16 a[140:141], v16 offset:8192
    ds_read_b64_tr_b16 a[142:143], v16 offset:8704
    ds_read_b64_tr_b16 a[156:157], v16 offset:12288
    ds_read_b64_tr_b16 a[158:159], v16 offset:12800
    v_exp_f32 v180, v180
    s_add_u32 m0, s70, 38912
    s_add_u32 s0, s67, 278528
    buffer_load_dwordx4 v6, s[24:27], s0 offen lds
    v_exp_f32 v181, v181
    v_exp_f32 v182, v182
    v_exp_f32 v183, v183
    v_mfma_f32_32x32x16_bf16 v[64:79], a[164:167], v[208:211], v[64:79]
    ds_read_b64_tr_b16 a[172:173], v16 offset:16384
    ds_read_b64_tr_b16 a[174:175], v16 offset:16896
    ds_read_b64_tr_b16 a[188:189], v16 offset:20480
    ds_read_b64_tr_b16 a[190:191], v16 offset:20992
    v_fma_f32 v176, v176, v242, v242
    v_fma_f32 v177, v177, v242, v242
    buffer_load_dwordx4 v10, s[24:27], s0 offen offset:1024 lds
    v_fma_f32 v178, v178, v242, v242
    v_fma_f32 v179, v179, v242, v242
    v_fma_f32 v180, v180, v242, v242
    v_fma_f32 v181, v181, v242, v242
    v_mfma_f32_32x32x16_bf16 v[64:79], a[180:183], v[216:219], v[64:79]
    ds_read_b64_tr_b16 a[204:205], v16 offset:24576
    ds_read_b64_tr_b16 a[206:207], v16 offset:25088
    ds_read_b64_tr_b16 a[220:221], v16 offset:28672
    ds_read_b64_tr_b16 a[222:223], v16 offset:29184
    v_fma_f32 v182, v182, v242, v242
    v_fma_f32 v183, v183, v242, v242
    v_rcp_f32 v176, v176
    v_rcp_f32 v177, v177
    s_add_u32 m0, s70, 98304
    s_add_u32 s0, s67, 294912
    buffer_load_dwordx4 v6, s[24:27], s0 offen lds
    v_rcp_f32 v178, v178
    v_mfma_f32_32x32x16_bf16 v[64:79], a[196:199], v[224:227], v[64:79]
    v_rcp_f32 v179, v179
    v_rcp_f32 v180, v180
    v_rcp_f32 v181, v181
    s_waitcnt lgkmcnt(14)
    v_mfma_f32_32x32x16_bf16 v[64:79], a[212:215], v[232:235], v[64:79]
    buffer_load_dwordx4 v10, s[24:27], s0 offen offset:1024 lds
    v_rcp_f32 v182, v182
    v_rcp_f32 v183, v183
    v_mul_f32 v48, v48, v176
    v_mul_f32 v49, v49, v177
    v_mul_f32 v50, v50, v178
    v_mfma_f32_32x32x16_bf16 v[64:79], a[98:101], v[244:247], v[64:79]
    v_mul_f32 v51, v51, v179
    v_mul_f32 v52, v52, v180
    v_mul_f32 v53, v53, v181
    v_mul_f32 v54, v54, v182
    v_mul_f32_e64 v55, v55, v183
    v_cvt_pk_bf16_f32 v56, v48, v49
    v_cvt_pk_bf16_f32 v57, v50, v51
    v_cvt_pk_bf16_f32 v58, v52, v53
    v_cvt_pk_bf16_f32 v59, v54, v55
    s_cmp_lg_u32 s55, 0
    s_cbranch_scc1 L_slow_h62
    buffer_store_dwordx4 v[56:59], v1, s[32:35], s91 offen offset:0
L_ret_h62:
    s_waitcnt lgkmcnt(0)
    s_barrier
    v_pk_mul_f32 v[176:177], v[64:65], v[64:65]
    v_pk_mul_f32 v[178:179], v[66:67], v[66:67]
    v_pk_mul_f32 v[180:181], v[68:69], v[68:69]
    v_pk_mul_f32 v[182:183], v[70:71], v[70:71]
    v_pk_fma_f32 v[176:177], v[176:177], v[240:241], v[240:241] op_sel:[0,1,0] op_sel_hi:[1,1,0]
    v_pk_fma_f32 v[178:179], v[178:179], v[240:241], v[240:241] op_sel:[0,1,0] op_sel_hi:[1,1,0]
    v_pk_fma_f32 v[180:181], v[180:181], v[240:241], v[240:241] op_sel:[0,1,0] op_sel_hi:[1,1,0]
    s_add_u32 m0, s70, 100352
    s_add_u32 s0, s67, 311296
    buffer_load_dwordx4 v6, s[24:27], s0 offen lds
    v_pk_fma_f32 v[182:183], v[182:183], v[240:241], v[240:241] op_sel:[0,1,0] op_sel_hi:[1,1,0]
    v_pk_mul_f32 v[176:177], v[176:177], v[64:65]
    v_pk_mul_f32 v[178:179], v[178:179], v[66:67]
    v_pk_mul_f32 v[180:181], v[180:181], v[68:69]
    v_pk_mul_f32 v[182:183], v[182:183], v[70:71]
    v_pk_mul_f32 v[64:65], v[64:65], v[72:73]
    v_pk_mul_f32 v[66:67], v[66:67], v[74:75]
    v_pk_mul_f32 v[68:69], v[68:69], v[76:77]
    v_pk_mul_f32 v[70:71], v[70:71], v[78:79]
    v_mfma_f32_32x32x16_bf16 v[80:95], a[136:139], v[192:195], v[80:95]
    buffer_load_dwordx4 v10, s[24:27], s0 offen offset:1024 lds
    v_exp_f32 v176, v176
    v_exp_f32 v177, v177
    v_exp_f32 v178, v178
    s_add_u32 m0, s70, 102400
    s_add_u32 s0, s67, 327680
    buffer_load_dwordx4 v6, s[24:27], s0 offen lds
    v_exp_f32 v179, v179
    v_mfma_f32_32x32x16_bf16 v[80:95], a[152:155], v[200:203], v[80:95]
    buffer_load_dwordx4 v10, s[24:27], s0 offen offset:1024 lds
    v_exp_f32 v180, v180
    v_exp_f32 v181, v181
    v_exp_f32 v182, v182
    v_exp_f32 v183, v183
    v_mfma_f32_32x32x16_bf16 v[80:95], a[168:171], v[208:211], v[80:95]
    s_add_u32 m0, s70, 104448
    s_add_u32 s0, s67, 344064
    buffer_load_dwordx4 v6, s[24:27], s0 offen lds
    v_fma_f32 v176, v176, v242, v242
    v_fma_f32 v177, v177, v242, v242
    v_fma_f32 v178, v178, v242, v242
    v_fma_f32 v179, v179, v242, v242
    v_fma_f32 v180, v180, v242, v242
    v_fma_f32 v181, v181, v242, v242
    buffer_load_dwordx4 v10, s[24:27], s0 offen offset:1024 lds
    v_mfma_f32_32x32x16_bf16 v[80:95], a[184:187], v[216:219], v[80:95]
    v_fma_f32 v182, v182, v242, v242
    v_fma_f32 v183, v183, v242, v242
    v_rcp_f32 v176, v176
    s_add_u32 m0, s70, 65536
    s_add_u32 s0, s67, 360448
    buffer_load_dwordx4 v6, s[24:27], s0 offen lds
    v_rcp_f32 v177, v177
    v_rcp_f32 v178, v178
    v_mfma_f32_32x32x16_bf16 v[80:95], a[200:203], v[224:227], v[80:95]
    buffer_load_dwordx4 v10, s[24:27], s0 offen offset:1024 lds
    v_rcp_f32 v179, v179
    v_rcp_f32 v180, v180
    v_rcp_f32 v181, v181
    v_mfma_f32_32x32x16_bf16 v[80:95], a[216:219], v[232:235], v[80:95]
    s_add_u32 m0, s70, 67584
    s_add_u32 s0, s67, 376832
    buffer_load_dwordx4 v6, s[24:27], s0 offen lds
    v_rcp_f32 v182, v182
    v_rcp_f32 v183, v183
    v_mul_f32 v64, v64, v176
    v_mul_f32 v65, v65, v177
    v_mul_f32 v66, v66, v178
    buffer_load_dwordx4 v10, s[24:27], s0 offen offset:1024 lds
    v_mfma_f32_32x32x16_bf16 v[80:95], a[100:103], v[244:247], v[80:95]
    v_mul_f32 v67, v67, v179
    v_mul_f32 v68, v68, v180
    v_mul_f32 v69, v69, v181
    v_mul_f32 v70, v70, v182
    v_mul_f32 v71, v71, v183
    v_cvt_pk_bf16_f32 v72, v64, v65
    v_cvt_pk_bf16_f32 v73, v66, v67
    v_cvt_pk_bf16_f32 v74, v68, v69
    v_cvt_pk_bf16_f32 v75, v70, v71
    s_cmp_lg_u32 s55, 0
    s_cbranch_scc1 L_slow_h63
    buffer_store_dwordx4 v[72:75], v1, s[32:35], s91 offen offset:1024
L_ret_h63:
    v_pk_mul_f32 v[176:177], v[80:81], v[80:81]
    v_pk_mul_f32 v[178:179], v[82:83], v[82:83]
    v_pk_mul_f32 v[180:181], v[84:85], v[84:85]
    v_pk_mul_f32 v[182:183], v[86:87], v[86:87]
    v_pk_fma_f32 v[176:177], v[176:177], v[240:241], v[240:241] op_sel:[0,1,0] op_sel_hi:[1,1,0]
    v_pk_fma_f32 v[178:179], v[178:179], v[240:241], v[240:241] op_sel:[0,1,0] op_sel_hi:[1,1,0]
    v_pk_fma_f32 v[180:181], v[180:181], v[240:241], v[240:241] op_sel:[0,1,0] op_sel_hi:[1,1,0]
    s_add_u32 m0, s70, 0
    s_add_u32 s0, s67, 425984
    buffer_load_dwordx4 v6, s[24:27], s0 offen lds
    s_nop 0
    v_pk_fma_f32 v[182:183], v[182:183], v[240:241], v[240:241] op_sel:[0,1,0] op_sel_hi:[1,1,0]
    v_pk_mul_f32 v[176:177], v[176:177], v[80:81]
    v_pk_mul_f32 v[178:179], v[178:179], v[82:83]
    v_pk_mul_f32 v[180:181], v[180:181], v[84:85]
    v_pk_mul_f32 v[182:183], v[182:183], v[86:87]
    v_pk_mul_f32 v[80:81], v[80:81], v[88:89]
    v_pk_mul_f32 v[82:83], v[82:83], v[90:91]
    v_pk_mul_f32 v[84:85], v[84:85], v[92:93]
    v_pk_mul_f32 v[86:87], v[86:87], v[94:95]
    v_mfma_f32_32x32x16_bf16 v[96:111], a[140:143], v[192:195], v[96:111]
    buffer_load_dwordx4 v10, s[24:27], s0 offen offset:1024 lds
    v_exp_f32 v176, v176
    v_exp_f32 v177, v177
    v_exp_f32 v178, v178
    v_exp_f32 v179, v179
    v_mfma_f32_32x32x16_bf16 v[96:111], a[156:159], v[200:203], v[96:111]
    s_add_u32 m0, s70, 2048
    s_add_u32 s0, s67, 442368
    buffer_load_dwordx4 v6, s[24:27], s0 offen lds
    v_exp_f32 v180, v180
    v_exp_f32 v181, v181
    v_exp_f32 v182, v182
    v_exp_f32 v183, v183
    v_mfma_f32_32x32x16_bf16 v[96:111], a[172:175], v[208:211], v[96:111]
    buffer_load_dwordx4 v10, s[24:27], s0 offen offset:1024 lds
    v_fma_f32 v176, v176, v242, v242
    v_fma_f32 v177, v177, v242, v242
    v_fma_f32 v178, v178, v242, v242
    v_fma_f32 v179, v179, v242, v242
    v_fma_f32 v180, v180, v242, v242
    v_fma_f32 v181, v181, v242, v242
    s_add_u32 m0, s70, 69632
    s_add_u32 s0, s67, 393216
    buffer_load_dwordx4 v6, s[24:27], s0 offen lds
    v_mfma_f32_32x32x16_bf16 v[96:111], a[188:191], v[216:219], v[96:111]
    v_fma_f32 v182, v182, v242, v242
    v_fma_f32 v183, v183, v242, v242
    v_rcp_f32 v176, v176
    v_rcp_f32 v177, v177
    buffer_load_dwordx4 v10, s[24:27], s0 offen offset:1024 lds
    v_rcp_f32 v178, v178
    v_mfma_f32_32x32x16_bf16 v[96:111], a[204:207], v[224:227], v[96:111]
    v_rcp_f32 v179, v179
    v_rcp_f32 v180, v180
    s_add_u32 m0, s70, 71680
    s_add_u32 s0, s67, 409600
    buffer_load_dwordx4 v6, s[24:27], s0 offen lds
    v_rcp_f32 v181, v181
    v_mfma_f32_32x32x16_bf16 v[96:111], a[220:223], v[232:235], v[96:111]
    v_rcp_f32 v182, v182
    v_rcp_f32 v183, v183
    buffer_load_dwordx4 v10, s[24:27], s0 offen offset:1024 lds
    v_mul_f32 v80, v80, v176
    v_mul_f32 v81, v81, v177
    v_mul_f32 v82, v82, v178
    v_mfma_f32_32x32x16_bf16 v[96:111], a[102:105], v[244:247], v[96:111]
    v_mul_f32 v83, v83, v179
    v_mul_f32 v84, v84, v180
    v_mul_f32 v85, v85, v181
    v_mul_f32 v86, v86, v182
    v_mul_f32 v87, v87, v183
    v_cvt_pk_bf16_f32 v88, v80, v81
    v_cvt_pk_bf16_f32 v89, v82, v83
    v_cvt_pk_bf16_f32 v90, v84, v85
    v_cvt_pk_bf16_f32 v91, v86, v87
    s_cmp_lg_u32 s55, 0
    s_cbranch_scc1 L_slow_h64
    buffer_store_dwordx4 v[88:91], v1, s[32:35], s91 offen offset:2048
L_ret_h64:
    v_pk_mul_f32 v[176:177], v[96:97], v[96:97]
    v_pk_mul_f32 v[178:179], v[98:99], v[98:99]
    v_pk_mul_f32 v[180:181], v[100:101], v[100:101]
    v_pk_mul_f32 v[182:183], v[102:103], v[102:103]
    v_pk_fma_f32 v[176:177], v[176:177], v[240:241], v[240:241] op_sel:[0,1,0] op_sel_hi:[1,1,0]
    v_pk_fma_f32 v[178:179], v[178:179], v[240:241], v[240:241] op_sel:[0,1,0] op_sel_hi:[1,1,0]
    v_pk_fma_f32 v[180:181], v[180:181], v[240:241], v[240:241] op_sel:[0,1,0] op_sel_hi:[1,1,0]
    v_pk_fma_f32 v[182:183], v[182:183], v[240:241], v[240:241] op_sel:[0,1,0] op_sel_hi:[1,1,0]
    v_pk_mul_f32 v[176:177], v[176:177], v[96:97]
    v_pk_mul_f32 v[178:179], v[178:179], v[98:99]
    v_pk_mul_f32 v[180:181], v[180:181], v[100:101]
    v_pk_mul_f32 v[182:183], v[182:183], v[102:103]
    v_pk_mul_f32 v[96:97], v[96:97], v[104:105]
    v_pk_mul_f32 v[98:99], v[98:99], v[106:107]
    v_pk_mul_f32 v[100:101], v[100:101], v[108:109]
    v_pk_mul_f32 v[102:103], v[102:103], v[110:111]
    v_mfma_f32_32x32x16_bf16 v[112:127], a[128:131], v[196:199], v[112:127]
    v_exp_f32 v176, v176
    v_exp_f32 v177, v177
    v_exp_f32 v178, v178
    v_exp_f32 v179, v179
    v_mfma_f32_32x32x16_bf16 v[112:127], a[144:147], v[204:207], v[112:127]
    v_exp_f32 v180, v180
    v_exp_f32 v181, v181
    v_exp_f32 v182, v182
    v_exp_f32 v183, v183
    v_mfma_f32_32x32x16_bf16 v[112:127], a[160:163], v[212:215], v[112:127]
    v_fma_f32 v176, v176, v242, v242
    v_fma_f32 v177, v177, v242, v242
    v_fma_f32 v178, v178, v242, v242
    v_fma_f32 v179, v179, v242, v242
    v_fma_f32 v180, v180, v242, v242
    v_fma_f32 v181, v181, v242, v242
    v_mfma_f32_32x32x16_bf16 v[112:127], a[176:179], v[220:223], v[112:127]
    v_fma_f32 v182, v182, v242, v242
    v_fma_f32 v183, v183, v242, v242
    v_rcp_f32 v176, v176
    v_rcp_f32 v177, v177
    v_rcp_f32 v178, v178
    v_mfma_f32_32x32x16_bf16 v[112:127], a[192:195], v[228:231], v[112:127]
    v_rcp_f32 v179, v179
    v_rcp_f32 v180, v180
    v_rcp_f32 v181, v181
    s_waitcnt vmcnt(33)
    v_mfma_f32_32x32x16_bf16 v[112:127], a[208:211], v[236:239], v[112:127]
    v_rcp_f32 v182, v182
    v_rcp_f32 v183, v183
    v_mul_f32 v96, v96, v176
    v_mul_f32 v97, v97, v177
    v_mul_f32 v98, v98, v178
    v_mfma_f32_32x32x16_bf16 v[112:127], a[96:99], v[252:255], v[112:127]
    v_mul_f32 v99, v99, v179
    v_mul_f32 v100, v100, v180
    v_mul_f32 v101, v101, v181
    v_mul_f32 v102, v102, v182
    v_mul_f32_e64 v103, v103, v183
    v_cvt_pk_bf16_f32 v104, v96, v97
    v_cvt_pk_bf16_f32 v105, v98, v99
    v_cvt_pk_bf16_f32 v106, v100, v101
    v_cvt_pk_bf16_f32 v107, v102, v103
    s_cmp_lg_u32 s55, 0
    s_cbranch_scc1 L_slow_h65
    buffer_store_dwordx4 v[104:107], v1, s[32:35], s91 offen offset:3072
L_ret_h65:
    s_add_u32 s76, s91, 114688
    v_pk_mul_f32 v[176:177], v[112:113], v[112:113]
    v_pk_mul_f32 v[178:179], v[114:115], v[114:115]
    v_pk_mul_f32 v[180:181], v[116:117], v[116:117]
    v_pk_mul_f32 v[182:183], v[118:119], v[118:119]
    v_pk_fma_f32 v[176:177], v[176:177], v[248:249], v[248:249] op_sel:[0,1,0] op_sel_hi:[1,1,0]
    v_pk_fma_f32 v[178:179], v[178:179], v[248:249], v[248:249] op_sel:[0,1,0] op_sel_hi:[1,1,0]
    v_pk_fma_f32 v[180:181], v[180:181], v[248:249], v[248:249] op_sel:[0,1,0] op_sel_hi:[1,1,0]
    v_pk_fma_f32 v[182:183], v[182:183], v[248:249], v[248:249] op_sel:[0,1,0] op_sel_hi:[1,1,0]
    v_pk_mul_f32 v[176:177], v[176:177], v[112:113]
    v_pk_mul_f32 v[178:179], v[178:179], v[114:115]
    v_pk_mul_f32 v[180:181], v[180:181], v[116:117]
    v_pk_mul_f32 v[182:183], v[182:183], v[118:119]
    v_pk_mul_f32 v[112:113], v[112:113], v[120:121]
    v_pk_mul_f32 v[114:115], v[114:115], v[122:123]
    v_pk_mul_f32 v[116:117], v[116:117], v[124:125]
    v_pk_mul_f32 v[118:119], v[118:119], v[126:127]
    v_mfma_f32_32x32x16_bf16 v[128:143], a[132:135], v[196:199], v[128:143]
    v_exp_f32 v176, v176
    v_exp_f32 v177, v177
    v_exp_f32 v178, v178
    v_exp_f32 v179, v179
    v_mfma_f32_32x32x16_bf16 v[128:143], a[148:151], v[204:207], v[128:143]
    v_exp_f32 v180, v180
    v_exp_f32 v181, v181
    v_exp_f32 v182, v182
    v_exp_f32 v183, v183
    v_mfma_f32_32x32x16_bf16 v[128:143], a[164:167], v[212:215], v[128:143]
    v_fma_f32 v176, v176, v250, v250
    v_fma_f32 v177, v177, v250, v250
    v_fma_f32 v178, v178, v250, v250
    v_fma_f32 v179, v179, v250, v250
    v_fma_f32 v180, v180, v250, v250
    v_fma_f32 v181, v181, v250, v250
    v_mfma_f32_32x32x16_bf16 v[128:143], a[180:183], v[220:223], v[128:143]
    v_fma_f32 v182, v182, v250, v250
    v_fma_f32 v183, v183, v250, v250
    v_rcp_f32 v176, v176
    v_rcp_f32 v177, v177
    v_rcp_f32 v178, v178
    v_mfma_f32_32x32x16_bf16 v[128:143], a[196:199], v[228:231], v[128:143]
    v_rcp_f32 v179, v179
    v_rcp_f32 v180, v180
    v_rcp_f32 v181, v181
    v_mfma_f32_32x32x16_bf16 v[128:143], a[212:215], v[236:239], v[128:143]
    v_rcp_f32 v182, v182
    v_rcp_f32 v183, v183
    v_mul_f32 v112, v112, v176
    v_mul_f32 v113, v113, v177
    v_mul_f32 v114, v114, v178
    v_mfma_f32_32x32x16_bf16 v[128:143], a[98:101], v[252:255], v[128:143]
    v_mul_f32 v115, v115, v179
    v_mul_f32 v116, v116, v180
    v_mul_f32 v117, v117, v181
    v_mul_f32 v118, v118, v182
    v_mul_f32 v119, v119, v183
    v_cvt_pk_bf16_f32 v120, v112, v113
    v_cvt_pk_bf16_f32 v121, v114, v115
    v_cvt_pk_bf16_f32 v122, v116, v117
    v_cvt_pk_bf16_f32 v123, v118, v119
    s_cmp_lg_u32 s55, 0
    s_cbranch_scc1 L_slow_h66
    buffer_store_dwordx4 v[120:123], v1, s[32:35], s76 offen offset:0
L_ret_h66:
    v_mov_b32 v30, 1
    s_waitcnt vmcnt(1)
    s_cmp_lg_u32 s55, 0
    s_cbranch_scc1 L_slow_f67
    buffer_store_dword v30, v28, s[32:35], s92 offen offset:1024
L_ret_f67:
    v_pk_mul_f32 v[176:177], v[128:129], v[128:129]
    v_pk_mul_f32 v[178:179], v[130:131], v[130:131]
    v_pk_mul_f32 v[180:181], v[132:133], v[132:133]
    v_pk_mul_f32 v[182:183], v[134:135], v[134:135]
    v_pk_fma_f32 v[176:177], v[176:177], v[248:249], v[248:249] op_sel:[0,1,0] op_sel_hi:[1,1,0]
    v_pk_fma_f32 v[178:179], v[178:179], v[248:249], v[248:249] op_sel:[0,1,0] op_sel_hi:[1,1,0]
    v_pk_fma_f32 v[180:181], v[180:181], v[248:249], v[248:249] op_sel:[0,1,0] op_sel_hi:[1,1,0]
    v_pk_fma_f32 v[182:183], v[182:183], v[248:249], v[248:249] op_sel:[0,1,0] op_sel_hi:[1,1,0]
    v_pk_mul_f32 v[176:177], v[176:177], v[128:129]
    v_pk_mul_f32 v[178:179], v[178:179], v[130:131]
    v_pk_mul_f32 v[180:181], v[180:181], v[132:133]
    v_pk_mul_f32 v[182:183], v[182:183], v[134:135]
    v_pk_mul_f32 v[128:129], v[128:129], v[136:137]
    v_pk_mul_f32 v[130:131], v[130:131], v[138:139]
    v_pk_mul_f32 v[132:133], v[132:133], v[140:141]
    v_pk_mul_f32 v[134:135], v[134:135], v[142:143]
    v_mfma_f32_32x32x16_bf16 v[144:159], a[136:139], v[196:199], v[144:159]
    v_exp_f32 v176, v176
    v_exp_f32 v177, v177
    v_exp_f32 v178, v178
    v_exp_f32 v179, v179
    v_mfma_f32_32x32x16_bf16 v[144:159], a[152:155], v[204:207], v[144:159]
    v_exp_f32 v180, v180
    v_exp_f32 v181, v181
    v_exp_f32 v182, v182
    v_exp_f32 v183, v183
    v_mfma_f32_32x32x16_bf16 v[144:159], a[168:171], v[212:215], v[144:159]
    v_fma_f32 v176, v176, v250, v250
    v_fma_f32 v177, v177, v250, v250
    v_fma_f32 v178, v178, v250, v250
    v_fma_f32 v179, v179, v250, v250
    v_fma_f32 v180, v180, v250, v250
    v_fma_f32 v181, v181, v250, v250
    buffer_load_dword v17, v23, s[32:35], s93 offen offset:1024 sc1
    v_mfma_f32_32x32x16_bf16 v[144:159], a[184:187], v[220:223], v[144:159]
    v_fma_f32 v182, v182, v250, v250
    v_fma_f32 v183, v183, v250, v250
    v_rcp_f32 v176, v176
    v_rcp_f32 v177, v177
    v_rcp_f32 v178, v178
    v_mfma_f32_32x32x16_bf16 v[144:159], a[200:203], v[228:231], v[144:159]
    v_rcp_f32 v179, v179
    v_rcp_f32 v180, v180
    v_rcp_f32 v181, v181
    v_mfma_f32_32x32x16_bf16 v[144:159], a[216:219], v[236:239], v[144:159]
    v_rcp_f32 v182, v182
    v_rcp_f32 v183, v183
    v_mul_f32 v128, v128, v176
    v_mul_f32 v129, v129, v177
    v_mul_f32 v130, v130, v178
    v_mfma_f32_32x32x16_bf16 v[144:159], a[100:103], v[252:255], v[144:159]
    v_mul_f32 v131, v131, v179
    v_mul_f32 v132, v132, v180
    v_mul_f32 v133, v133, v181
    v_mul_f32 v134, v134, v182
    v_mul_f32 v135, v135, v183
    v_cvt_pk_bf16_f32 v136, v128, v129
    v_cvt_pk_bf16_f32 v137, v130, v131
    v_cvt_pk_bf16_f32 v138, v132, v133
    v_cvt_pk_bf16_f32 v139, v134, v135
    s_cmp_lg_u32 s55, 0
    s_cbranch_scc1 L_slow_h68
    buffer_store_dwordx4 v[136:139], v1, s[32:35], s76 offen offset:1024
L_ret_h68:
    v_pk_mul_f32 v[176:177], v[144:145], v[144:145]
    v_pk_mul_f32 v[178:179], v[146:147], v[146:147]
    v_pk_mul_f32 v[180:181], v[148:149], v[148:149]
    v_pk_mul_f32 v[182:183], v[150:151], v[150:151]
    v_pk_fma_f32 v[176:177], v[176:177], v[248:249], v[248:249] op_sel:[0,1,0] op_sel_hi:[1,1,0]
    v_pk_fma_f32 v[178:179], v[178:179], v[248:249], v[248:249] op_sel:[0,1,0] op_sel_hi:[1,1,0]
    v_pk_fma_f32 v[180:181], v[180:181], v[248:249], v[248:249] op_sel:[0,1,0] op_sel_hi:[1,1,0]
    v_pk_fma_f32 v[182:183], v[182:183], v[248:249], v[248:249] op_sel:[0,1,0] op_sel_hi:[1,1,0]
    v_pk_mul_f32 v[176:177], v[176:177], v[144:145]
    v_pk_mul_f32 v[178:179], v[178:179], v[146:147]
    v_pk_mul_f32 v[180:181], v[180:181], v[148:149]
    v_pk_mul_f32 v[182:183], v[182:183], v[150:151]
    v_pk_mul_f32 v[144:145], v[144:145], v[152:153]
    v_pk_mul_f32 v[146:147], v[146:147], v[154:155]
    v_pk_mul_f32 v[148:149], v[148:149], v[156:157]
    v_pk_mul_f32 v[150:151], v[150:151], v[158:159]
    v_mfma_f32_32x32x16_bf16 v[160:175], a[140:143], v[196:199], v[160:175]
    v_exp_f32 v176, v176
    v_exp_f32 v177, v177
    v_exp_f32 v178, v178
    v_exp_f32 v179, v179
    v_mfma_f32_32x32x16_bf16 v[160:175], a[156:159], v[204:207], v[160:175]
    v_exp_f32 v180, v180
    v_exp_f32 v181, v181
    v_exp_f32 v182, v182
    v_exp_f32 v183, v183
    v_mfma_f32_32x32x16_bf16 v[160:175], a[172:175], v[212:215], v[160:175]
    s_waitcnt vmcnt(1)
    v_cmp_eq_u32 vcc, 0, v17
    s_nop 0
    s_cbranch_vccnz L_redo70
L_done69:
    s_add_u32 s58, s94, 0
    buffer_load_dwordx4 v[48:51], v1, s[32:35], s58 offen offset:0 sc1
    v_fma_f32 v176, v176, v250, v250
    v_fma_f32 v177, v177, v250, v250
    v_fma_f32 v178, v178, v250, v250
    v_fma_f32 v179, v179, v250, v250
    v_fma_f32 v180, v180, v250, v250
    v_fma_f32 v181, v181, v250, v250
    v_mfma_f32_32x32x16_bf16 v[160:175], a[188:191], v[220:223], v[160:175]
    buffer_load_dwordx4 v[52:55], v1, s[32:35], s58 offen offset:1024 sc1
    v_fma_f32 v182, v182, v250, v250
    v_fma_f32 v183, v183, v250, v250
    v_rcp_f32 v176, v176
    v_rcp_f32 v177, v177
    v_rcp_f32 v178, v178
    v_mfma_f32_32x32x16_bf16 v[160:175], a[204:207], v[228:231], v[160:175]
    buffer_load_dwordx4 v[56:59], v1, s[32:35], s58 offen offset:2048 sc1
    v_rcp_f32 v179, v179
    v_rcp_f32 v180, v180
    v_rcp_f32 v181, v181
    v_mfma_f32_32x32x16_bf16 v[160:175], a[220:223], v[236:239], v[160:175]
    v_rcp_f32 v182, v182
    buffer_load_dwordx4 v[60:63], v1, s[32:35], s58 offen offset:3072 sc1
    v_rcp_f32 v183, v183
    v_mul_f32 v144, v144, v176
    v_mul_f32 v145, v145, v177
    v_mul_f32 v146, v146, v178
    v_mfma_f32_32x32x16_bf16 v[160:175], a[102:105], v[252:255], v[160:175]
    v_mul_f32 v147, v147, v179
    v_mul_f32 v148, v148, v180
    v_mul_f32 v149, v149, v181
    v_mul_f32 v150, v150, v182
    v_mul_f32_e64 v151, v151, v183
    v_cvt_pk_bf16_f32 v152, v144, v145
    v_cvt_pk_bf16_f32 v153, v146, v147
    v_cvt_pk_bf16_f32 v154, v148, v149
    v_cvt_pk_bf16_f32 v155, v150, v151
    s_cmp_lg_u32 s55, 0
    s_cbranch_scc1 L_slow_h72
    buffer_store_dwordx4 v[152:155], v1, s[32:35], s76 offen offset:2048
L_ret_h72:
    v_pk_mul_f32 v[176:177], v[160:161], v[160:161]
    v_pk_mul_f32 v[178:179], v[162:163], v[162:163]
    v_pk_mul_f32 v[180:181], v[164:165], v[164:165]
    s_add_u32 s58, s94, 4096
    buffer_load_dwordx4 v[64:67], v1, s[32:35], s58 offen offset:0 sc1
    v_pk_mul_f32 v[182:183], v[166:167], v[166:167]
    v_pk_fma_f32 v[176:177], v[176:177], v[248:249], v[248:249] op_sel:[0,1,0] op_sel_hi:[1,1,0]
    v_pk_fma_f32 v[178:179], v[178:179], v[248:249], v[248:249] op_sel:[0,1,0] op_sel_hi:[1,1,0]
    v_pk_fma_f32 v[180:181], v[180:181], v[248:249], v[248:249] op_sel:[0,1,0] op_sel_hi:[1,1,0]
    v_pk_fma_f32 v[182:183], v[182:183], v[248:249], v[248:249] op_sel:[0,1,0] op_sel_hi:[1,1,0]
    v_pk_mul_f32 v[176:177], v[176:177], v[160:161]
    v_pk_mul_f32 v[178:179], v[178:179], v[162:163]
    v_pk_mul_f32 v[180:181], v[180:181], v[164:165]
    v_pk_mul_f32 v[182:183], v[182:183], v[166:167]
    v_pk_mul_f32 v[160:161], v[160:161], v[168:169]
    v_pk_mul_f32 v[162:163], v[162:163], v[170:171]
    v_pk_mul_f32 v[164:165], v[164:165], v[172:173]
    v_pk_mul_f32 v[166:167], v[166:167], v[174:175]
    v_exp_f32 v176, v176
    buffer_load_dwordx4 v[68:71], v1, s[32:35], s58 offen offset:1024 sc1
    v_exp_f32 v177, v177
    v_exp_f32 v178, v178
    v_exp_f32 v179, v179
    v_exp_f32 v180, v180
    v_exp_f32 v181, v181
    v_exp_f32 v182, v182
    buffer_load_dwordx4 v[72:75], v1, s[32:35], s58 offen offset:2048 sc1
    v_exp_f32 v183, v183
    v_pk_fma_f32 v[176:177], v[176:177], v[250:251], v[250:251] op_sel_hi:[1,0,0]
    v_pk_fma_f32 v[178:179], v[178:179], v[250:251], v[250:251] op_sel_hi:[1,0,0]
    v_pk_fma_f32 v[180:181], v[180:181], v[250:251], v[250:251] op_sel_hi:[1,0,0]
    v_pk_fma_f32 v[182:183], v[182:183], v[250:251], v[250:251] op_sel_hi:[1,0,0]
    v_rcp_f32 v176, v176
    v_rcp_f32 v177, v177
    v_rcp_f32 v178, v178
    v_rcp_f32 v179, v179
    buffer_load_dwordx4 v[76:79], v1, s[32:35], s58 offen offset:3072 sc1
    v_rcp_f32 v180, v180
    v_rcp_f32 v181, v181
    v_rcp_f32 v182, v182
    v_rcp_f32 v183, v183
    v_pk_mul_f32 v[160:161], v[160:161], v[176:177]
    v_pk_mul_f32 v[162:163], v[162:163], v[178:179]
    v_pk_mul_f32 v[164:165], v[164:165], v[180:181]
    v_pk_mul_f32 v[166:167], v[166:167], v[182:183]
    v_cvt_pk_bf16_f32 v168, v160, v161
    v_cvt_pk_bf16_f32 v169, v162, v163
    v_cvt_pk_bf16_f32 v170, v164, v165
    v_cvt_pk_bf16_f32 v171, v166, v167
    s_cmp_lg_u32 s55, 0
    s_cbranch_scc1 L_slow_h73
    buffer_store_dwordx4 v[168:171], v1, s[32:35], s76 offen offset:3072
L_ret_h73:
L_k4_1:
    v_add_u32 v24, 65536, v18
    v_add_u32 v25, 65536, v19
    s_waitcnt vmcnt(9)
    v_mfma_f32_32x32x16_bf16 v[144:159], a[4:7], v[48:51], 0
    s_add_u32 s58, s94, 8192
    buffer_load_dwordx4 v[80:83], v1, s[32:35], s58 offen offset:0 sc1
    v_mfma_f32_32x32x16_bf16 v[112:127], a[0:3], v[48:51], 0
    s_and_b32 s57, s48, 2
    s_waitcnt vmcnt(9)
    v_mfma_f32_32x32x16_bf16 v[144:159], a[12:15], v[52:55], v[144:159]
    buffer_load_dwordx4 v[84:87], v1, s[32:35], s58 offen offset:1024 sc1
    v_mfma_f32_32x32x16_bf16 v[112:127], a[8:11], v[52:55], v[112:127]
    s_lshl_b32 s57, s57, 14
    ds_read_b64_tr_b16 a[80:81], v18 offset:6144
    ds_read_b64_tr_b16 a[82:83], v18 offset:6656
    ds_read_b64_tr_b16 a[84:85], v19 offset:6144
    ds_read_b64_tr_b16 a[86:87], v19 offset:6656
    s_waitcnt vmcnt(9)
    v_mfma_f32_32x32x16_bf16 v[144:159], a[20:23], v[56:59], v[144:159]
    buffer_load_dwordx4 v[88:91], v1, s[32:35], s58 offen offset:2048 sc1
    v_mfma_f32_32x32x16_bf16 v[112:127], a[16:19], v[56:59], v[112:127]
    v_mov_b32 v30, 1
    s_waitcnt vmcnt(3)
    s_cmp_lg_u32 s55, 0
    s_cbranch_scc1 L_slow_f77
    buffer_store_dword v30, v28, s[36:39], s92 offen offset:1152
L_ret_f77:
    s_and_b32 s76, s48, 1
    ds_read_b64_tr_b16 a[88:89], v20 offset:0
    ds_read_b64_tr_b16 a[90:91], v20 offset:512
    ds_read_b64_tr_b16 a[92:93], v21 offset:0
    ds_read_b64_tr_b16 a[94:95], v21 offset:512
    v_mfma_f32_32x32x16_bf16 v[144:159], a[28:31], v[60:63], v[144:159]
    buffer_load_dwordx4 v[92:95], v1, s[32:35], s58 offen offset:3072 sc1
    v_mfma_f32_32x32x16_bf16 v[112:127], a[24:27], v[60:63], v[112:127]
    s_lshl_b32 s76, s76, 12
    ds_read_b64_tr_b16 a[96:97], v20 offset:2048
    ds_read_b64_tr_b16 a[98:99], v20 offset:2560
    ds_read_b64_tr_b16 a[100:101], v21 offset:2048
    ds_read_b64_tr_b16 a[102:103], v21 offset:2560
    v_mfma_f32_32x32x16_bf16 v[144:159], a[36:39], v[64:67], v[144:159]
    s_add_u32 s58, s94, 12288
    buffer_load_dwordx4 v[96:99], v1, s[32:35], s58 offen offset:0 sc1
    v_mfma_f32_32x32x16_bf16 v[112:127], a[32:35], v[64:67], v[112:127]
    s_add_u32 s57, s57, s76
    ds_read_b64_tr_b16 a[104:105], v20 offset:4096
    ds_read_b64_tr_b16 a[106:107], v20 offset:4608
    ds_read_b64_tr_b16 a[108:109], v21 offset:4096
    ds_read_b64_tr_b16 a[110:111], v21 offset:4608
    v_mfma_f32_32x32x16_bf16 v[144:159], a[44:47], v[68:71], v[144:159]
    buffer_load_dwordx4 v[100:103], v1, s[32:35], s58 offen offset:1024 sc1
    v_mfma_f32_32x32x16_bf16 v[112:127], a[40:43], v[68:71], v[112:127]
    v_add_u32_e64 v12, s57, v1
    ds_read_b64_tr_b16 a[112:113], v18 offset:32768
    ds_read_b64_tr_b16 a[114:115], v18 offset:33280
    ds_read_b64_tr_b16 a[116:117], v19 offset:32768
    ds_read_b64_tr_b16 a[118:119], v19 offset:33280
    v_mfma_f32_32x32x16_bf16 v[144:159], a[52:55], v[72:75], v[144:159]
    buffer_load_dwordx4 v[104:107], v1, s[32:35], s58 offen offset:2048 sc1
    v_mfma_f32_32x32x16_bf16 v[112:127], a[48:51], v[72:75], v[112:127]
    v_xor_b32 v13, 0x5000, v12
    ds_read_b64_tr_b16 a[120:121], v18 offset:34816
    ds_read_b64_tr_b16 a[122:123], v18 offset:35328
    ds_read_b64_tr_b16 a[124:125], v19 offset:34816
    ds_read_b64_tr_b16 a[126:127], v19 offset:35328
    v_mfma_f32_32x32x16_bf16 v[144:159], a[60:63], v[76:79], v[144:159]
    buffer_load_dwordx4 v[108:111], v1, s[32:35], s58 offen offset:3072 sc1
    v_mfma_f32_32x32x16_bf16 v[112:127], a[56:59], v[76:79], v[112:127]
    v_xor_b32 v14, 0xa000, v12
    ds_read_b64_tr_b16 a[128:129], v18 offset:36864
    ds_read_b64_tr_b16 a[130:131], v18 offset:37376
    ds_read_b64_tr_b16 a[132:133], v19 offset:36864
    ds_read_b64_tr_b16 a[134:135], v19 offset:37376
    s_waitcnt vmcnt(8)
    v_mfma_f32_32x32x16_bf16 v[144:159], a[68:71], v[80:83], v[144:159]
    s_add_u32 s58, s94, 16384
    buffer_load_dwordx4 v[176:179], v1, s[32:35], s58 offen offset:0 sc1
    v_mfma_f32_32x32x16_bf16 v[112:127], a[64:67], v[80:83], v[112:127]
    v_xor_b32 v15, 0xf000, v12
    ds_read_b64_tr_b16 a[136:137], v18 offset:38912
    ds_read_b64_tr_b16 a[138:139], v18 offset:39424
    ds_read_b64_tr_b16 a[140:141], v19 offset:38912
    ds_read_b64_tr_b16 a[142:143], v19 offset:39424
    s_waitcnt vmcnt(8)
    v_mfma_f32_32x32x16_bf16 v[144:159], a[76:79], v[84:87], v[144:159]
    buffer_load_dwordx4 v[180:183], v1, s[32:35], s58 offen offset:1024 sc1
    v_mfma_f32_32x32x16_bf16 v[112:127], a[72:75], v[84:87], v[112:127]
    s_lshl_b32 s57, s48, 14
    ds_read_b64_tr_b16 a[144:145], v24 offset:32768
    ds_read_b64_tr_b16 a[146:147], v24 offset:33280
    ds_read_b64_tr_b16 a[148:149], v25 offset:32768
    ds_read_b64_tr_b16 a[150:151], v25 offset:33280
    s_waitcnt vmcnt(8) lgkmcnt(14)
    v_mfma_f32_32x32x16_bf16 v[144:159], a[84:87], v[88:91], v[144:159]
    buffer_load_dwordx4 v[184:187], v1, s[32:35], s58 offen offset:2048 sc1
    v_mfma_f32_32x32x16_bf16 v[112:127], a[80:83], v[88:91], v[112:127]
    v_add_u32_e64 v16, s57, v1
    ds_read_b64_tr_b16 a[152:153], v24 offset:34816
    ds_read_b64_tr_b16 a[154:155], v24 offset:35328
    ds_read_b64_tr_b16 a[156:157], v25 offset:34816
    ds_read_b64_tr_b16 a[158:159], v25 offset:35328
    s_waitcnt vmcnt(7)
    v_mfma_f32_32x32x16_bf16 v[144:159], a[92:95], v[92:95], v[144:159]
    buffer_load_dwordx4 v[188:191], v1, s[32:35], s58 offen offset:3072 sc1
    v_mfma_f32_32x32x16_bf16 v[112:127], a[88:91], v[92:95], v[112:127]
    ds_read_b64_tr_b16 a[160:161], v24 offset:36864
    ds_read_b64_tr_b16 a[162:163], v24 offset:37376
    ds_read_b64_tr_b16 a[164:165], v25 offset:36864
    ds_read_b64_tr_b16 a[166:167], v25 offset:37376
    s_waitcnt vmcnt(7)
    v_mfma_f32_32x32x16_bf16 v[144:159], a[100:103], v[96:99], v[144:159]
    s_add_u32 s58, s94, 20480
    buffer_load_dwordx4 v[192:195], v1, s[32:35], s58 offen offset:0 sc1
    v_mfma_f32_32x32x16_bf16 v[112:127], a[96:99], v[96:99], v[112:127]
    ds_read_b64_tr_b16 a[168:169], v24 offset:38912
    ds_read_b64_tr_b16 a[170:171], v24 offset:39424
    ds_read_b64_tr_b16 a[172:173], v25 offset:38912
    ds_read_b64_tr_b16 a[174:175], v25 offset:39424
    s_waitcnt vmcnt(7)
    v_mfma_f32_32x32x16_bf16 v[144:159], a[108:111], v[100:103], v[144:159]
    buffer_load_dwordx4 v[196:199], v1, s[32:35], s58 offen offset:1024 sc1
    v_mfma_f32_32x32x16_bf16 v[112:127], a[104:107], v[100:103], v[112:127]
    ds_read_b64_tr_b16 a[176:177], v24 offset:0
    ds_read_b64_tr_b16 a[178:179], v24 offset:512
    ds_read_b64_tr_b16 a[180:181], v25 offset:0
    ds_read_b64_tr_b16 a[182:183], v25 offset:512
    s_waitcnt vmcnt(7)
    v_mfma_f32_32x32x16_bf16 v[144:159], a[116:119], v[104:107], v[144:159]
    buffer_load_dword v17, v23, s[32:35], s93 offen offset:1152 sc1
    buffer_load_dwordx4 v[200:203], v1, s[32:35], s58 offen offset:2048 sc1
    v_mfma_f32_32x32x16_bf16 v[112:127], a[112:115], v[104:107], v[112:127]
    ds_read_b64_tr_b16 a[184:185], v24 offset:2048
    ds_read_b64_tr_b16 a[186:187], v24 offset:2560
    ds_read_b64_tr_b16 a[188:189], v25 offset:2048
    ds_read_b64_tr_b16 a[190:191], v25 offset:2560
    s_waitcnt vmcnt(8) lgkmcnt(14)
    v_mfma_f32_32x32x16_bf16 v[144:159], a[124:127], v[108:111], v[144:159]
    buffer_load_dwordx4 v[204:207], v1, s[32:35], s58 offen offset:3072 sc1
    v_mfma_f32_32x32x16_bf16 v[112:127], a[120:123], v[108:111], v[112:127]
    ds_read_b64_tr_b16 a[192:193], v24 offset:4096
    ds_read_b64_tr_b16 a[194:195], v24 offset:4608
    ds_read_b64_tr_b16 a[196:197], v25 offset:4096
    ds_read_b64_tr_b16 a[198:199], v25 offset:4608
    s_waitcnt vmcnt(8)
    v_mfma_f32_32x32x16_bf16 v[144:159], a[132:135], v[176:179], v[144:159]
    s_add_u32 s58, s94, 24576
    buffer_load_dwordx4 v[208:211], v1, s[32:35], s58 offen offset:0 sc1
    v_mfma_f32_32x32x16_bf16 v[112:127], a[128:131], v[176:179], v[112:127]
    ds_read_b64_tr_b16 a[200:201], v24 offset:6144
    ds_read_b64_tr_b16 a[202:203], v24 offset:6656
    ds_read_b64_tr_b16 a[204:205], v25 offset:6144
    ds_read_b64_tr_b16 a[206:207], v25 offset:6656
    s_waitcnt vmcnt(8)
    v_mfma_f32_32x32x16_bf16 v[144:159], a[140:143], v[180:183], v[144:159]
    buffer_load_dwordx4 v[212:215], v1, s[32:35], s58 offen offset:1024 sc1
    v_mfma_f32_32x32x16_bf16 v[112:127], a[136:139], v[180:183], v[112:127]
    ds_read_b64_tr_b16 a[208:209], v18 offset:0
    ds_read_b64_tr_b16 a[210:211], v18 offset:512
    ds_read_b64_tr_b16 a[212:213], v19 offset:0
    ds_read_b64_tr_b16 a[214:215], v19 offset:512
    s_waitcnt vmcnt(8)
    v_mfma_f32_32x32x16_bf16 v[144:159], a[148:151], v[184:187], v[144:159]
    buffer_load_dwordx4 v[216:219], v1, s[32:35], s58 offen offset:2048 sc1
    v_mfma_f32_32x32x16_bf16 v[112:127], a[144:147], v[184:187], v[112:127]
    ds_read_b64_tr_b16 a[216:217], v18 offset:2048
    ds_read_b64_tr_b16 a[218:219], v18 offset:2560
    ds_read_b64_tr_b16 a[220:221], v19 offset:2048
    ds_read_b64_tr_b16 a[222:223], v19 offset:2560
    s_waitcnt vmcnt(8)
    v_mfma_f32_32x32x16_bf16 v[144:159], a[156:159], v[188:191], v[144:159]
    buffer_load_dwordx4 v[220:223], v1, s[32:35], s58 offen offset:3072 sc1
    v_mfma_f32_32x32x16_bf16 v[112:127], a[152:155], v[188:191], v[112:127]
    s_waitcnt vmcnt(8) lgkmcnt(14)
    v_mfma_f32_32x32x16_bf16 v[144:159], a[164:167], v[192:195], v[144:159]
    s_waitcnt vmcnt(6)
    v_cmp_eq_u32 vcc, 0, v17
    s_nop 0
    s_cbranch_vccnz L_redo79
L_done78:
    s_add_u32 s58, s94, 114688
    buffer_load_dwordx4 v[224:227], v1, s[32:35], s58 offen offset:0 sc1
    v_mfma_f32_32x32x16_bf16 v[112:127], a[160:163], v[192:195], v[112:127]
    v_mfma_f32_32x32x16_bf16 v[144:159], a[172:175], v[196:199], v[144:159]
    buffer_load_dwordx4 v[228:231], v1, s[32:35], s58 offen offset:1024 sc1
    v_mfma_f32_32x32x16_bf16 v[112:127], a[168:171], v[196:199], v[112:127]
    s_waitcnt vmcnt(7)
    v_mfma_f32_32x32x16_bf16 v[144:159], a[180:183], v[200:203], v[144:159]
    buffer_load_dwordx4 v[232:235], v1, s[32:35], s58 offen offset:2048 sc1
    v_mfma_f32_32x32x16_bf16 v[112:127], a[176:179], v[200:203], v[112:127]
    s_waitcnt vmcnt(7)
    v_mfma_f32_32x32x16_bf16 v[144:159], a[188:191], v[204:207], v[144:159]
    buffer_load_dwordx4 v[236:239], v1, s[32:35], s58 offen offset:3072 sc1
    v_mfma_f32_32x32x16_bf16 v[112:127], a[184:187], v[204:207], v[112:127]
    s_waitcnt vmcnt(7) lgkmcnt(12)
    v_mfma_f32_32x32x16_bf16 v[144:159], a[196:199], v[208:211], v[144:159]
    s_add_u32 s58, s94, 118784
    buffer_load_dwordx4 v[240:243], v1, s[32:35], s58 offen offset:0 sc1
    v_mfma_f32_32x32x16_bf16 v[112:127], a[192:195], v[208:211], v[112:127]
    s_waitcnt lgkmcnt(0)
    s_barrier
    s_waitcnt vmcnt(7)
    v_mfma_f32_32x32x16_bf16 v[144:159], a[204:207], v[212:215], v[144:159]
    buffer_load_dwordx4 v[244:247], v1, s[32:35], s58 offen offset:1024 sc1
    v_mfma_f32_32x32x16_bf16 v[112:127], a[200:203], v[212:215], v[112:127]
    s_waitcnt vmcnt(7)
    v_mfma_f32_32x32x16_bf16 v[144:159], a[212:215], v[216:219], v[144:159]
    buffer_load_dwordx4 v[248:251], v1, s[32:35], s58 offen offset:2048 sc1
    v_mfma_f32_32x32x16_bf16 v[112:127], a[208:211], v[216:219], v[112:127]
    s_waitcnt vmcnt(7)
    v_mfma_f32_32x32x16_bf16 v[144:159], a[220:223], v[220:223], v[144:159]
    buffer_load_dwordx4 v[252:255], v1, s[32:35], s58 offen offset:3072 sc1
    v_mfma_f32_32x32x16_bf16 v[112:127], a[216:219], v[220:223], v[112:127]
    s_waitcnt vmcnt(7)
    v_mfma_f32_32x32x16_bf16 v[160:175], a[4:7], v[224:227], 0
    s_add_u32 s58, s94, 122880
    buffer_load_dwordx4 v[48:51], v1, s[32:35], s58 offen offset:0 sc1
    v_mfma_f32_32x32x16_bf16 v[128:143], a[0:3], v[224:227], 0
    s_waitcnt vmcnt(7)
    v_mfma_f32_32x32x16_bf16 v[160:175], a[12:15], v[228:231], v[160:175]
    buffer_load_dwordx4 v[52:55], v1, s[32:35], s58 offen offset:1024 sc1
    v_mfma_f32_32x32x16_bf16 v[128:143], a[8:11], v[228:231], v[128:143]
    s_waitcnt vmcnt(7)
    v_mfma_f32_32x32x16_bf16 v[160:175], a[20:23], v[232:235], v[160:175]
    buffer_load_dwordx4 v[56:59], v1, s[32:35], s58 offen offset:2048 sc1
    v_mfma_f32_32x32x16_bf16 v[128:143], a[16:19], v[232:235], v[128:143]
    s_waitcnt vmcnt(7)
    v_mfma_f32_32x32x16_bf16 v[160:175], a[28:31], v[236:239], v[160:175]
    buffer_load_dwordx4 v[60:63], v1, s[32:35], s58 offen offset:3072 sc1
    v_mfma_f32_32x32x16_bf16 v[128:143], a[24:27], v[236:239], v[128:143]
    s_waitcnt vmcnt(7)
    v_mfma_f32_32x32x16_bf16 v[160:175], a[36:39], v[240:243], v[160:175]
    s_add_u32 s58, s94, 126976
    buffer_load_dwordx4 v[64:67], v1, s[32:35], s58 offen offset:0 sc1
    v_mfma_f32_32x32x16_bf16 v[128:143], a[32:35], v[240:243], v[128:143]
    ds_write_b128 v14, v[144:147] offset:0
    s_waitcnt vmcnt(7)
    v_mfma_f32_32x32x16_bf16 v[160:175], a[44:47], v[244:247], v[160:175]
    buffer_load_dwordx4 v[68:71], v1, s[32:35], s58 offen offset:1024 sc1
    v_mfma_f32_32x32x16_bf16 v[128:143], a[40:43], v[244:247], v[128:143]
    ds_write_b128 v14, v[148:151] offset:1024
    s_waitcnt vmcnt(7)
    v_mfma_f32_32x32x16_bf16 v[160:175], a[52:55], v[248:251], v[160:175]
    buffer_load_dwordx4 v[72:75], v1, s[32:35], s58 offen offset:2048 sc1
    v_mfma_f32_32x32x16_bf16 v[128:143], a[48:51], v[248:251], v[128:143]
    ds_write_b128 v14, v[152:155] offset:2048
    s_waitcnt vmcnt(7)
    v_mfma_f32_32x32x16_bf16 v[160:175], a[60:63], v[252:255], v[160:175]
    buffer_load_dwordx4 v[76:79], v1, s[32:35], s58 offen offset:3072 sc1
    v_mfma_f32_32x32x16_bf16 v[128:143], a[56:59], v[252:255], v[128:143]
    ds_write_b128 v14, v[156:159] offset:3072
    s_waitcnt vmcnt(7)
    v_mfma_f32_32x32x16_bf16 v[160:175], a[68:71], v[48:51], v[160:175]
    s_add_u32 s58, s94, 131072
    buffer_load_dwordx4 v[80:83], v1, s[32:35], s58 offen offset:0 sc1
    v_mfma_f32_32x32x16_bf16 v[128:143], a[64:67], v[48:51], v[128:143]
    s_bitcmp1_b32 s48, 0
    s_cbranch_scc1 L_slow_a81
    v_add_f32 v32, v32, v112
    v_add_f32 v33, v33, v113
    v_add_f32 v34, v34, v114
    v_add_f32 v35, v35, v115
    s_branch L_ret_a81
L_slow_a81:
    ds_write_b128 v12, v[112:115] offset:0
L_ret_a81:
    s_waitcnt vmcnt(7)
    v_mfma_f32_32x32x16_bf16 v[160:175], a[76:79], v[52:55], v[160:175]
    buffer_load_dwordx4 v[84:87], v1, s[32:35], s58 offen offset:1024 sc1
    v_mfma_f32_32x32x16_bf16 v[128:143], a[72:75], v[52:55], v[128:143]
    s_bitcmp1_b32 s48, 0
    s_cbranch_scc1 L_slow_a82
    v_add_f32 v36, v36, v116
    v_add_f32 v37, v37, v117
    v_add_f32 v38, v38, v118
    v_add_f32 v39, v39, v119
    s_branch L_ret_a82
L_slow_a82:
    ds_write_b128 v12, v[116:119] offset:1024
L_ret_a82:
    s_waitcnt vmcnt(7)
    v_mfma_f32_32x32x16_bf16 v[160:175], a[84:87], v[56:59], v[160:175]
    buffer_load_dwordx4 v[88:91], v1, s[32:35], s58 offen offset:2048 sc1
    v_mfma_f32_32x32x16_bf16 v[128:143], a[80:83], v[56:59], v[128:143]
    s_bitcmp1_b32 s48, 0
    s_cbranch_scc1 L_slow_a83
    v_add_f32 v40, v40, v120
    v_add_f32 v41, v41, v121
    v_add_f32 v42, v42, v122
    v_add_f32 v43, v43, v123
    s_branch L_ret_a83
L_slow_a83:
    ds_write_b128 v12, v[120:123] offset:2048
L_ret_a83:
    s_waitcnt vmcnt(7)
    v_mfma_f32_32x32x16_bf16 v[160:175], a[92:95], v[60:63], v[160:175]
    buffer_load_dwordx4 v[92:95], v1, s[32:35], s58 offen offset:3072 sc1
    v_mfma_f32_32x32x16_bf16 v[128:143], a[88:91], v[60:63], v[128:143]
    s_bitcmp1_b32 s48, 0
    s_cbranch_scc1 L_slow_a84
    v_add_f32 v44, v44, v124
    v_add_f32 v45, v45, v125
    v_add_f32 v46, v46, v126
    v_add_f32 v47, v47, v127
    s_branch L_ret_a84
L_slow_a84:
    ds_write_b128 v12, v[124:127] offset:3072
L_ret_a84:
    s_waitcnt vmcnt(7)
    v_mfma_f32_32x32x16_bf16 v[160:175], a[100:103], v[64:67], v[160:175]
    s_add_u32 s58, s94, 135168
    buffer_load_dwordx4 v[96:99], v1, s[32:35], s58 offen offset:0 sc1
    v_mfma_f32_32x32x16_bf16 v[128:143], a[96:99], v[64:67], v[128:143]
    s_waitcnt vmcnt(7)
    v_mfma_f32_32x32x16_bf16 v[160:175], a[108:111], v[68:71], v[160:175]
    buffer_load_dwordx4 v[100:103], v1, s[32:35], s58 offen offset:1024 sc1
    v_mfma_f32_32x32x16_bf16 v[128:143], a[104:107], v[68:71], v[128:143]
    s_waitcnt vmcnt(7)
    v_mfma_f32_32x32x16_bf16 v[160:175], a[116:119], v[72:75], v[160:175]
    buffer_load_dwordx4 v[104:107], v1, s[32:35], s58 offen offset:2048 sc1
    v_mfma_f32_32x32x16_bf16 v[128:143], a[112:115], v[72:75], v[128:143]
    s_waitcnt vmcnt(7)
    v_mfma_f32_32x32x16_bf16 v[160:175], a[124:127], v[76:79], v[160:175]
    buffer_load_dwordx4 v[108:111], v1, s[32:35], s58 offen offset:3072 sc1
    v_mfma_f32_32x32x16_bf16 v[128:143], a[120:123], v[76:79], v[128:143]
    s_waitcnt vmcnt(7)
    v_mfma_f32_32x32x16_bf16 v[160:175], a[132:135], v[80:83], v[160:175]
    s_add_u32 s58, s94, 139264
    buffer_load_dwordx4 v[176:179], v1, s[32:35], s58 offen offset:0 sc1
    v_mfma_f32_32x32x16_bf16 v[128:143], a[128:131], v[80:83], v[128:143]
    s_waitcnt vmcnt(7)
    v_mfma_f32_32x32x16_bf16 v[160:175], a[140:143], v[84:87], v[160:175]
    buffer_load_dwordx4 v[180:183], v1, s[32:35], s58 offen offset:1024 sc1
    v_mfma_f32_32x32x16_bf16 v[128:143], a[136:139], v[84:87], v[128:143]
    s_waitcnt vmcnt(7)
    v_mfma_f32_32x32x16_bf16 v[160:175], a[148:151], v[88:91], v[160:175]
    buffer_load_dwordx4 v[184:187], v1, s[32:35], s58 offen offset:2048 sc1
    v_mfma_f32_32x32x16_bf16 v[128:143], a[144:147], v[88:91], v[128:143]
    s_waitcnt vmcnt(7)
    v_mfma_f32_32x32x16_bf16 v[160:175], a[156:159], v[92:95], v[160:175]
    buffer_load_dwordx4 v[188:191], v1, s[32:35], s58 offen offset:3072 sc1
    v_mfma_f32_32x32x16_bf16 v[128:143], a[152:155], v[92:95], v[128:143]
    s_waitcnt vmcnt(7)
    v_mfma_f32_32x32x16_bf16 v[160:175], a[164:167], v[96:99], v[160:175]
    v_mfma_f32_32x32x16_bf16 v[128:143], a[160:163], v[96:99], v[128:143]
    s_waitcnt vmcnt(6)
    v_mfma_f32_32x32x16_bf16 v[160:175], a[172:175], v[100:103], v[160:175]
    v_mfma_f32_32x32x16_bf16 v[128:143], a[168:171], v[100:103], v[128:143]
    s_waitcnt vmcnt(5)
    v_mfma_f32_32x32x16_bf16 v[160:175], a[180:183], v[104:107], v[160:175]
    v_mfma_f32_32x32x16_bf16 v[128:143], a[176:179], v[104:107], v[128:143]
    s_waitcnt vmcnt(4)
    v_mfma_f32_32x32x16_bf16 v[160:175], a[188:191], v[108:111], v[160:175]
    s_waitcnt vmcnt(3)
    v_mfma_f32_32x32x16_bf16 v[160:175], a[196:199], v[176:179], v[160:175]
    s_waitcnt vmcnt(2)
    v_mfma_f32_32x32x16_bf16 v[160:175], a[204:207], v[180:183], v[160:175]
    s_waitcnt vmcnt(1)
    v_mfma_f32_32x32x16_bf16 v[160:175], a[212:215], v[184:187], v[160:175]
    s_waitcnt vmcnt(0)
    v_mfma_f32_32x32x16_bf16 v[160:175], a[220:223], v[188:191], v[160:175]
    v_mfma_f32_32x32x16_bf16 v[128:143], a[184:187], v[108:111], v[128:143]
    v_mfma_f32_32x32x16_bf16 v[128:143], a[192:195], v[176:179], v[128:143]
    ds_write_b128 v15, v[160:163] offset:0
    v_mfma_f32_32x32x16_bf16 v[128:143], a[200:203], v[180:183], v[128:143]
    ds_write_b128 v15, v[164:167] offset:1024
    v_mfma_f32_32x32x16_bf16 v[128:143], a[208:211], v[184:187], v[128:143]
    ds_write_b128 v15, v[168:171] offset:2048
    v_mfma_f32_32x32x16_bf16 v[128:143], a[216:219], v[188:191], v[128:143]
    ds_write_b128 v15, v[172:175] offset:3072
    s_bitcmp0_b32 s48, 0
    s_cbranch_scc1 L_slow_a85
    s_nop 8
    s_nop 0
    v_pk_add_f32 v[32:33], v[32:33], v[128:129]
    v_pk_add_f32 v[34:35], v[34:35], v[130:131]
    v_pk_add_f32 v[36:37], v[36:37], v[132:133]
    v_pk_add_f32 v[38:39], v[38:39], v[134:135]
    v_pk_add_f32 v[40:41], v[40:41], v[136:137]
    v_pk_add_f32 v[42:43], v[42:43], v[138:139]
    v_pk_add_f32 v[44:45], v[44:45], v[140:141]
    v_pk_add_f32 v[46:47], v[46:47], v[142:143]
    s_branch L_ret_a85
L_slow_a85:
    s_nop 8
    ds_write_b128 v13, v[128:131] offset:0
    ds_write_b128 v13, v[132:135] offset:1024
    ds_write_b128 v13, v[136:139] offset:2048
    ds_write_b128 v13, v[140:143] offset:3072
L_ret_a85:
    s_waitcnt lgkmcnt(0)
    s_barrier
    ds_read_b128 v[128:131], v16 offset:4096
    ds_read_b128 v[132:135], v16 offset:5120
    ds_read_b128 v[136:139], v16 offset:6144
    ds_read_b128 v[140:143], v16 offset:7168
    ds_read_b128 v[144:147], v16 offset:8192
    ds_read_b128 v[148:151], v16 offset:9216
    ds_read_b128 v[152:155], v16 offset:10240
    ds_read_b128 v[156:159], v16 offset:11264
    ds_read_b128 v[160:163], v16 offset:12288
    ds_read_b128 v[164:167], v16 offset:13312
    ds_read_b128 v[168:171], v16 offset:14336
    ds_read_b128 v[172:175], v16 offset:15360
    s_waitcnt lgkmcnt(11)
    v_pk_add_f32 v[32:33], v[32:33], v[128:129]
    v_pk_add_f32 v[34:35], v[34:35], v[130:131]
    s_waitcnt lgkmcnt(10)
    v_pk_add_f32 v[36:37], v[36:37], v[132:133]
    v_pk_add_f32 v[38:39], v[38:39], v[134:135]
    s_waitcnt lgkmcnt(9)
    v_pk_add_f32 v[40:41], v[40:41], v[136:137]
    v_pk_add_f32 v[42:43], v[42:43], v[138:139]
    s_waitcnt lgkmcnt(8)
    v_pk_add_f32 v[44:45], v[44:45], v[140:141]
    v_pk_add_f32 v[46:47], v[46:47], v[142:143]
    s_waitcnt lgkmcnt(7)
    v_pk_add_f32 v[32:33], v[32:33], v[144:145]
    v_pk_add_f32 v[34:35], v[34:35], v[146:147]
    s_waitcnt lgkmcnt(6)
    v_pk_add_f32 v[36:37], v[36:37], v[148:149]
    v_pk_add_f32 v[38:39], v[38:39], v[150:151]
    s_waitcnt lgkmcnt(5)
    v_pk_add_f32 v[40:41], v[40:41], v[152:153]
    v_pk_add_f32 v[42:43], v[42:43], v[154:155]
    s_waitcnt lgkmcnt(4)
    v_pk_add_f32 v[44:45], v[44:45], v[156:157]
    v_pk_add_f32 v[46:47], v[46:47], v[158:159]
    s_waitcnt lgkmcnt(3)
    v_pk_add_f32 v[32:33], v[32:33], v[160:161]
    v_pk_add_f32 v[34:35], v[34:35], v[162:163]
    s_waitcnt lgkmcnt(2)
    v_pk_add_f32 v[36:37], v[36:37], v[164:165]
    v_pk_add_f32 v[38:39], v[38:39], v[166:167]
    s_waitcnt lgkmcnt(1)
    v_pk_add_f32 v[40:41], v[40:41], v[168:169]
    v_pk_add_f32 v[42:43], v[42:43], v[170:171]
    s_waitcnt lgkmcnt(0)
    v_pk_add_f32 v[44:45], v[44:45], v[172:173]
    v_pk_add_f32 v[46:47], v[46:47], v[174:175]
    v_cvt_pk_bf16_f32 v48, v32, v33
    v_cvt_pk_bf16_f32 v49, v34, v35
    v_cvt_pk_bf16_f32 v50, v36, v37
    v_cvt_pk_bf16_f32 v51, v38, v39
    v_cvt_pk_bf16_f32 v52, v40, v41
    v_cvt_pk_bf16_f32 v53, v42, v43
    v_cvt_pk_bf16_f32 v54, v44, v45
    v_cvt_pk_bf16_f32 v55, v46, v47
    buffer_store_dwordx4 v[48:51], v8, s[28:31], s75 offen
    buffer_store_dwordx4 v[52:55], v8, s[28:31], s75 offen offset:32
L_end:
    s_endpgm
L_redo6:
L_poll7:
    buffer_load_dword v113, v112, s[32:35], s59 offen offset:0 sc1
    s_waitcnt vmcnt(0)
    v_and_b32 v29, 63, v113
    v_cmp_ne_u32 vcc, 32, v29
    s_nop 1
    s_cbranch_vccz L_done5
    s_sub_u32 s56, s56, 1
    s_cbranch_scc0 L_poll7
    s_mov_b32 s56, 0
    s_branch L_done5
L_redo17:
L_poll18:
    buffer_load_dword v29, v246, s[32:35], s2 offen offset:0 sc1
    s_waitcnt vmcnt(0)
    v_cmp_eq_u32 vcc, 0, v29
    s_nop 1
    s_cbranch_vccz L_done16
    s_sub_u32 s56, s56, 1
    s_cbranch_scc0 L_poll18
    s_mov_b32 s56, 0
    s_branch L_done16
L_redo20:
L_poll21:
    buffer_load_dwordx4 a[100:103], v12, s[32:35], s47 offen sc1
    s_waitcnt vmcnt(0)
    v_accvgpr_read_b32 v184, a100
    v_accvgpr_read_b32 v185, a101
    v_accvgpr_read_b32 v186, a102
    v_accvgpr_read_b32 v187, a103
    v_min3_u32 v29, v184, v185, v186
    v_min_u32 v29, v29, v187
    s_waitcnt vmcnt(0)
    v_cmp_eq_u32 vcc, 0, v29
    s_nop 1
    s_cbranch_vccz L_done19
    s_sub_u32 s56, s56, 1
    s_cbranch_scc0 L_poll21
    s_mov_b32 s56, 0
    s_branch L_done19
L_redo24:
L_poll25:
    buffer_load_dword v17, v23, s[32:35], s93 offen offset:0 sc1
    s_waitcnt vmcnt(0)
    v_cmp_eq_u32 vcc, 0, v17
    s_nop 1
    s_cbranch_vccz L_done23
    s_sub_u32 s56, s56, 1
    s_cbranch_scc0 L_poll25
    s_mov_b32 s56, 0
    s_branch L_done23
L_redo31:
L_poll32:
    buffer_load_dword v17, v23, s[32:35], s93 offen offset:128 sc1
    s_waitcnt vmcnt(0)
    v_cmp_eq_u32 vcc, 0, v17
    s_nop 1
    s_cbranch_vccz L_done30
    s_sub_u32 s56, s56, 1
    s_cbranch_scc0 L_poll32
    s_mov_b32 s56, 0
    s_branch L_done30
L_redo38:
L_poll39:
    buffer_load_dword v19, v18, s[32:35], s57 offen offset:0 sc1
    s_waitcnt vmcnt(0)
    v_and_b32 v29, 63, v19
    v_cmp_ne_u32 vcc, 16, v29
    s_nop 1
    s_cbranch_vccz L_done37
    s_sub_u32 s56, s56, 1
    s_cbranch_scc0 L_poll39
    s_mov_b32 s56, 0
    s_branch L_done37
L_redo47:
L_poll48:
    buffer_load_dword v127, v126, s[32:35], s86 offen offset:2560 sc1
    s_waitcnt vmcnt(0)
    v_cmp_eq_u32 vcc, 0, v127
    s_nop 1
    s_cbranch_vccz L_done46
    s_sub_u32 s56, s56, 1
    s_cbranch_scc0 L_poll48
    s_mov_b32 s56, 0
    s_branch L_done46
L_redo60:
L_poll61:
    buffer_load_dword v29, v246, s[32:35], s2 offen offset:16 sc1
    s_waitcnt vmcnt(0)
    v_cmp_eq_u32 vcc, 0, v29
    s_nop 1
    s_cbranch_vccz L_done59
    s_sub_u32 s56, s56, 1
    s_cbranch_scc0 L_poll61
    s_mov_b32 s56, 0
    s_branch L_done59
L_redo70:
L_poll71:
    buffer_load_dword v17, v23, s[32:35], s93 offen offset:1024 sc1
    s_waitcnt vmcnt(0)
    v_cmp_eq_u32 vcc, 0, v17
    s_nop 1
    s_cbranch_vccz L_done69
    s_sub_u32 s56, s56, 1
    s_cbranch_scc0 L_poll71
    s_mov_b32 s56, 0
    s_branch L_done69
L_redo79:
L_poll80:
    buffer_load_dword v17, v23, s[32:35], s93 offen offset:1152 sc1
    s_waitcnt vmcnt(0)
    v_cmp_eq_u32 vcc, 0, v17
    s_nop 1
    s_cbranch_vccz L_done78
    s_sub_u32 s56, s56, 1
    s_cbranch_scc0 L_poll80
    s_mov_b32 s56, 0
    s_branch L_done78
L_idle1:
L_poll74:
    buffer_load_dword v30, v12, s[32:35], s85 offen offset:2048 sc1
    s_sub_u32 s56, s56, 1
    s_cselect_b64 s[76:77], 0, -1
    s_max_i32 s56, s56, 0
    s_waitcnt vmcnt(0)
    v_cmp_eq_u32 vcc, 0, v30
    s_and_b64 vcc, vcc, s[76:77]
    s_cbranch_scc1 L_poll74
    s_waitcnt lgkmcnt(0)
    s_barrier
    buffer_load_dwordx4 v[48:51], v1, s[32:35], s89 offen offset:0 sc1
    buffer_load_dwordx4 v[52:55], v1, s[32:35], s89 offen offset:1024 sc1
    buffer_load_dwordx4 v[56:59], v1, s[32:35], s89 offen offset:2048 sc1
    buffer_load_dwordx4 v[60:63], v1, s[32:35], s89 offen offset:3072 sc1
    s_add_u32 s57, s89, 4096
    buffer_load_dwordx4 v[64:67], v1, s[32:35], s57 offen offset:0 sc1
    buffer_load_dwordx4 v[68:71], v1, s[32:35], s57 offen offset:1024 sc1
    buffer_load_dwordx4 v[72:75], v1, s[32:35], s57 offen offset:2048 sc1
    buffer_load_dwordx4 v[76:79], v1, s[32:35], s57 offen offset:3072 sc1
    s_add_u32 m0, s70, 4096
    s_add_u32 s0, s67, 32768
    buffer_load_dwordx4 v6, s[24:27], s0 offen lds
    buffer_load_dwordx4 v10, s[24:27], s0 offen offset:1024 lds
    s_add_u32 m0, s70, 6144
    s_add_u32 s0, s67, 49152
    buffer_load_dwordx4 v6, s[24:27], s0 offen lds
    buffer_load_dwordx4 v10, s[24:27], s0 offen offset:1024 lds
    s_add_u32 m0, s70, 131072
    s_add_u32 s0, s67, 65536
    buffer_load_dwordx4 v6, s[24:27], s0 offen lds
    buffer_load_dwordx4 v10, s[24:27], s0 offen offset:1024 lds
    s_add_u32 m0, s70, 133120
    s_add_u32 s0, s67, 81920
    buffer_load_dwordx4 v6, s[24:27], s0 offen lds
    buffer_load_dwordx4 v10, s[24:27], s0 offen offset:1024 lds
    s_add_u32 m0, s70, 135168
    s_add_u32 s0, s67, 98304
    buffer_load_dwordx4 v6, s[24:27], s0 offen lds
    buffer_load_dwordx4 v10, s[24:27], s0 offen offset:1024 lds
    s_cmp_eq_u32 s50, 28
    s_cselect_b32 s58, 0, 117440512
    s_add_u32 s57, s58, s1
    s_add_u32 s58, s58, s2
    s_waitcnt vmcnt(15)
    v_pk_add_f32 v[48:49], v[48:49], v[56:57]
    v_pk_add_f32 v[50:51], v[50:51], v[58:59]
    s_waitcnt vmcnt(14)
    v_pk_add_f32 v[52:53], v[52:53], v[60:61]
    v_pk_add_f32 v[54:55], v[54:55], v[62:63]
    v_pk_add_f32 v[48:49], v[48:49], v[52:53]
    v_pk_add_f32 v[50:51], v[50:51], v[54:55]
    v_pk_add_f32 v[48:49], v[48:49], v[50:51]
    v_mov_b32 v50, v48
    v_mov_b32 v51, v49
    s_nop 0
    v_permlane32_swap_b32 v48, v50
    v_permlane32_swap_b32 v49, v51
    v_add_f32 v48, v48, v50
    v_add_f32 v49, v49, v51
    v_mul_f32 v51, 0x3b000000, v48
    v_mul_f32 v49, 0x3b000000, v49
    v_mul_f32 v48, 0xba800000, v48
    v_fma_f32 v50, -v51, v51, v49
    v_cvt_pk_bf16_f32 v51, v48, v48
    v_max_f32 v50, 0, v50
    v_and_b32 v51, 0xffff0000, v51
    v_add_f32 v50, 0x3727c5ac, v50
    v_sub_f32 v51, v48, v51
    v_rsq_f32 v49, v50
    v_cvt_pk_bf16_f32 v56, v48, v51
    v_mov_b32 v57, v56
    v_mov_b32 v58, 0
    v_mov_b32 v59, 0
    v_mul_f32 v53, v49, v49
    v_mul_f32 v52, 0xc0135761, v49
    v_mul_f32 v53, v53, v49
    v_mov_b32 v54, v50
    v_mov_b32 v55, v56
    v_mul_f32 v53, 0xbdd2d3e8, v53
    buffer_store_dwordx4 v[52:55], v1, s[32:35], s57 offen offset:0 sc1
    s_waitcnt vmcnt(12)
    v_pk_add_f32 v[64:65], v[64:65], v[72:73]
    v_pk_add_f32 v[66:67], v[66:67], v[74:75]
    s_waitcnt vmcnt(11)
    v_pk_add_f32 v[68:69], v[68:69], v[76:77]
    v_pk_add_f32 v[70:71], v[70:71], v[78:79]
    v_pk_add_f32 v[64:65], v[64:65], v[68:69]
    v_pk_add_f32 v[66:67], v[66:67], v[70:71]
    v_pk_add_f32 v[64:65], v[64:65], v[66:67]
    v_mov_b32 v66, v64
    v_mov_b32 v67, v65
    s_nop 0
    v_permlane32_swap_b32 v64, v66
    v_permlane32_swap_b32 v65, v67
    v_add_f32 v64, v64, v66
    v_add_f32_e64 v65, v65, v67
    v_mul_f32 v67, 0x3b000000, v64
    v_mul_f32 v65, 0x3b000000, v65
    v_mul_f32 v64, 0xba800000, v64
    v_fma_f32 v66, -v67, v67, v65
    v_cvt_pk_bf16_f32 v67, v64, v64
    v_max_f32 v66, 0, v66
    v_and_b32 v67, 0xffff0000, v67
    v_add_f32 v66, 0x3727c5ac, v66
    v_sub_f32 v67, v64, v67
    v_rsq_f32 v65, v66
    v_cvt_pk_bf16_f32 v72, v64, v67
    v_mov_b32 v73, v72
    v_mov_b32 v74, 0
    v_mov_b32 v75, 0
    v_mul_f32 v69, v65, v65
    v_mul_f32 v68, 0xc0135761, v65
    v_mul_f32 v69, v69, v65
    v_mov_b32 v70, v66
    v_mov_b32 v71, v72
    v_mul_f32 v69, 0xbdd2d3e8, v69
    buffer_store_dwordx4 v[68:71], v1, s[32:35], s57 offen offset:1024 sc1
    v_mov_b32 v30, 1
    s_waitcnt vmcnt(0)
    s_cmp_lg_u32 s55, 0
    s_cbranch_scc1 L_slow_f75
    buffer_store_dword v30, v28, s[32:35], s58 offen offset:16
L_ret_f75:
    s_add_u32 m0, s70, 32768
    s_add_u32 s0, s67, 229376
    buffer_load_dwordx4 v6, s[24:27], s0 offen lds
    buffer_load_dwordx4 v10, s[24:27], s0 offen offset:1024 lds
    s_add_u32 m0, s70, 34816
    s_add_u32 s0, s67, 245760
    buffer_load_dwordx4 v6, s[24:27], s0 offen lds
    buffer_load_dwordx4 v10, s[24:27], s0 offen offset:1024 lds
    s_add_u32 m0, s70, 36864
    s_add_u32 s0, s67, 262144
    buffer_load_dwordx4 v6, s[24:27], s0 offen lds
    buffer_load_dwordx4 v10, s[24:27], s0 offen offset:1024 lds
    s_add_u32 m0, s70, 38912
    s_add_u32 s0, s67, 278528
    buffer_load_dwordx4 v6, s[24:27], s0 offen lds
    buffer_load_dwordx4 v10, s[24:27], s0 offen offset:1024 lds
    s_add_u32 m0, s70, 98304
    s_add_u32 s0, s67, 294912
    buffer_load_dwordx4 v6, s[24:27], s0 offen lds
    buffer_load_dwordx4 v10, s[24:27], s0 offen offset:1024 lds
    s_add_u32 m0, s70, 100352
    s_add_u32 s0, s67, 311296
    buffer_load_dwordx4 v6, s[24:27], s0 offen lds
    buffer_load_dwordx4 v10, s[24:27], s0 offen offset:1024 lds
    s_add_u32 m0, s70, 102400
    s_add_u32 s0, s67, 327680
    buffer_load_dwordx4 v6, s[24:27], s0 offen lds
    buffer_load_dwordx4 v10, s[24:27], s0 offen offset:1024 lds
    s_add_u32 m0, s70, 104448
    s_add_u32 s0, s67, 344064
    buffer_load_dwordx4 v6, s[24:27], s0 offen lds
    buffer_load_dwordx4 v10, s[24:27], s0 offen offset:1024 lds
    s_add_u32 m0, s70, 65536
    s_add_u32 s0, s67, 360448
    buffer_load_dwordx4 v6, s[24:27], s0 offen lds
    buffer_load_dwordx4 v10, s[24:27], s0 offen offset:1024 lds
    s_add_u32 m0, s70, 67584
    s_add_u32 s0, s67, 376832
    buffer_load_dwordx4 v6, s[24:27], s0 offen lds
    buffer_load_dwordx4 v10, s[24:27], s0 offen offset:1024 lds
    s_add_u32 m0, s70, 69632
    s_add_u32 s0, s67, 393216
    buffer_load_dwordx4 v6, s[24:27], s0 offen lds
    buffer_load_dwordx4 v10, s[24:27], s0 offen offset:1024 lds
    s_add_u32 m0, s70, 71680
    s_add_u32 s0, s67, 409600
    buffer_load_dwordx4 v6, s[24:27], s0 offen lds
    buffer_load_dwordx4 v10, s[24:27], s0 offen offset:1024 lds
    v_lshlrev_b32 v29, 7, v9
    v_add_u32 v29, s70, v29
    v_add_u32 v29, L_tail_1-interleave_layers__linear_kernel_hedgehog__geglu_ffn__prompt_kernel, v29
    v_min_u32 v29, L_last-interleave_layers__linear_kernel_hedgehog__geglu_ffn__prompt_kernel, v29
    global_load_dword v60, v29, s[8:9]
    ds_read_b64_tr_b16 a[0:1], v18 offset:0
    ds_read_b64_tr_b16 a[2:3], v18 offset:512
    ds_read_b64_tr_b16 a[4:5], v19 offset:0
    ds_read_b64_tr_b16 a[6:7], v19 offset:512
    s_waitcnt lgkmcnt(0)
    s_add_u32 m0, s70, 0
    s_add_u32 s0, s67, 114688
    buffer_load_dwordx4 v6, s[24:27], s0 offen lds
    buffer_load_dwordx4 v10, s[24:27], s0 offen offset:1024 lds
    ds_read_b64_tr_b16 a[8:9], v18 offset:2048
    ds_read_b64_tr_b16 a[10:11], v18 offset:2560
    ds_read_b64_tr_b16 a[12:13], v19 offset:2048
    ds_read_b64_tr_b16 a[14:15], v19 offset:2560
    s_waitcnt lgkmcnt(0)
    s_add_u32 m0, s70, 2048
    s_add_u32 s0, s67, 131072
    buffer_load_dwordx4 v6, s[24:27], s0 offen lds
    buffer_load_dwordx4 v10, s[24:27], s0 offen offset:1024 lds
    ds_read_b64_tr_b16 a[16:17], v18 offset:4096
    ds_read_b64_tr_b16 a[18:19], v18 offset:4608
    ds_read_b64_tr_b16 a[20:21], v19 offset:4096
    ds_read_b64_tr_b16 a[22:23], v19 offset:4608
    s_waitcnt lgkmcnt(0)
    s_add_u32 m0, s70, 4096
    s_add_u32 s0, s67, 147456
    buffer_load_dwordx4 v6, s[24:27], s0 offen lds
    buffer_load_dwordx4 v10, s[24:27], s0 offen offset:1024 lds
    ds_read_b64_tr_b16 a[24:25], v18 offset:6144
    ds_read_b64_tr_b16 a[26:27], v18 offset:6656
    ds_read_b64_tr_b16 a[28:29], v19 offset:6144
    ds_read_b64_tr_b16 a[30:31], v19 offset:6656
    s_waitcnt lgkmcnt(0)
    s_add_u32 m0, s70, 6144
    s_add_u32 s0, s67, 163840
    buffer_load_dwordx4 v6, s[24:27], s0 offen lds
    buffer_load_dwordx4 v10, s[24:27], s0 offen offset:1024 lds
    ds_read_b64_tr_b16 a[32:33], v20 offset:0
    ds_read_b64_tr_b16 a[34:35], v20 offset:512
    ds_read_b64_tr_b16 a[36:37], v21 offset:0
    ds_read_b64_tr_b16 a[38:39], v21 offset:512
    s_waitcnt lgkmcnt(0)
    s_add_u32 m0, s70, 131072
    s_add_u32 s0, s67, 180224
    buffer_load_dwordx4 v6, s[24:27], s0 offen lds
    buffer_load_dwordx4 v10, s[24:27], s0 offen offset:1024 lds
    ds_read_b64_tr_b16 a[40:41], v20 offset:2048
    ds_read_b64_tr_b16 a[42:43], v20 offset:2560
    ds_read_b64_tr_b16 a[44:45], v21 offset:2048
    ds_read_b64_tr_b16 a[46:47], v21 offset:2560
    s_waitcnt lgkmcnt(0)
    s_add_u32 m0, s70, 133120
    s_add_u32 s0, s67, 196608
    buffer_load_dwordx4 v6, s[24:27], s0 offen lds
    buffer_load_dwordx4 v10, s[24:27], s0 offen offset:1024 lds
    ds_read_b64_tr_b16 a[48:49], v20 offset:4096
    ds_read_b64_tr_b16 a[50:51], v20 offset:4608
    ds_read_b64_tr_b16 a[52:53], v21 offset:4096
    ds_read_b64_tr_b16 a[54:55], v21 offset:4608
    s_waitcnt lgkmcnt(0)
    s_add_u32 m0, s70, 135168
    s_add_u32 s0, s67, 212992
    buffer_load_dwordx4 v6, s[24:27], s0 offen lds
    buffer_load_dwordx4 v10, s[24:27], s0 offen offset:1024 lds
    v_lshlrev_b32 v29, 7, v9
    s_lshl2_add_u32 s57, s54, s48
    s_mul_i32 s57, s57, 57344
    s_mul_i32 s58, s49, 917504
    s_add_u32 s57, s57, s58
    s_add_u32 s57, s57, 11534336
    s_waitcnt vmcnt(12)
    ds_read_b64_tr_b16 a[56:57], v18 offset:0
    ds_read_b64_tr_b16 a[58:59], v18 offset:512
    ds_read_b64_tr_b16 a[60:61], v19 offset:0
    ds_read_b64_tr_b16 a[62:63], v19 offset:512
    s_waitcnt lgkmcnt(0)
    s_add_u32 m0, s70, 0
    s_add_u32 s0, s67, 425984
    buffer_load_dwordx4 v6, s[24:27], s0 offen lds
    buffer_load_dwordx4 v10, s[24:27], s0 offen offset:1024 lds
    s_waitcnt vmcnt(12)
    ds_read_b64_tr_b16 a[64:65], v18 offset:2048
    ds_read_b64_tr_b16 a[66:67], v18 offset:2560
    ds_read_b64_tr_b16 a[68:69], v19 offset:2048
    ds_read_b64_tr_b16 a[70:71], v19 offset:2560
    s_waitcnt lgkmcnt(0)
    s_add_u32 m0, s70, 2048
    s_add_u32 s0, s67, 442368
    buffer_load_dwordx4 v6, s[24:27], s0 offen lds
    buffer_load_dwordx4 v10, s[24:27], s0 offen offset:1024 lds
    s_waitcnt vmcnt(12)
    ds_read_b64_tr_b16 a[72:73], v18 offset:4096
    ds_read_b64_tr_b16 a[74:75], v18 offset:4608
    ds_read_b64_tr_b16 a[76:77], v19 offset:4096
    ds_read_b64_tr_b16 a[78:79], v19 offset:4608
    buffer_load_dword v48, v29, s[32:35], s57 offen sc1
    s_add_u32 s57, s57, 8192
    buffer_load_dword v49, v29, s[32:35], s57 offen sc1
    s_add_u32 s57, s57, 8192
    buffer_load_dword v50, v29, s[32:35], s57 offen sc1
    s_add_u32 s57, s57, 8192
    buffer_load_dword v51, v29, s[32:35], s57 offen sc1
    s_add_u32 s57, s57, 8192
    buffer_load_dword v52, v29, s[32:35], s57 offen sc1
    s_add_u32 s57, s57, 8192
    buffer_load_dword v53, v29, s[32:35], s57 offen sc1
    s_add_u32 s57, s57, 8192
    buffer_load_dword v54, v29, s[32:35], s57 offen sc1
    s_add_u32 s57, s57, 8192
L_poll76:
    buffer_load_dword v30, v23, s[32:35], s93 offen offset:1024 sc1
    s_sub_u32 s56, s56, 1
    s_cselect_b64 s[76:77], 0, -1
    s_max_i32 s56, s56, 0
    s_waitcnt vmcnt(0)
    v_cmp_eq_u32 vcc, 0, v30
    s_and_b64 vcc, vcc, s[76:77]
    s_cbranch_scc1 L_poll76
    s_add_u32 s58, s94, 0
    buffer_load_dwordx4 v[48:51], v1, s[32:35], s58 offen offset:0 sc1
    buffer_load_dwordx4 v[52:55], v1, s[32:35], s58 offen offset:1024 sc1
    buffer_load_dwordx4 v[56:59], v1, s[32:35], s58 offen offset:2048 sc1
    buffer_load_dwordx4 v[60:63], v1, s[32:35], s58 offen offset:3072 sc1
    s_add_u32 s58, s94, 4096
    buffer_load_dwordx4 v[64:67], v1, s[32:35], s58 offen offset:0 sc1
    buffer_load_dwordx4 v[68:71], v1, s[32:35], s58 offen offset:1024 sc1
    buffer_load_dwordx4 v[72:75], v1, s[32:35], s58 offen offset:2048 sc1
    buffer_load_dwordx4 v[76:79], v1, s[32:35], s58 offen offset:3072 sc1
    s_waitcnt vmcnt(0) lgkmcnt(0)
    s_branch L_k4_1
L_idle0:
L_poll26:
    buffer_load_dword v30, v12, s[32:35], s85 offen offset:1536 sc1
    s_sub_u32 s56, s56, 1
    s_cselect_b64 s[76:77], 0, -1
    s_max_i32 s56, s56, 0
    s_waitcnt vmcnt(0)
    v_cmp_eq_u32 vcc, 0, v30
    s_and_b64 vcc, vcc, s[76:77]
    s_cbranch_scc1 L_poll26
    s_waitcnt lgkmcnt(0)
    s_barrier
    buffer_load_dwordx4 v[48:51], v1, s[32:35], s89 offen offset:0 sc1
    buffer_load_dwordx4 v[52:55], v1, s[32:35], s89 offen offset:1024 sc1
    buffer_load_dwordx4 v[56:59], v1, s[32:35], s89 offen offset:2048 sc1
    buffer_load_dwordx4 v[60:63], v1, s[32:35], s89 offen offset:3072 sc1
    s_add_u32 s57, s89, 4096
    buffer_load_dwordx4 v[64:67], v1, s[32:35], s57 offen offset:0 sc1
    buffer_load_dwordx4 v[68:71], v1, s[32:35], s57 offen offset:1024 sc1
    buffer_load_dwordx4 v[72:75], v1, s[32:35], s57 offen offset:2048 sc1
    buffer_load_dwordx4 v[76:79], v1, s[32:35], s57 offen offset:3072 sc1
    s_add_u32 m0, s70, 4096
    s_add_u32 s0, s67, 32768
    buffer_load_dwordx4 v6, s[24:27], s0 offen lds
    buffer_load_dwordx4 v10, s[24:27], s0 offen offset:1024 lds
    s_add_u32 m0, s70, 6144
    s_add_u32 s0, s67, 49152
    buffer_load_dwordx4 v6, s[24:27], s0 offen lds
    buffer_load_dwordx4 v10, s[24:27], s0 offen offset:1024 lds
    s_add_u32 m0, s70, 131072
    s_add_u32 s0, s67, 65536
    buffer_load_dwordx4 v6, s[24:27], s0 offen lds
    buffer_load_dwordx4 v10, s[24:27], s0 offen offset:1024 lds
    s_add_u32 m0, s70, 133120
    s_add_u32 s0, s67, 81920
    buffer_load_dwordx4 v6, s[24:27], s0 offen lds
    buffer_load_dwordx4 v10, s[24:27], s0 offen offset:1024 lds
    s_add_u32 m0, s70, 135168
    s_add_u32 s0, s67, 98304
    buffer_load_dwordx4 v6, s[24:27], s0 offen lds
    buffer_load_dwordx4 v10, s[24:27], s0 offen offset:1024 lds
    s_cmp_eq_u32 s50, 28
    s_cselect_b32 s58, 0, 117440512
    s_add_u32 s57, s58, s1
    s_add_u32 s58, s58, s2
    s_waitcnt vmcnt(15)
    v_pk_add_f32 v[48:49], v[48:49], v[56:57]
    v_pk_add_f32 v[50:51], v[50:51], v[58:59]
    s_waitcnt vmcnt(14)
    v_pk_add_f32 v[52:53], v[52:53], v[60:61]
    v_pk_add_f32 v[54:55], v[54:55], v[62:63]
    v_pk_add_f32 v[48:49], v[48:49], v[52:53]
    v_pk_add_f32 v[50:51], v[50:51], v[54:55]
    v_pk_add_f32 v[48:49], v[48:49], v[50:51]
    v_mov_b32 v50, v48
    v_mov_b32 v51, v49
    s_nop 0
    v_permlane32_swap_b32 v48, v50
    v_permlane32_swap_b32 v49, v51
    v_add_f32 v48, v48, v50
    v_add_f32 v49, v49, v51
    v_mul_f32 v51, 0x3b000000, v48
    v_mul_f32 v49, 0x3b000000, v49
    v_mul_f32 v48, 0xba800000, v48
    v_fma_f32 v50, -v51, v51, v49
    v_cvt_pk_bf16_f32 v51, v48, v48
    v_max_f32 v50, 0, v50
    v_and_b32 v51, 0xffff0000, v51
    v_add_f32 v50, 0x3727c5ac, v50
    v_sub_f32 v51, v48, v51
    v_rsq_f32 v49, v50
    v_cvt_pk_bf16_f32 v56, v48, v51
    v_mov_b32 v57, v56
    v_mov_b32 v58, 0
    v_mov_b32 v59, 0
    v_mul_f32 v53, v49, v49
    v_mul_f32 v52, 0xc0135761, v49
    v_mul_f32 v53, v53, v49
    v_mov_b32 v54, v50
    v_mov_b32 v55, v56
    v_mul_f32 v53, 0xbdd2d3e8, v53
    buffer_store_dwordx4 v[52:55], v1, s[32:35], s57 offen offset:0 sc1
    s_waitcnt vmcnt(12)
    v_pk_add_f32 v[64:65], v[64:65], v[72:73]
    v_pk_add_f32 v[66:67], v[66:67], v[74:75]
    s_waitcnt vmcnt(11)
    v_pk_add_f32 v[68:69], v[68:69], v[76:77]
    v_pk_add_f32 v[70:71], v[70:71], v[78:79]
    v_pk_add_f32 v[64:65], v[64:65], v[68:69]
    v_pk_add_f32 v[66:67], v[66:67], v[70:71]
    v_pk_add_f32 v[64:65], v[64:65], v[66:67]
    v_mov_b32 v66, v64
    v_mov_b32 v67, v65
    s_nop 0
    v_permlane32_swap_b32 v64, v66
    v_permlane32_swap_b32 v65, v67
    v_add_f32 v64, v64, v66
    v_add_f32_e64 v65, v65, v67
    v_mul_f32 v67, 0x3b000000, v64
    v_mul_f32 v65, 0x3b000000, v65
    v_mul_f32 v64, 0xba800000, v64
    v_fma_f32 v66, -v67, v67, v65
    v_cvt_pk_bf16_f32 v67, v64, v64
    v_max_f32 v66, 0, v66
    v_and_b32 v67, 0xffff0000, v67
    v_add_f32 v66, 0x3727c5ac, v66
    v_sub_f32 v67, v64, v67
    v_rsq_f32 v65, v66
    v_cvt_pk_bf16_f32 v72, v64, v67
    v_mov_b32 v73, v72
    v_mov_b32 v74, 0
    v_mov_b32 v75, 0
    v_mul_f32 v69, v65, v65
    v_mul_f32 v68, 0xc0135761, v65
    v_mul_f32 v69, v69, v65
    v_mov_b32 v70, v66
    v_mov_b32 v71, v72
    v_mul_f32 v69, 0xbdd2d3e8, v69
    buffer_store_dwordx4 v[68:71], v1, s[32:35], s57 offen offset:1024 sc1
    v_mov_b32 v30, 1
    s_waitcnt vmcnt(0)
    s_cmp_lg_u32 s55, 0
    s_cbranch_scc1 L_slow_f27
    buffer_store_dword v30, v28, s[32:35], s58 offen offset:0
L_ret_f27:
    s_lshl_b32 s58, s48, 5
    v_xor_b32 v14, s58, v4
    v_add_u32 v13, 65536, v14
    v_mov_b32 v80, 0x3f803f80
    v_mov_b32 v81, 0x3f803f80
    v_mov_b32 v82, 0x3f803f80
    v_mov_b32 v83, 0x3f803f80
    s_add_u32 m0, s69, 49152
    s_add_u32 s0, s66, 688128
    buffer_load_dwordx4 v7, s[16:19], s0 offen lds
    buffer_load_dwordx4 v11, s[20:23], s0 offen offset:1024 lds
    s_add_u32 m0, s69, 57344
    s_add_u32 s0, s66, 802816
    buffer_load_dwordx4 v7, s[16:19], s0 offen lds
    buffer_load_dwordx4 v11, s[20:23], s0 offen offset:1024 lds
    s_add_u32 m0, s69, 98304
    s_add_u32 s0, s66, 917504
    buffer_load_dwordx4 v7, s[16:19], s0 offen lds
    buffer_load_dwordx4 v11, s[20:23], s0 offen offset:1024 lds
    s_add_u32 m0, s69, 106496
    s_add_u32 s0, s66, 1032192
    buffer_load_dwordx4 v7, s[16:19], s0 offen lds
    buffer_load_dwordx4 v11, s[20:23], s0 offen offset:1024 lds
    s_add_u32 m0, s69, 114688
    s_add_u32 s0, s66, 1146880
    buffer_load_dwordx4 v7, s[16:19], s0 offen lds
    buffer_load_dwordx4 v11, s[20:23], s0 offen offset:1024 lds
    s_add_u32 m0, s69, 122880
    s_add_u32 s0, s66, 1261568
    buffer_load_dwordx4 v7, s[16:19], s0 offen lds
    buffer_load_dwordx4 v11, s[20:23], s0 offen offset:1024 lds
    ds_read_b64_tr_b16 v[96:97], v13 offset:0
    ds_read_b64_tr_b16 v[98:99], v13 offset:512
    ds_read_b64_tr_b16 v[100:101], v13 offset:4096
    ds_read_b64_tr_b16 v[102:103], v13 offset:4608
    ds_read_b64_tr_b16 v[104:105], v13 offset:8192
    ds_read_b64_tr_b16 v[106:107], v13 offset:8704
    ds_read_b64_tr_b16 v[108:109], v13 offset:12288
    ds_read_b64_tr_b16 v[110:111], v13 offset:12800
    s_waitcnt lgkmcnt(6)
    v_mfma_f32_32x32x16_bf16 v[48:63], v[80:83], v[96:99], 0
    ds_read_b64_tr_b16 v[112:113], v13 offset:16384
    ds_read_b64_tr_b16 v[114:115], v13 offset:16896
    s_waitcnt lgkmcnt(6)
    v_mfma_f32_32x32x16_bf16 v[48:63], v[80:83], v[100:103], v[48:63]
    ds_read_b64_tr_b16 v[116:117], v13 offset:20480
    ds_read_b64_tr_b16 v[118:119], v13 offset:20992
    s_waitcnt lgkmcnt(6)
    v_mfma_f32_32x32x16_bf16 v[48:63], v[80:83], v[104:107], v[48:63]
    ds_read_b64_tr_b16 v[120:121], v13 offset:24576
    ds_read_b64_tr_b16 v[122:123], v13 offset:25088
    s_waitcnt lgkmcnt(6)
    v_mfma_f32_32x32x16_bf16 v[48:63], v[80:83], v[108:111], v[48:63]
    ds_read_b64_tr_b16 v[124:125], v13 offset:28672
    ds_read_b64_tr_b16 v[126:127], v13 offset:29184
    s_waitcnt lgkmcnt(6)
    v_mfma_f32_32x32x16_bf16 v[48:63], v[80:83], v[112:115], v[48:63]
    s_waitcnt lgkmcnt(4)
    v_mfma_f32_32x32x16_bf16 v[48:63], v[80:83], v[116:119], v[48:63]
    s_waitcnt lgkmcnt(2)
    v_mfma_f32_32x32x16_bf16 v[48:63], v[80:83], v[120:123], v[48:63]
    s_waitcnt lgkmcnt(0)
    v_mfma_f32_32x32x16_bf16 v[48:63], v[80:83], v[124:127], v[48:63]
    s_barrier
    s_add_u32 m0, s69, 65536
    s_add_u32 s0, s66, 1376256
    buffer_load_dwordx4 v7, s[16:19], s0 offen lds
    buffer_load_dwordx4 v11, s[20:23], s0 offen offset:1024 lds
    s_add_u32 m0, s69, 73728
    s_add_u32 s0, s66, 1490944
    buffer_load_dwordx4 v7, s[16:19], s0 offen lds
    buffer_load_dwordx4 v11, s[20:23], s0 offen offset:1024 lds
    s_add_u32 m0, s69, 81920
    s_add_u32 s0, s66, 1605632
    buffer_load_dwordx4 v7, s[16:19], s0 offen lds
    buffer_load_dwordx4 v11, s[20:23], s0 offen offset:1024 lds
    s_add_u32 m0, s69, 90112
    s_add_u32 s0, s66, 1720320
    buffer_load_dwordx4 v7, s[16:19], s0 offen lds
    buffer_load_dwordx4 v11, s[20:23], s0 offen offset:1024 lds
    s_waitcnt vmcnt(0)
    s_barrier
    s_nop 0
    ds_read_b64_tr_b16 v[96:97], v14 offset:32768
    ds_read_b64_tr_b16 v[98:99], v14 offset:33280
    ds_read_b64_tr_b16 v[100:101], v14 offset:36864
    ds_read_b64_tr_b16 v[102:103], v14 offset:37376
    ds_read_b64_tr_b16 v[104:105], v14 offset:40960
    ds_read_b64_tr_b16 v[106:107], v14 offset:41472
    ds_read_b64_tr_b16 v[108:109], v14 offset:45056
    ds_read_b64_tr_b16 v[110:111], v14 offset:45568
    s_waitcnt lgkmcnt(6)
    v_mfma_f32_32x32x16_bf16 v[48:63], v[80:83], v[96:99], v[48:63]
    ds_read_b64_tr_b16 v[112:113], v14 offset:49152
    ds_read_b64_tr_b16 v[114:115], v14 offset:49664
    s_waitcnt lgkmcnt(6)
    v_mfma_f32_32x32x16_bf16 v[48:63], v[80:83], v[100:103], v[48:63]
    ds_read_b64_tr_b16 v[116:117], v14 offset:53248
    ds_read_b64_tr_b16 v[118:119], v14 offset:53760
    s_waitcnt lgkmcnt(6)
    v_mfma_f32_32x32x16_bf16 v[48:63], v[80:83], v[104:107], v[48:63]
    ds_read_b64_tr_b16 v[120:121], v14 offset:57344
    ds_read_b64_tr_b16 v[122:123], v14 offset:57856
    s_waitcnt lgkmcnt(6)
    v_mfma_f32_32x32x16_bf16 v[48:63], v[80:83], v[108:111], v[48:63]
    ds_read_b64_tr_b16 v[124:125], v14 offset:61440
    ds_read_b64_tr_b16 v[126:127], v14 offset:61952
    s_waitcnt lgkmcnt(6)
    v_mfma_f32_32x32x16_bf16 v[48:63], v[80:83], v[112:115], v[48:63]
    ds_read_b64_tr_b16 v[96:97], v13 offset:32768
    ds_read_b64_tr_b16 v[98:99], v13 offset:33280
    s_waitcnt lgkmcnt(6)
    v_mfma_f32_32x32x16_bf16 v[48:63], v[80:83], v[116:119], v[48:63]
    ds_read_b64_tr_b16 v[100:101], v13 offset:36864
    ds_read_b64_tr_b16 v[102:103], v13 offset:37376
    s_waitcnt lgkmcnt(6)
    v_mfma_f32_32x32x16_bf16 v[48:63], v[80:83], v[120:123], v[48:63]
    ds_read_b64_tr_b16 v[104:105], v13 offset:40960
    ds_read_b64_tr_b16 v[106:107], v13 offset:41472
    s_waitcnt lgkmcnt(6)
    v_mfma_f32_32x32x16_bf16 v[48:63], v[80:83], v[124:127], v[48:63]
    ds_read_b64_tr_b16 v[108:109], v13 offset:45056
    ds_read_b64_tr_b16 v[110:111], v13 offset:45568
    s_waitcnt lgkmcnt(6)
    v_mfma_f32_32x32x16_bf16 v[48:63], v[80:83], v[96:99], v[48:63]
    ds_read_b64_tr_b16 v[112:113], v13 offset:49152
    ds_read_b64_tr_b16 v[114:115], v13 offset:49664
    s_waitcnt lgkmcnt(6)
    v_mfma_f32_32x32x16_bf16 v[48:63], v[80:83], v[100:103], v[48:63]
    ds_read_b64_tr_b16 v[116:117], v13 offset:53248
    ds_read_b64_tr_b16 v[118:119], v13 offset:53760
    s_waitcnt lgkmcnt(6)
    v_mfma_f32_32x32x16_bf16 v[48:63], v[80:83], v[104:107], v[48:63]
    ds_read_b64_tr_b16 v[120:121], v13 offset:57344
    ds_read_b64_tr_b16 v[122:123], v13 offset:57856
    s_waitcnt lgkmcnt(6)
    v_mfma_f32_32x32x16_bf16 v[48:63], v[80:83], v[108:111], v[48:63]
    ds_read_b64_tr_b16 v[124:125], v13 offset:61440
    ds_read_b64_tr_b16 v[126:127], v13 offset:61952
    s_waitcnt lgkmcnt(6)
    v_mfma_f32_32x32x16_bf16 v[48:63], v[80:83], v[112:115], v[48:63]
    ds_read_b64_tr_b16 v[96:97], v13 offset:0
    ds_read_b64_tr_b16 v[98:99], v13 offset:512
    s_waitcnt lgkmcnt(6)
    v_mfma_f32_32x32x16_bf16 v[48:63], v[80:83], v[116:119], v[48:63]
    ds_read_b64_tr_b16 v[100:101], v13 offset:4096
    ds_read_b64_tr_b16 v[102:103], v13 offset:4608
    s_waitcnt lgkmcnt(6)
    v_mfma_f32_32x32x16_bf16 v[48:63], v[80:83], v[120:123], v[48:63]
    ds_read_b64_tr_b16 v[104:105], v13 offset:8192
    ds_read_b64_tr_b16 v[106:107], v13 offset:8704
    s_waitcnt lgkmcnt(6)
    v_mfma_f32_32x32x16_bf16 v[48:63], v[80:83], v[124:127], v[48:63]
    ds_read_b64_tr_b16 v[108:109], v13 offset:12288
    ds_read_b64_tr_b16 v[110:111], v13 offset:12800
    s_waitcnt lgkmcnt(6)
    v_mfma_f32_32x32x16_bf16 v[48:63], v[80:83], v[96:99], v[48:63]
    ds_read_b64_tr_b16 v[112:113], v13 offset:16384
    ds_read_b64_tr_b16 v[114:115], v13 offset:16896
    s_waitcnt lgkmcnt(6)
    v_mfma_f32_32x32x16_bf16 v[48:63], v[80:83], v[100:103], v[48:63]
    ds_read_b64_tr_b16 v[116:117], v13 offset:20480
    ds_read_b64_tr_b16 v[118:119], v13 offset:20992
    s_waitcnt lgkmcnt(6)
    v_mfma_f32_32x32x16_bf16 v[48:63], v[80:83], v[104:107], v[48:63]
    ds_read_b64_tr_b16 v[120:121], v13 offset:24576
    ds_read_b64_tr_b16 v[122:123], v13 offset:25088
    s_waitcnt lgkmcnt(6)
    v_mfma_f32_32x32x16_bf16 v[48:63], v[80:83], v[108:111], v[48:63]
    ds_read_b64_tr_b16 v[124:125], v13 offset:28672
    ds_read_b64_tr_b16 v[126:127], v13 offset:29184
    s_waitcnt lgkmcnt(6)
    v_mfma_f32_32x32x16_bf16 v[48:63], v[80:83], v[112:115], v[48:63]
    s_waitcnt lgkmcnt(4)
    v_mfma_f32_32x32x16_bf16 v[48:63], v[80:83], v[116:119], v[48:63]
    s_waitcnt lgkmcnt(2)
    v_mfma_f32_32x32x16_bf16 v[48:63], v[80:83], v[120:123], v[48:63]
    s_waitcnt lgkmcnt(0)
    v_mfma_f32_32x32x16_bf16 v[48:63], v[80:83], v[124:127], v[48:63]
    s_barrier
    s_cmp_lt_u32 s53, 28
    s_cselect_b32 s58, s47, 117440512
    s_lshl2_add_u32 s58, s48, s58
    v_lshrrev_b32 v29, 5, v9
    v_lshl_add_u32 v29, v29, 28, v1
    s_mov_b32 s18, 0
    s_mov_b32 s22, 0
    s_nop 3
    v_or_b32 v48, 1, v48
    buffer_store_dword v48, v29, s[32:35], s58 offen sc1
    s_add_u32 m0, s70, 32768
    s_add_u32 s0, s67, 229376
    buffer_load_dwordx4 v6, s[24:27], s0 offen lds
    buffer_load_dwordx4 v10, s[24:27], s0 offen offset:1024 lds
    s_add_u32 m0, s70, 34816
    s_add_u32 s0, s67, 245760
    buffer_load_dwordx4 v6, s[24:27], s0 offen lds
    buffer_load_dwordx4 v10, s[24:27], s0 offen offset:1024 lds
    s_add_u32 m0, s70, 36864
    s_add_u32 s0, s67, 262144
    buffer_load_dwordx4 v6, s[24:27], s0 offen lds
    buffer_load_dwordx4 v10, s[24:27], s0 offen offset:1024 lds
    s_add_u32 m0, s70, 38912
    s_add_u32 s0, s67, 278528
    buffer_load_dwordx4 v6, s[24:27], s0 offen lds
    buffer_load_dwordx4 v10, s[24:27], s0 offen offset:1024 lds
    s_add_u32 m0, s70, 98304
    s_add_u32 s0, s67, 294912
    buffer_load_dwordx4 v6, s[24:27], s0 offen lds
    buffer_load_dwordx4 v10, s[24:27], s0 offen offset:1024 lds
    s_add_u32 m0, s70, 100352
    s_add_u32 s0, s67, 311296
    buffer_load_dwordx4 v6, s[24:27], s0 offen lds
    buffer_load_dwordx4 v10, s[24:27], s0 offen offset:1024 lds
    s_add_u32 m0, s70, 102400
    s_add_u32 s0, s67, 327680
    buffer_load_dwordx4 v6, s[24:27], s0 offen lds
    buffer_load_dwordx4 v10, s[24:27], s0 offen offset:1024 lds
    s_add_u32 m0, s70, 104448
    s_add_u32 s0, s67, 344064
    buffer_load_dwordx4 v6, s[24:27], s0 offen lds
    buffer_load_dwordx4 v10, s[24:27], s0 offen offset:1024 lds
    s_add_u32 m0, s70, 65536
    s_add_u32 s0, s67, 360448
    buffer_load_dwordx4 v6, s[24:27], s0 offen lds
    buffer_load_dwordx4 v10, s[24:27], s0 offen offset:1024 lds
    s_add_u32 m0, s70, 67584
    s_add_u32 s0, s67, 376832
    buffer_load_dwordx4 v6, s[24:27], s0 offen lds
    buffer_load_dwordx4 v10, s[24:27], s0 offen offset:1024 lds
    s_add_u32 m0, s70, 69632
    s_add_u32 s0, s67, 393216
    buffer_load_dwordx4 v6, s[24:27], s0 offen lds
    buffer_load_dwordx4 v10, s[24:27], s0 offen offset:1024 lds
    s_add_u32 m0, s70, 71680
    s_add_u32 s0, s67, 409600
    buffer_load_dwordx4 v6, s[24:27], s0 offen lds
    buffer_load_dwordx4 v10, s[24:27], s0 offen offset:1024 lds
    v_lshlrev_b32 v29, 7, v9
    v_add_u32 v29, s70, v29
    v_add_u32 v29, L_tail_0-interleave_layers__linear_kernel_hedgehog__geglu_ffn__prompt_kernel, v29
    v_min_u32 v29, L_last-interleave_layers__linear_kernel_hedgehog__geglu_ffn__prompt_kernel, v29
    global_load_dword v60, v29, s[8:9]
    ds_read_b64_tr_b16 a[0:1], v18 offset:0
    ds_read_b64_tr_b16 a[2:3], v18 offset:512
    ds_read_b64_tr_b16 a[4:5], v19 offset:0
    ds_read_b64_tr_b16 a[6:7], v19 offset:512
    s_waitcnt lgkmcnt(0)
    s_add_u32 m0, s70, 0
    s_add_u32 s0, s67, 114688
    buffer_load_dwordx4 v6, s[24:27], s0 offen lds
    buffer_load_dwordx4 v10, s[24:27], s0 offen offset:1024 lds
    ds_read_b64_tr_b16 a[8:9], v18 offset:2048
    ds_read_b64_tr_b16 a[10:11], v18 offset:2560
    ds_read_b64_tr_b16 a[12:13], v19 offset:2048
    ds_read_b64_tr_b16 a[14:15], v19 offset:2560
    s_waitcnt lgkmcnt(0)
    s_add_u32 m0, s70, 2048
    s_add_u32 s0, s67, 131072
    buffer_load_dwordx4 v6, s[24:27], s0 offen lds
    buffer_load_dwordx4 v10, s[24:27], s0 offen offset:1024 lds
    ds_read_b64_tr_b16 a[16:17], v18 offset:4096
    ds_read_b64_tr_b16 a[18:19], v18 offset:4608
    ds_read_b64_tr_b16 a[20:21], v19 offset:4096
    ds_read_b64_tr_b16 a[22:23], v19 offset:4608
    s_waitcnt lgkmcnt(0)
    s_add_u32 m0, s70, 4096
    s_add_u32 s0, s67, 147456
    buffer_load_dwordx4 v6, s[24:27], s0 offen lds
    buffer_load_dwordx4 v10, s[24:27], s0 offen offset:1024 lds
    ds_read_b64_tr_b16 a[24:25], v18 offset:6144
    ds_read_b64_tr_b16 a[26:27], v18 offset:6656
    ds_read_b64_tr_b16 a[28:29], v19 offset:6144
    ds_read_b64_tr_b16 a[30:31], v19 offset:6656
    s_waitcnt lgkmcnt(0)
    s_add_u32 m0, s70, 6144
    s_add_u32 s0, s67, 163840
    buffer_load_dwordx4 v6, s[24:27], s0 offen lds
    buffer_load_dwordx4 v10, s[24:27], s0 offen offset:1024 lds
    ds_read_b64_tr_b16 a[32:33], v20 offset:0
    ds_read_b64_tr_b16 a[34:35], v20 offset:512
    ds_read_b64_tr_b16 a[36:37], v21 offset:0
    ds_read_b64_tr_b16 a[38:39], v21 offset:512
    s_waitcnt lgkmcnt(0)
    s_add_u32 m0, s70, 131072
    s_add_u32 s0, s67, 180224
    buffer_load_dwordx4 v6, s[24:27], s0 offen lds
    buffer_load_dwordx4 v10, s[24:27], s0 offen offset:1024 lds
    ds_read_b64_tr_b16 a[40:41], v20 offset:2048
    ds_read_b64_tr_b16 a[42:43], v20 offset:2560
    ds_read_b64_tr_b16 a[44:45], v21 offset:2048
    ds_read_b64_tr_b16 a[46:47], v21 offset:2560
    s_waitcnt lgkmcnt(0)
    s_add_u32 m0, s70, 133120
    s_add_u32 s0, s67, 196608
    buffer_load_dwordx4 v6, s[24:27], s0 offen lds
    buffer_load_dwordx4 v10, s[24:27], s0 offen offset:1024 lds
    ds_read_b64_tr_b16 a[48:49], v20 offset:4096
    ds_read_b64_tr_b16 a[50:51], v20 offset:4608
    ds_read_b64_tr_b16 a[52:53], v21 offset:4096
    ds_read_b64_tr_b16 a[54:55], v21 offset:4608
    s_waitcnt lgkmcnt(0)
    s_add_u32 m0, s70, 135168
    s_add_u32 s0, s67, 212992
    buffer_load_dwordx4 v6, s[24:27], s0 offen lds
    buffer_load_dwordx4 v10, s[24:27], s0 offen offset:1024 lds
    s_waitcnt vmcnt(12)
    ds_read_b64_tr_b16 a[56:57], v18 offset:0
    ds_read_b64_tr_b16 a[58:59], v18 offset:512
    ds_read_b64_tr_b16 a[60:61], v19 offset:0
    ds_read_b64_tr_b16 a[62:63], v19 offset:512
    s_waitcnt lgkmcnt(0)
    s_add_u32 m0, s70, 0
    s_add_u32 s0, s67, 425984
    buffer_load_dwordx4 v6, s[24:27], s0 offen lds
    buffer_load_dwordx4 v10, s[24:27], s0 offen offset:1024 lds
    s_waitcnt vmcnt(12)
    ds_read_b64_tr_b16 a[64:65], v18 offset:2048
    ds_read_b64_tr_b16 a[66:67], v18 offset:2560
    ds_read_b64_tr_b16 a[68:69], v19 offset:2048
    ds_read_b64_tr_b16 a[70:71], v19 offset:2560
    s_waitcnt lgkmcnt(0)
    s_add_u32 m0, s70, 2048
    s_add_u32 s0, s67, 442368
    buffer_load_dwordx4 v6, s[24:27], s0 offen lds
    buffer_load_dwordx4 v10, s[24:27], s0 offen offset:1024 lds
    s_waitcnt vmcnt(12)
    ds_read_b64_tr_b16 a[72:73], v18 offset:4096
    ds_read_b64_tr_b16 a[74:75], v18 offset:4608
    ds_read_b64_tr_b16 a[76:77], v19 offset:4096
    ds_read_b64_tr_b16 a[78:79], v19 offset:4608
L_poll28:
    buffer_load_dword v30, v23, s[32:35], s93 offen offset:0 sc1
    s_sub_u32 s56, s56, 1
    s_cselect_b64 s[76:77], 0, -1
    s_max_i32 s56, s56, 0
    s_waitcnt vmcnt(0)
    v_cmp_eq_u32 vcc, 0, v30
    s_and_b64 vcc, vcc, s[76:77]
    s_cbranch_scc1 L_poll28
    s_add_u32 s58, s94, 0
    buffer_load_dwordx4 v[48:51], v1, s[32:35], s58 offen offset:0 sc1
    buffer_load_dwordx4 v[52:55], v1, s[32:35], s58 offen offset:1024 sc1
    buffer_load_dwordx4 v[56:59], v1, s[32:35], s58 offen offset:2048 sc1
    buffer_load_dwordx4 v[60:63], v1, s[32:35], s58 offen offset:3072 sc1
    s_waitcnt vmcnt(0) lgkmcnt(0)
    s_branch L_k4_0
L_slow_o8:
    buffer_store_dwordx4 v[60:63], v1, s[32:35], s78 offen sc1
    buffer_store_dwordx4 v[76:79], v1, s[32:35], s78 offen offset:1024 sc1
    s_nop 1
    s_branch L_ret_o8
L_slow_f9:
    buffer_store_dword v30, v28, s[32:35], s79 offen offset:0 sc1
    s_nop 1
    s_branch L_ret_f9
L_slow_x11:
    buffer_store_dwordx4 v[48:51], v1, s[32:35], s82 offen sc1
    buffer_store_dwordx4 v[52:55], v1, s[32:35], s82 offen offset:1024 sc1
    s_nop 1
    s_branch L_ret_x11
L_slow_s12:
    buffer_store_dwordx2 v[56:57], v60, s[32:35], s83 offen sc1
    s_nop 1
    s_branch L_ret_s12
L_slow_f13:
    buffer_store_dword v30, v28, s[32:35], s84 offen offset:0 sc1
    s_nop 1
    s_branch L_ret_f13
L_slow_f14:
    buffer_store_dword v30, v28, s[32:35], s84 offen offset:1536 sc1
    s_nop 1
    s_branch L_ret_f14
L_slow_f22:
    buffer_store_dword v30, v28, s[32:35], s92 offen offset:0 sc1
    s_nop 1
    s_branch L_ret_f22
L_slow_f29:
    buffer_store_dword v30, v28, s[36:39], s92 offen offset:128 sc1
    s_nop 1
    s_branch L_ret_f29
L_slow_x41:
    buffer_store_dwordx4 v[48:51], v1, s[32:35], s82 offen sc1
    buffer_store_dwordx4 v[52:55], v1, s[32:35], s82 offen offset:1024 sc1
    s_nop 1
    s_branch L_ret_x41
L_slow_s42:
    buffer_store_dwordx2 v[56:57], v60, s[32:35], s83 offen sc1
    s_nop 1
    s_branch L_ret_s42
L_slow_f43:
    buffer_store_dword v30, v28, s[32:35], s84 offen offset:1024 sc1
    s_nop 1
    s_branch L_ret_f43
L_slow_f44:
    buffer_store_dword v30, v28, s[32:35], s84 offen offset:2560 sc1
    s_nop 1
    s_branch L_ret_f44
L_slow_o51:
    buffer_store_dwordx4 v[60:63], v1, s[32:35], s78 offen sc1
    buffer_store_dwordx4 v[76:79], v1, s[32:35], s78 offen offset:1024 sc1
    s_nop 1
    s_branch L_ret_o51
L_slow_f52:
    buffer_store_dword v30, v28, s[32:35], s79 offen offset:512 sc1
    s_nop 1
    s_branch L_ret_f52
L_slow_x54:
    buffer_store_dwordx4 v[48:51], v1, s[32:35], s82 offen sc1
    buffer_store_dwordx4 v[52:55], v1, s[32:35], s82 offen offset:1024 sc1
    s_nop 1
    s_branch L_ret_x54
L_slow_s55:
    buffer_store_dwordx2 v[56:57], v60, s[32:35], s83 offen sc1
    s_nop 1
    s_branch L_ret_s55
L_slow_f56:
    buffer_store_dword v30, v28, s[32:35], s84 offen offset:512 sc1
    s_nop 1
    s_branch L_ret_f56
L_slow_f57:
    buffer_store_dword v30, v28, s[32:35], s84 offen offset:2048 sc1
    s_nop 1
    s_branch L_ret_f57
L_slow_h62:
    buffer_store_dwordx4 v[56:59], v1, s[32:35], s91 offen offset:0 sc1
    s_nop 1
    s_branch L_ret_h62
L_slow_h63:
    buffer_store_dwordx4 v[72:75], v1, s[32:35], s91 offen offset:1024 sc1
    s_nop 1
    s_branch L_ret_h63
L_slow_h64:
    buffer_store_dwordx4 v[88:91], v1, s[32:35], s91 offen offset:2048 sc1
    s_nop 1
    s_branch L_ret_h64
L_slow_h65:
    buffer_store_dwordx4 v[104:107], v1, s[32:35], s91 offen offset:3072 sc1
    s_nop 1
    s_branch L_ret_h65
L_slow_h66:
    buffer_store_dwordx4 v[120:123], v1, s[32:35], s76 offen offset:0 sc1
    s_nop 1
    s_branch L_ret_h66
L_slow_f67:
    buffer_store_dword v30, v28, s[32:35], s92 offen offset:1024 sc1
    s_nop 1
    s_branch L_ret_f67
L_slow_h68:
    buffer_store_dwordx4 v[136:139], v1, s[32:35], s76 offen offset:1024 sc1
    s_nop 1
    s_branch L_ret_h68
L_slow_h72:
    buffer_store_dwordx4 v[152:155], v1, s[32:35], s76 offen offset:2048 sc1
    s_nop 1
    s_branch L_ret_h72
L_slow_h73:
    buffer_store_dwordx4 v[168:171], v1, s[32:35], s76 offen offset:3072 sc1
    s_nop 1
    s_branch L_ret_h73
L_slow_f77:
    buffer_store_dword v30, v28, s[36:39], s92 offen offset:1152 sc1
    s_nop 1
    s_branch L_ret_f77
L_slow_f27:
    buffer_store_dword v30, v28, s[32:35], s58 offen offset:0 sc1
    s_nop 1
    s_branch L_ret_f27
L_slow_f75:
    buffer_store_dword v30, v28, s[32:35], s58 offen offset:16 sc1
    s_nop 1
    s_branch L_ret_f75
L_last:
    s_endpgm
.section .rodata,"a"
.p2align 6
.amdhsa_kernel interleave_layers__linear_kernel_hedgehog__geglu_ffn__prompt_kernel
  .amdhsa_next_free_vgpr 512
  .amdhsa_next_free_sgpr 102
  .amdhsa_accum_offset 256
  .amdhsa_group_segment_fixed_size 0
  .amdhsa_kernarg_size 88
  .amdhsa_user_sgpr_count 2
  .amdhsa_user_sgpr_kernarg_segment_ptr 1
  .amdhsa_system_sgpr_workgroup_id_x 1
  .amdhsa_float_denorm_mode_32 3
  .amdhsa_float_denorm_mode_16_64 3
.end_amdhsa_kernel
```
